```python
import torch

def _softmax(x, axis=-1):
    return torch.softmax(x, dim=axis)
def _gelu(x):
    return torch.nn.functional.gelu(x, approximate="tanh")
def _silu(x):
    return torch.nn.functional.silu(x)
def _sigmoid(x):
    return torch.sigmoid(x)
def _layernorm(x, axis=-1, eps=1e-5):
    m = x.mean(dim=axis, keepdim=True)
    v = x.var(dim=axis, keepdim=True, unbiased=False)
    return (x - m) / torch.sqrt(v + eps)
def _scatter_add(tgt, idx, src, axis=0):
    return tgt.clone().index_add_(axis, idx, src)
def _segment_sum(src, seg, n):
    out = torch.zeros((n,) + src.shape[1:], dtype=src.dtype)
    return out.index_add_(0, seg, src)
def _pad(x, pw):
    flat = tuple(v for pair in reversed(pw) for v in pair)
    return torch.nn.functional.pad(x, flat)

kernel_name = 'interleave_layers__sliding_block__dense_activation_squared_relu__prompt'

def setup_inputs():

    _w = (lambda a: (lambda t: t.to(torch.bfloat16) if t.is_floating_point() else t)(torch.as_tensor(a)))
    def _A_setup():
        B, S, D = 1, 2048, 640
        return {
            "x": _w((lambda *s: torch.randn(*s, dtype=torch.bfloat16) * 0.05)(B, S, D)),
            "wqkv": _w((lambda *s: torch.randn(*s, dtype=torch.bfloat16) * 0.05)(D, 3 * D)),
            "wo": _w((lambda *s: torch.randn(*s, dtype=torch.bfloat16) * 0.05)(D, D)),
        }
    _A_in = _A_setup()

    def _B_setup():
        B, S, D, F = 1, 2048, 640, 1536
        return {
            "x": _w((lambda *s: torch.randn(*s, dtype=torch.bfloat16) * 0.05)(B, S, D)),
            "w1": _w((lambda *s: torch.randn(*s, dtype=torch.bfloat16) * 0.05)(D, F)),
            "b1": _w((lambda *s: torch.randn(*s, dtype=torch.bfloat16) * 0.2)(F)),
            "w2": _w((lambda *s: torch.randn(*s, dtype=torch.bfloat16) * 0.05)(F, D)),
            "b2": _w((lambda *s: torch.randn(*s, dtype=torch.bfloat16) * 0.8)(D)),
        }
    _B_in = _B_setup()

    return {
        "A_x": _A_in["x"],
        "A_wqkv": _A_in["wqkv"],
        "A_wo": _A_in["wo"],
        "B_x": _B_in["x"],
        "B_w1": _B_in["w1"],
        "B_b1": _B_in["b1"],
        "B_w2": _B_in["w2"],
        "B_b2": _B_in["b2"],
    }

def reference(A_x, A_wqkv, A_wo, B_x, B_w1, B_b1, B_w2, B_b2):
    def _A_ref(x, wqkv, wo):
        B, S, D = x.shape
        H = 32; Dh = D // H; W = 256
        qkv = (lambda x, *d: x.permute(*d))((x @ wqkv).reshape(B, S, 3, H, Dh), 2, 0, 3, 1, 4)
        q, k, v = qkv[0], qkv[1], qkv[2]
        scores = torch.einsum("bhqd,bhkd->bhqk", q, k) * (Dh ** -0.5)
        idx = torch.arange(S)
        mask = (idx[:, None] - idx[None, :] >= 0) & (idx[:, None] - idx[None, :] < W)
        scores = torch.where(mask[None, None], scores, -1e9)
        p = _softmax(scores, axis=-1)
        o = torch.einsum("bhqk,bhkd->bhqd", p, v)
        return (lambda x, *d: x.permute(*d))(o, 0, 2, 1, 3).reshape(B, S, D) @ wo

    def _B_ref(x, w1, b1, w2, b2):
        h = torch.einsum("bsd,df->bsf", x, w1) + b1
        zero = torch.zeros_like(h)
        r = torch.where(h > zero, h, zero)
        h = r * r
        out = torch.einsum("bsf,fd->bsd", h, w2) + b2
        return out

    x = A_x
    x = x + _A_ref(_layernorm(x, axis=-1), A_wqkv, A_wo)
    x = x + _B_ref(_layernorm(x, axis=-1), B_w1, B_b1, B_w2, B_b2)
    x = x + _A_ref(_layernorm(x, axis=-1), A_wqkv, A_wo)
    x = x + _B_ref(_layernorm(x, axis=-1), B_w1, B_b1, B_w2, B_b2)
    return x
```

```asm
; @launch grid=(256,1,1) block=(512,1,1) lds=163840
.amdgcn_target "amdgcn-amd-amdhsa--gfx950"
.text
.p2align 8
.globl interleave_layers__sliding_block__dense_activation_squared_relu__prompt_kernel
.type interleave_layers__sliding_block__dense_activation_squared_relu__prompt_kernel,@function
interleave_layers__sliding_block__dense_activation_squared_relu__prompt_kernel:
    s_cmp_ge_u32 s2, 256
    s_cbranch_scc1 interleave_layers__sliding_block__dense_activation_squared_relu__prompt_kernel_end
    s_load_dwordx2 s[44:45], s[0:1], 0
    s_load_dwordx2 s[52:53], s[0:1], 8
    s_load_dwordx2 s[48:49], s[0:1], 72
    s_load_dwordx2 s[4:5], s[0:1], 80
    s_load_dwordx2 s[8:9], s[0:1], 56
    s_load_dwordx2 s[12:13], s[0:1], 64
    s_memrealtime s[56:57]
    v_lshrrev_b32 v1, 6, v0
    v_and_b32 v0, 63, v0
    v_readfirstlane_b32 s3, v1
    s_and_b32 s16, s2, 7
    s_lshr_b32 s17, s2, 3
    s_mov_b32 s39, 0
    s_and_b32 s26, s3, 3
    s_cmp_ge_u32 s3, 4
    s_cbranch_scc1 fast_svc
    s_mov_b32 s46, 0x280000
    s_mov_b32 s47, 0x20000
    v_lshrrev_b32 v16, 3, v0
    v_and_b32 v17, 7, v0
    v_mul_u32_u24 v23, 1280, v16
    v_lshrrev_b32 v18, 2, v17
    v_lshl_add_u32 v23, v18, 6, v23
    v_and_b32 v18, 3, v17
    v_lshl_add_u32 v23, v18, 3, v23
    s_lshl_b32 s40, s16, 5
    s_add_u32 s40, s40, s17
    s_mul_i32 s40, s40, 10240
    s_lshl_b32 s41, s26, 7
    s_add_u32 s40, s40, s41
    s_cmp_lt_u32 s26, 2
    s_cselect_b32 s41, 0, 0x7fff0000
    v_add_u32 v21, s41, v23
    s_waitcnt lgkmcnt(0)
    buffer_load_dwordx2 v[24:25], v23, s[44:47], s40 offen offset:0
    buffer_load_dwordx2 v[26:27], v23, s[44:47], s40 offen offset:32
    buffer_load_dwordx2 v[28:29], v23, s[44:47], s40 offen offset:512
    buffer_load_dwordx2 v[30:31], v23, s[44:47], s40 offen offset:544
    buffer_load_dwordx2 v[32:33], v21, s[44:47], s40 offen offset:1024
    buffer_load_dwordx2 v[34:35], v21, s[44:47], s40 offen offset:1056
    s_branch setup
fast_svc:
    s_mov_b32 s47, 0x20000
    s_mov_b32 s54, 0x258000
    s_mov_b32 s55, 0x20000
    s_mul_i32 s34, s26, 12288
    s_add_u32 s34, s34, 106496
    s_cmp_ge_u32 s26, 2
    s_cbranch_scc1 fast_no
    s_cmp_ge_u32 s17, 20
    s_cbranch_scc1 fast_no
    v_mul_u32_u24 v17, 205, v0
    v_lshrrev_b32 v17, 11, v17
    v_mul_u32_u24 v18, 3680, v17
    v_lshl_add_u32 v64, v0, 4, v18
    s_lshl_b32 s40, s17, 5
    s_lshl_b32 s41, s26, 3
    s_add_u32 s40, s40, s41
    s_mul_i32 s40, s40, 3840
    s_mul_i32 s41, s16, 160
    s_add_u32 s40, s40, s41
    s_mov_b32 exec_hi, 0xff
    s_waitcnt lgkmcnt(0)
    s_add_u32 m0, s34, 0
    s_add_u32 s42, s40, 0
    buffer_load_dwordx4 v64, s[52:55], s42 offen lds
    s_add_u32 m0, s34, 1024
    s_add_u32 s42, s40, 15360
    buffer_load_dwordx4 v64, s[52:55], s42 offen lds
    s_add_u32 m0, s34, 2048
    s_add_u32 s42, s40, 61440
    buffer_load_dwordx4 v64, s[52:55], s42 offen lds
    s_add_u32 m0, s34, 3072
    s_add_u32 s42, s40, 76800
    buffer_load_dwordx4 v64, s[52:55], s42 offen lds
    s_add_u32 m0, s34, 4096
    s_add_u32 s42, s40, 1280
    buffer_load_dwordx4 v64, s[52:55], s42 offen lds
    s_add_u32 m0, s34, 5120
    s_add_u32 s42, s40, 16640
    buffer_load_dwordx4 v64, s[52:55], s42 offen lds
    s_add_u32 m0, s34, 6144
    s_add_u32 s42, s40, 62720
    buffer_load_dwordx4 v64, s[52:55], s42 offen lds
    s_add_u32 m0, s34, 7168
    s_add_u32 s42, s40, 78080
    buffer_load_dwordx4 v64, s[52:55], s42 offen lds
    s_add_u32 m0, s34, 8192
    s_add_u32 s42, s40, 2560
    buffer_load_dwordx4 v64, s[52:55], s42 offen lds
    s_add_u32 m0, s34, 9216
    s_add_u32 s42, s40, 17920
    buffer_load_dwordx4 v64, s[52:55], s42 offen lds
    s_add_u32 m0, s34, 10240
    s_add_u32 s42, s40, 64000
    buffer_load_dwordx4 v64, s[52:55], s42 offen lds
    s_add_u32 m0, s34, 11264
    s_add_u32 s42, s40, 79360
    buffer_load_dwordx4 v64, s[52:55], s42 offen lds
    s_mov_b32 exec_hi, -1
fast_no:
    s_lshl_b32 s40, s17, 3
    s_add_u32 s40, s40, s3
    s_cmp_lg_u32 s40, 255
    s_cbranch_scc1 cp_1
    s_getpc_b64 s[58:59]
    v_lshlrev_b32 v2, 7, v0
    global_load_dword v240, v2, s[58:59]
    v_add_u32 v2, 8192, v2
    global_load_dword v241, v2, s[58:59]
    v_add_u32 v2, 8192, v2
    global_load_dword v242, v2, s[58:59]
    v_add_u32 v2, 8192, v2
    global_load_dword v243, v2, s[58:59]
    v_add_u32 v2, 8192, v2
    global_load_dword v244, v2, s[58:59]
    v_add_u32 v2, 8192, v2
    global_load_dword v245, v2, s[58:59]
    v_add_u32 v2, 8192, v2
    global_load_dword v246, v2, s[58:59]
    v_add_u32 v2, 8192, v2
cp_1:
setup:
    s_nop 2
    s_waitcnt lgkmcnt(0)
    s_mov_b32 s6, 0x10000000
    s_mov_b32 s7, 0x20000
    s_mov_b32 s10, 0x500
    s_mov_b32 s11, 0x20000
    s_mov_b32 s14, 0x280000
    s_mov_b32 s15, 0x20000
    s_mov_b32 s50, 0x100
    s_mov_b32 s51, 0x20000
    s_or_b32 s41, s2, s3
    s_cmp_lg_u32 s41, 0
    s_cbranch_scc1 nn_2
    s_or_b32 s56, s56, 1
    v_mov_b32 v10, s56
    v_mov_b32 v12, 0
    s_mov_b64 exec, 1
    buffer_store_dword v10, v12, s[48:51], 0 offen sc1
    s_mov_b64 exec, -1
nn_2:
    s_nop 0
    v_lshlrev_b32 v1, 4, v0
    v_lshlrev_b32 v2, 3, v0
    v_lshlrev_b32 v3, 2, v0
    s_lshl_b32 s40, s16, 3
    s_add_u32 s19, s40, s26
    s_sub_u32 s18, 7, s26
    s_add_u32 s18, s18, s40
    s_mov_b32 s20, 20004864
    s_mov_b32 s21, 5513216
    s_mov_b32 s22, 0
    s_mov_b32 s23, 400000
    s_and_b32 s24, s17, 3
    s_lshr_b32 s25, s17, 2
    s_lshl_b32 s41, s24, 1
    s_add_u32 s28, s40, s41
    s_lshr_b32 s41, s26, 1
    s_add_u32 s28, s28, s41
    s_and_b32 s29, s26, 1
    s_lshr_b32 s30, s17, 1
    s_and_b32 s41, s17, 1
    s_lshl_b32 s41, s41, 2
    s_add_u32 s31, s40, s41
    s_add_u32 s31, s31, s26
    s_lshl_b32 s27, s16, 5
    s_add_u32 s27, s27, s17
    s_lshl_b32 s27, s27, 2
    s_add_u32 s27, s27, s26
    v_lshrrev_b32 v4, 5, v0
    v_and_b32 v5, 31, v0
    v_cmp_eq_u32 s[32:33], 0, v4
    v_add_u32 v8, 106496, v1
    v_mov_b32 v6, 122880
    v_lshl_add_u32 v13, v5, 3, v6
    v_mov_b32 v6, 159744
    v_cndmask_b32 v9, v13, v6, s[32:33]
    v_bfe_u32 v6, v5, 1, 3
    v_mov_b32 v7, 126976
    v_lshl_add_u32 v7, v5, 6, v7
    v_add_u32 v14, 0, v4
    v_xor_b32 v14, v14, v6
    v_lshl_add_u32 v10, v14, 3, v7
    v_add_u32 v14, 2, v4
    v_xor_b32 v14, v14, v6
    v_lshl_add_u32 v11, v14, 3, v7
    v_add_u32 v14, 4, v4
    v_xor_b32 v14, v14, v6
    v_lshl_add_u32 v12, v14, 3, v7
    s_getreg_b32 s62, hwreg(HW_REG_XCC_ID)
    s_and_b32 s62, s62, 15
    s_add_u32 s62, s62, 1
    s_lshl_b32 s63, s16, 7
    s_add_u32 s63, s63, 5510144
    s_cmp_ge_u32 s3, 4
    s_cbranch_scc1 service
    v_mov_b32 v236, v8
    v_mov_b32 v237, v13
    v_mov_b32 v238, v9
    v_mov_b32 v239, v10
    v_mov_b32 v240, v11
    v_mov_b32 v241, v12
    v_bfe_u32 v6, v0, 2, 2
    v_lshl_add_u32 v6, v4, 2, v6
    v_bfe_u32 v7, v0, 4, 1
    v_and_b32 v14, 3, v0
    v_lshl_add_u32 v7, v7, 2, v14
    v_lshrrev_b32 v14, 1, v6
    v_xor_b32 v7, v7, v14
    v_mov_b32 v14, 126976
    v_lshl_add_u32 v6, v6, 6, v14
    v_lshl_add_u32 v242, v7, 3, v6
    v_xor_b32 v7, 4, v7
    v_lshl_add_u32 v243, v7, 3, v6
    v_and_b32 v14, 15, v0
    v_lshrrev_b32 v15, 4, v0
    v_lshlrev_b32 v6, 9, v15
    v_lshl_add_u32 v244, v14, 4, v6
    s_mul_i32 s40, s28, 40960
    s_lshl_b32 s41, s29, 8
    s_add_u32 s40, s40, s41
    s_add_u32 s40, s40, 2621440
    s_mul_i32 s41, s25, 5
    s_add_u32 s42, s41, 0
    s_lshr_b32 s43, s42, 1
    s_lshl_b32 s43, s43, 11
    s_and_b32 s42, s42, 1
    s_lshl_b32 s42, s42, 3
    s_add_u32 s43, s43, s42
    s_add_u32 s34, s43, s40
    s_add_u32 s42, s41, 1
    s_lshr_b32 s43, s42, 1
    s_lshl_b32 s43, s43, 11
    s_and_b32 s42, s42, 1
    s_lshl_b32 s42, s42, 3
    s_add_u32 s43, s43, s42
    s_add_u32 s35, s43, s40
    s_add_u32 s42, s41, 2
    s_lshr_b32 s43, s42, 1
    s_lshl_b32 s43, s43, 11
    s_and_b32 s42, s42, 1
    s_lshl_b32 s42, s42, 3
    s_add_u32 s43, s43, s42
    s_add_u32 s36, s43, s40
    s_add_u32 s42, s41, 3
    s_lshr_b32 s43, s42, 1
    s_lshl_b32 s43, s43, 11
    s_and_b32 s42, s42, 1
    s_lshl_b32 s42, s42, 3
    s_add_u32 s43, s43, s42
    s_add_u32 s37, s43, s40
    s_add_u32 s42, s41, 4
    s_lshr_b32 s43, s42, 1
    s_lshl_b32 s43, s43, 11
    s_and_b32 s42, s42, 1
    s_lshl_b32 s42, s42, 3
    s_add_u32 s43, s43, s42
    s_add_u32 s38, s43, s40
    v_lshlrev_b32 v19, 9, v17
    v_lshl_add_u32 v19, v16, 4, v19
    v_mov_b32 v20, 0x7fff0000
    s_cmp_lt_u32 s26, 2
    s_cselect_b64 vcc, -1, 0
    v_cndmask_b32 v22, v20, v19, vcc
    s_lshl_b32 s42, s16, 3
    s_add_u32 s42, s42, s25
    s_mul_i32 s43, s42, 40960
    s_lshl_b32 s41, s24, 7
    s_add_u32 s43, s43, s41
    s_lshl_b32 s41, s26, 12
    s_add_u32 s43, s43, s41
    s_add_u32 s43, s43, 2621440
    v_mov_b32 v12, 0
    v_mov_b32 v13, 0
    s_lshl_b32 s58, s28, 3
    s_add_u32 s58, s58, s25
    s_lshl_b32 s58, s58, 8
    s_lshl_b32 s41, s29, 7
    s_add_u32 s58, s58, s41
    s_mov_b64 exec, 0xffff
    s_add_u32 s41, s58, 5644288
    buffer_store_dwordx2 v[12:13], v2, s[4:7], s41 offen sc1
    s_add_u32 s41, s58, 5922816
    buffer_store_dwordx2 v[12:13], v2, s[4:7], s41 offen sc1
    s_add_u32 s41, s58, 6053888
    buffer_store_dwordx2 v[12:13], v2, s[4:7], s41 offen sc1
    s_mov_b64 exec, -1
    s_waitcnt vmcnt(7)
    buffer_store_dwordx4 v[24:27], v19, s[4:7], s43 offen sc1
    s_add_u32 s43, s43, 16384
    s_waitcnt vmcnt(6)
    buffer_store_dwordx4 v[28:31], v19, s[4:7], s43 offen sc1
    s_add_u32 s43, s43, 16384
    s_waitcnt vmcnt(5)
    buffer_store_dwordx4 v[32:35], v22, s[4:7], s43 offen sc1
    s_add_u32 s43, s43, 16384
    v_lshlrev_b32 v40, 16, v24
    v_and_b32 v41, 0xffff0000, v24
    v_lshlrev_b32 v42, 16, v25
    v_and_b32 v43, 0xffff0000, v25
    v_lshlrev_b32 v44, 16, v26
    v_and_b32 v45, 0xffff0000, v26
    v_lshlrev_b32 v46, 16, v27
    v_and_b32 v47, 0xffff0000, v27
    v_lshlrev_b32 v48, 16, v28
    v_and_b32 v49, 0xffff0000, v28
    v_lshlrev_b32 v50, 16, v29
    v_and_b32 v51, 0xffff0000, v29
    v_lshlrev_b32 v52, 16, v30
    v_and_b32 v53, 0xffff0000, v30
    v_lshlrev_b32 v54, 16, v31
    v_and_b32 v55, 0xffff0000, v31
    v_lshlrev_b32 v56, 16, v32
    v_and_b32 v57, 0xffff0000, v32
    v_lshlrev_b32 v58, 16, v33
    v_and_b32 v59, 0xffff0000, v33
    v_lshlrev_b32 v60, 16, v34
    v_and_b32 v61, 0xffff0000, v34
    v_lshlrev_b32 v62, 16, v35
    v_and_b32 v63, 0xffff0000, v35
    v_pk_mul_f32 v[38:39], v[40:41], v[40:41]
    v_pk_add_f32 v[36:37], v[40:41], v[42:43]
    v_pk_fma_f32 v[38:39], v[42:43], v[42:43], v[38:39]
    v_pk_add_f32 v[36:37], v[36:37], v[44:45]
    v_pk_fma_f32 v[38:39], v[44:45], v[44:45], v[38:39]
    v_pk_add_f32 v[36:37], v[36:37], v[46:47]
    v_pk_fma_f32 v[38:39], v[46:47], v[46:47], v[38:39]
    v_pk_add_f32 v[36:37], v[36:37], v[48:49]
    v_pk_fma_f32 v[38:39], v[48:49], v[48:49], v[38:39]
    v_pk_add_f32 v[36:37], v[36:37], v[50:51]
    v_pk_fma_f32 v[38:39], v[50:51], v[50:51], v[38:39]
    v_pk_add_f32 v[36:37], v[36:37], v[52:53]
    v_pk_fma_f32 v[38:39], v[52:53], v[52:53], v[38:39]
    v_pk_add_f32 v[36:37], v[36:37], v[54:55]
    v_pk_fma_f32 v[38:39], v[54:55], v[54:55], v[38:39]
    v_pk_add_f32 v[36:37], v[36:37], v[56:57]
    v_pk_fma_f32 v[38:39], v[56:57], v[56:57], v[38:39]
    v_pk_add_f32 v[36:37], v[36:37], v[58:59]
    v_pk_fma_f32 v[38:39], v[58:59], v[58:59], v[38:39]
    v_pk_add_f32 v[36:37], v[36:37], v[60:61]
    v_pk_fma_f32 v[38:39], v[60:61], v[60:61], v[38:39]
    v_pk_add_f32 v[36:37], v[36:37], v[62:63]
    v_pk_fma_f32 v[38:39], v[62:63], v[62:63], v[38:39]
    v_add_f32 v36, v36, v37
    v_add_f32 v37, v38, v39
    s_nop 0
    v_add_f32_dpp v36, v36, v36 quad_perm:[1,0,3,2] row_mask:0xf bank_mask:0xf
    v_add_f32_dpp v37, v37, v37 quad_perm:[1,0,3,2] row_mask:0xf bank_mask:0xf
    s_nop 0
    v_add_f32_dpp v36, v36, v36 quad_perm:[2,3,0,1] row_mask:0xf bank_mask:0xf
    v_add_f32_dpp v37, v37, v37 quad_perm:[2,3,0,1] row_mask:0xf bank_mask:0xf
    s_nop 0
    v_add_f32_dpp v36, v36, v36 row_half_mirror row_mask:0xf bank_mask:0xf
    v_add_f32_dpp v37, v37, v37 row_half_mirror row_mask:0xf bank_mask:0xf
    v_or_b32 v37, 0x80000000, v37
    v_cmp_eq_u32 vcc, 0, v17
    s_nop 1
    v_cndmask_b32 v36, 0, v36, vcc
    v_mov_b32 v38, 0x80000000
    v_cndmask_b32 v37, v38, v37, vcc
    v_lshlrev_b32 v38, 10, v17
    v_lshl_add_u32 v38, v16, 3, v38
    v_cmp_gt_u32 vcc, 2, v17
    s_nop 1
    v_cndmask_b32 v38, v20, v38, vcc
    s_lshl_b32 s41, s42, 11
    s_lshl_b32 s40, s26, 8
    s_add_u32 s41, s41, s40
    s_lshl_b32 s40, s24, 6
    s_add_u32 s41, s41, s40
    s_add_u32 s41, s41, 5513216
    buffer_store_dwordx2 v[36:37], v38, s[4:7], s41 offen sc1
    v_mov_b32 v16, 159752
    ds_write_b32 v16, v12
    s_waitcnt lgkmcnt(0)
    s_barrier
    s_mov_b32 s61, 0
pl_3:
    v_mov_b32 v10, 0
    buffer_load_dword v10, v10, s[48:51], 0 offen sc1
    s_waitcnt vmcnt(0)
ck_5:
    s_nop 0
    v_cmp_eq_u32 vcc, 0, v10
    s_add_u32 s61, s61, 1
    s_nop 3
    s_cbranch_vccz pd_4
    s_cmp_ge_u32 s61, s23
    s_cbranch_scc1 to_6
    s_branch pl_3
pd_4:
    v_readfirstlane_b32 s100, v10
    v_mov_b32 v16, 159752
    v_mov_b32 v17, 1
    s_mov_b64 exec, 1
    ds_add_rtn_u32 v17, v16, v17
    s_cmp_lt_u32 s17, 20
    s_cselect_b32 s40, 5, 3
    s_waitcnt lgkmcnt(0)
    v_cmp_ne_u32 vcc, s40, v17
    s_nop 4
    s_cbranch_vccnz ar_7
    s_lshr_b32 s40, s27, 2
    s_lshl_b32 s40, s40, 7
    s_add_u32 s40, s40, 5373952
    v_mov_b32 v16, 0
    v_mov_b32 v17, s100
    buffer_store_dword v17, v16, s[4:7], s40 offen sc1
ar_7:
    s_nop 1
    s_mov_b64 exec, -1
    v_mov_b32 v10, 159748
    s_mov_b32 s61, 0
lf_8:
    s_nop 1
    ds_read_b32 v11, v10
    s_waitcnt lgkmcnt(0)
    v_cmp_ne_u32 vcc, s100, v11
    s_add_u32 s61, s61, 1
    s_nop 3
    s_cbranch_vccz lfd_9
    s_lshr_b32 s60, s61, 5
    s_cmp_ge_u32 s60, s23
    s_cbranch_scc1 to_10
    s_sleep 1
    s_branch lf_8
lfd_9:
    s_lshl_b32 s42, s26, 11
    s_mul_i32 s43, s17, 81920
    s_add_u32 s43, s43, s42
    s_add_u32 s40, s42, 0
    s_mov_b32 m0, s40
    s_add_u32 s41, s43, 0
    buffer_load_dwordx4 v1, s[4:7], s41 offen offset:0 sc1 lds
    buffer_load_dwordx4 v1, s[4:7], s41 offen offset:1024 sc1 lds
    s_add_u32 s40, s42, 8192
    s_mov_b32 m0, s40
    s_add_u32 s41, s43, 8192
    buffer_load_dwordx4 v1, s[4:7], s41 offen offset:0 sc1 lds
    buffer_load_dwordx4 v1, s[4:7], s41 offen offset:1024 sc1 lds
    s_mov_b32 s22, 1
layer_top:
    s_cmp_eq_u32 s16, 0
    s_cselect_b32 s101, 6291456, 0
    s_add_u32 s101, s101, s20
    s_sub_u32 s101, s101, 786432
    s_lshl_b32 s42, s18, 11
    s_add_u32 s42, s42, s21
    s_lshl_b32 s43, s19, 11
    s_add_u32 s43, s43, s21
    s_mul_i32 s44, s18, 40960
    s_add_u32 s44, s44, 2621440
    s_mul_i32 s45, s19, 40960
    s_add_u32 s45, s45, 2621440
    v_add_u32 v212, 40960, v1
    s_mov_b32 s61, 0
pl_13:
    s_nop 1
    buffer_load_dwordx2 v[12:13], v2, s[4:7], s42 offen offset:0 sc1
    buffer_load_dwordx2 v[14:15], v2, s[4:7], s42 offen offset:512 sc1
    buffer_load_dwordx2 v[16:17], v2, s[4:7], s42 offen offset:1024 sc1
    buffer_load_dwordx2 v[18:19], v2, s[4:7], s42 offen offset:1536 sc1
    buffer_load_dwordx2 v[20:21], v2, s[4:7], s43 offen offset:0 sc1
    buffer_load_dwordx2 v[22:23], v2, s[4:7], s43 offen offset:512 sc1
    buffer_load_dwordx2 v[24:25], v2, s[4:7], s43 offen offset:1024 sc1
    buffer_load_dwordx2 v[26:27], v2, s[4:7], s43 offen offset:1536 sc1
    s_waitcnt vmcnt(0)
    v_and_b32 v219, v13, v15
    v_and_b32 v219, v219, v17
    v_and_b32 v219, v219, v19
    v_and_b32 v219, v219, v21
    v_and_b32 v219, v219, v23
    v_and_b32 v219, v219, v25
    v_and_b32 v219, v219, v27
    v_cmp_le_i32 vcc, 0, v219
    s_add_u32 s61, s61, 1
    s_nop 3
    s_cbranch_vccz pd_14
    s_cmp_ge_u32 s61, s23
    s_cbranch_scc1 to_15
    s_branch pl_13
pd_14:
    s_cmp_eq_u32 s22, 0
    s_cbranch_scc1 inv_16
invr_17:
    buffer_load_dwordx4 v[52:55], v1, s[4:7], s44 offen offset:0 sc1
    buffer_load_dwordx4 v[84:87], v1, s[4:7], s45 offen offset:0 sc1
    buffer_load_dwordx4 v[56:59], v1, s[4:7], s44 offen offset:1024 sc1
    buffer_load_dwordx4 v[88:91], v1, s[4:7], s45 offen offset:1024 sc1
    buffer_load_dwordx4 v[60:63], v1, s[4:7], s44 offen offset:2048 sc1
    buffer_load_dwordx4 v[92:95], v1, s[4:7], s45 offen offset:2048 sc1
    s_cmp_eq_u32 s39, 0
    s_cbranch_scc1 q0_18
    s_barrier
q1_19:
    ds_read_b128 v[28:31], v1 offset:0
    ds_read_b128 v[32:35], v1 offset:1024
    ds_read_b128 v[36:39], v1 offset:2048
    ds_read_b128 v[40:43], v1 offset:3072
    s_waitcnt vmcnt(5) lgkmcnt(3)
    v_mfma_f32_32x32x16_bf16 v[116:131], v[28:31], v[52:55], 0
    ds_read_b128 v[44:47], v1 offset:4096
    buffer_load_dwordx4 v[96:99], v1, s[4:7], s45 offen offset:3072 sc1
    s_add_u32 s45, s45, 4096
    s_waitcnt lgkmcnt(3)
    v_mfma_f32_32x32x16_bf16 v[132:147], v[32:35], v[52:55], 0
    buffer_load_dwordx4 v[64:67], v1, s[4:7], s44 offen offset:3072 sc1
    s_add_u32 s44, s44, 4096
    s_waitcnt vmcnt(6)
    v_mfma_f32_32x32x16_bf16 v[148:163], v[28:31], v[84:87], 0
    ds_read_b128 v[48:51], v1 offset:5120
    buffer_load_dwordx4 v[68:71], v1, s[4:7], s44 offen offset:0 sc1
    v_mfma_f32_32x32x16_bf16 v[164:179], v[32:35], v[84:87], 0
    buffer_load_dwordx4 v[100:103], v1, s[4:7], s45 offen offset:0 sc1
    s_waitcnt vmcnt(7) lgkmcnt(3)
    v_mfma_f32_32x32x16_bf16 v[116:131], v[36:39], v[56:59], v[116:131]
    ds_read_b128 v[28:31], v1 offset:6144
    buffer_load_dwordx4 v[104:107], v1, s[4:7], s45 offen offset:1024 sc1
    s_waitcnt lgkmcnt(3)
    v_mfma_f32_32x32x16_bf16 v[132:147], v[40:43], v[56:59], v[132:147]
    buffer_load_dwordx4 v[72:75], v1, s[4:7], s44 offen offset:1024 sc1
    s_waitcnt vmcnt(8)
    v_mfma_f32_32x32x16_bf16 v[148:163], v[36:39], v[88:91], v[148:163]
    ds_read_b128 v[32:35], v1 offset:7168
    buffer_load_dwordx4 v[76:79], v1, s[4:7], s44 offen offset:2048 sc1
    v_mfma_f32_32x32x16_bf16 v[164:179], v[40:43], v[88:91], v[164:179]
    buffer_load_dwordx4 v[108:111], v1, s[4:7], s45 offen offset:2048 sc1
    s_waitcnt vmcnt(9) lgkmcnt(3)
    v_mfma_f32_32x32x16_bf16 v[116:131], v[44:47], v[60:63], v[116:131]
    ds_read_b128 v[36:39], v1 offset:8192
    v_pk_add_f32 v[12:13], v[12:13], v[14:15]
    buffer_load_dwordx4 v[112:115], v1, s[4:7], s45 offen offset:3072 sc1
    s_add_u32 s45, s45, 4096
    s_waitcnt lgkmcnt(3)
    v_mfma_f32_32x32x16_bf16 v[132:147], v[48:51], v[60:63], v[132:147]
    buffer_load_dwordx4 v[80:83], v1, s[4:7], s44 offen offset:3072 sc1
    s_add_u32 s44, s44, 4096
    v_pk_add_f32 v[16:17], v[16:17], v[18:19]
    s_waitcnt vmcnt(10)
    v_mfma_f32_32x32x16_bf16 v[148:163], v[44:47], v[92:95], v[148:163]
    ds_read_b128 v[40:43], v1 offset:9216
    v_pk_add_f32 v[12:13], v[12:13], v[16:17]
    buffer_load_dwordx4 v[52:55], v1, s[4:7], s44 offen offset:0 sc1
    v_mfma_f32_32x32x16_bf16 v[164:179], v[48:51], v[92:95], v[164:179]
    buffer_load_dwordx4 v[84:87], v1, s[4:7], s45 offen offset:0 sc1
    v_mov_b32 v14, v12
    s_waitcnt vmcnt(10) lgkmcnt(3)
    v_mfma_f32_32x32x16_bf16 v[116:131], v[28:31], v[64:67], v[116:131]
    ds_read_b128 v[44:47], v1 offset:10240
    v_mov_b32 v15, v13
    buffer_load_dwordx4 v[88:91], v1, s[4:7], s45 offen offset:1024 sc1
    s_waitcnt lgkmcnt(3)
    v_mfma_f32_32x32x16_bf16 v[132:147], v[32:35], v[64:67], v[132:147]
    buffer_load_dwordx4 v[56:59], v1, s[4:7], s44 offen offset:1024 sc1
    v_permlane32_swap_b32 v12, v14
    v_mfma_f32_32x32x16_bf16 v[148:163], v[28:31], v[96:99], v[148:163]
    ds_read_b128 v[48:51], v1 offset:11264
    v_permlane32_swap_b32 v13, v15
    buffer_load_dwordx4 v[60:63], v1, s[4:7], s44 offen offset:2048 sc1
    v_mfma_f32_32x32x16_bf16 v[164:179], v[32:35], v[96:99], v[164:179]
    buffer_load_dwordx4 v[92:95], v1, s[4:7], s45 offen offset:2048 sc1
    v_pk_add_f32 v[12:13], v[12:13], v[14:15]
    s_waitcnt vmcnt(13) lgkmcnt(3)
    v_mfma_f32_32x32x16_bf16 v[116:131], v[36:39], v[68:71], v[116:131]
    ds_read_b128 v[28:31], v1 offset:12288
    v_mul_f32 v12, 0x3acccccd, v12
    buffer_load_dwordx4 v[96:99], v1, s[4:7], s45 offen offset:3072 sc1
    s_add_u32 s45, s45, 4096
    s_waitcnt lgkmcnt(3)
    v_mfma_f32_32x32x16_bf16 v[132:147], v[40:43], v[68:71], v[132:147]
    buffer_load_dwordx4 v[64:67], v1, s[4:7], s44 offen offset:3072 sc1
    s_add_u32 s44, s44, 4096
    v_mul_f32 v13, 0xbacccccd, v13
    s_waitcnt vmcnt(14)
    v_mfma_f32_32x32x16_bf16 v[148:163], v[36:39], v[100:103], v[148:163]
    ds_read_b128 v[32:35], v1 offset:13312
    v_fma_f32 v13, -v12, v12, v13
    buffer_load_dwordx4 v[68:71], v1, s[4:7], s44 offen offset:0 sc1
    v_mfma_f32_32x32x16_bf16 v[164:179], v[40:43], v[100:103], v[164:179]
    buffer_load_dwordx4 v[100:103], v1, s[4:7], s45 offen offset:0 sc1
    v_max_f32 v13, 0, v13
    s_waitcnt vmcnt(14) lgkmcnt(3)
    v_mfma_f32_32x32x16_bf16 v[116:131], v[44:47], v[72:75], v[116:131]
    ds_read_b128 v[36:39], v1 offset:14336
    v_cvt_pk_bf16_f32 v13, v13, v13
    s_waitcnt lgkmcnt(3)
    v_mfma_f32_32x32x16_bf16 v[132:147], v[48:51], v[72:75], v[132:147]
    buffer_load_dwordx4 v[72:75], v1, s[4:7], s44 offen offset:1024 sc1
    v_and_b32 v13, 0xffff0000, v13
    v_mfma_f32_32x32x16_bf16 v[148:163], v[44:47], v[104:107], v[148:163]
    ds_read_b128 v[40:43], v1 offset:15360
    v_add_f32 v13, 0x3727c5ac, v13
    v_mfma_f32_32x32x16_bf16 v[164:179], v[48:51], v[104:107], v[164:179]
    buffer_load_dwordx4 v[104:107], v1, s[4:7], s45 offen offset:1024 sc1
    v_cvt_pk_bf16_f32 v13, v13, v13
    s_waitcnt vmcnt(15) lgkmcnt(3)
    v_mfma_f32_32x32x16_bf16 v[116:131], v[28:31], v[76:79], v[116:131]
    s_cmp_eq_u32 s39, 0
    s_cbranch_scc1 q0_20
q1_21:
    ds_read_b128 v[44:47], v1 offset:16384
    v_and_b32 v13, 0xffff0000, v13
    s_waitcnt lgkmcnt(3)
    v_mfma_f32_32x32x16_bf16 v[132:147], v[32:35], v[76:79], v[132:147]
    buffer_load_dwordx4 v[76:79], v1, s[4:7], s44 offen offset:2048 sc1
    v_sqrt_f32 v13, v13
    s_waitcnt vmcnt(15)
    v_mfma_f32_32x32x16_bf16 v[148:163], v[28:31], v[108:111], v[148:163]
    ds_read_b128 v[48:51], v1 offset:17408
    v_cvt_pk_bf16_f32 v4, v12, v12
    v_mfma_f32_32x32x16_bf16 v[164:179], v[32:35], v[108:111], v[164:179]
    buffer_load_dwordx4 v[108:111], v1, s[4:7], s45 offen offset:2048 sc1
    v_cvt_pk_bf16_f32 v5, v12, v13
    s_waitcnt vmcnt(14) lgkmcnt(3)
    v_mfma_f32_32x32x16_bf16 v[116:131], v[36:39], v[80:83], v[116:131]
    ds_read_b128 v[28:31], v1 offset:18432
    v_mov_b32 v6, 0
    s_waitcnt lgkmcnt(3)
    v_mfma_f32_32x32x16_bf16 v[132:147], v[40:43], v[80:83], v[132:147]
    buffer_load_dwordx4 v[80:83], v1, s[4:7], s44 offen offset:3072 sc1
    s_add_u32 s44, s44, 4096
    v_mov_b32 v7, 0
    v_mfma_f32_32x32x16_bf16 v[148:163], v[36:39], v[112:115], v[148:163]
    ds_read_b128 v[32:35], v1 offset:19456
    v_and_b32 v13, 0xffff0000, v5
    v_mfma_f32_32x32x16_bf16 v[164:179], v[40:43], v[112:115], v[164:179]
    buffer_load_dwordx4 v[112:115], v1, s[4:7], s45 offen offset:3072 sc1
    s_add_u32 s45, s45, 4096
    v_rcp_f32 v14, v13
    s_waitcnt vmcnt(15) lgkmcnt(3)
    v_mfma_f32_32x32x16_bf16 v[116:131], v[44:47], v[52:55], v[116:131]
    ds_read_b128 v[36:39], v1 offset:20480
    v_mov_b32 v15, v14
    s_waitcnt lgkmcnt(3)
    v_mfma_f32_32x32x16_bf16 v[132:147], v[48:51], v[52:55], v[132:147]
    buffer_load_dwordx4 v[52:55], v1, s[4:7], s44 offen offset:0 sc1
    v_mul_f32 v16, 0x3ea52b5c, v14
    s_waitcnt vmcnt(15)
    v_mfma_f32_32x32x16_bf16 v[148:163], v[44:47], v[84:87], v[148:163]
    ds_read_b128 v[40:43], v1 offset:21504
    v_mov_b32 v17, v16
    v_mfma_f32_32x32x16_bf16 v[164:179], v[48:51], v[84:87], v[164:179]
    buffer_load_dwordx4 v[84:87], v1, s[4:7], s45 offen offset:0 sc1
    v_cndmask_b32 v18, v14, v16, s[32:33]
    s_waitcnt vmcnt(14) lgkmcnt(3)
    v_mfma_f32_32x32x16_bf16 v[116:131], v[28:31], v[56:59], v[116:131]
    ds_read_b128 v[44:47], v1 offset:22528
    v_mov_b32 v19, v18
    s_waitcnt lgkmcnt(3)
    v_mfma_f32_32x32x16_bf16 v[132:147], v[32:35], v[56:59], v[132:147]
    buffer_load_dwordx4 v[56:59], v1, s[4:7], s44 offen offset:1024 sc1
    v_pk_add_f32 v[20:21], v[20:21], v[22:23]
    v_mfma_f32_32x32x16_bf16 v[148:163], v[28:31], v[88:91], v[148:163]
    ds_read_b128 v[48:51], v1 offset:23552
    v_pk_add_f32 v[24:25], v[24:25], v[26:27]
    v_mfma_f32_32x32x16_bf16 v[164:179], v[32:35], v[88:91], v[164:179]
    buffer_load_dwordx4 v[88:91], v1, s[4:7], s45 offen offset:1024 sc1
    v_pk_add_f32 v[20:21], v[20:21], v[24:25]
    s_waitcnt vmcnt(15) lgkmcnt(3)
    v_mfma_f32_32x32x16_bf16 v[116:131], v[36:39], v[60:63], v[116:131]
    s_cmp_eq_u32 s39, 0
    s_cbranch_scc1 q0_22
q1_23:
    ds_read_b128 v[28:31], v1 offset:24576
    v_mov_b32 v22, v20
    s_waitcnt lgkmcnt(3)
    v_mfma_f32_32x32x16_bf16 v[132:147], v[40:43], v[60:63], v[132:147]
    buffer_load_dwordx4 v[60:63], v1, s[4:7], s44 offen offset:2048 sc1
    v_mov_b32 v23, v21
    s_waitcnt vmcnt(15)
    v_mfma_f32_32x32x16_bf16 v[148:163], v[36:39], v[92:95], v[148:163]
    ds_read_b128 v[32:35], v1 offset:25600
    v_permlane32_swap_b32 v20, v22
    v_mfma_f32_32x32x16_bf16 v[164:179], v[40:43], v[92:95], v[164:179]
    buffer_load_dwordx4 v[92:95], v1, s[4:7], s45 offen offset:2048 sc1
    v_permlane32_swap_b32 v21, v23
    s_waitcnt vmcnt(14) lgkmcnt(3)
    v_mfma_f32_32x32x16_bf16 v[116:131], v[44:47], v[64:67], v[116:131]
    ds_read_b128 v[36:39], v1 offset:26624
    v_pk_add_f32 v[20:21], v[20:21], v[22:23]
    s_waitcnt lgkmcnt(3)
    v_mfma_f32_32x32x16_bf16 v[132:147], v[48:51], v[64:67], v[132:147]
    buffer_load_dwordx4 v[64:67], v1, s[4:7], s44 offen offset:3072 sc1
    s_add_u32 s44, s44, 4096
    v_mul_f32 v20, 0x3acccccd, v20
    v_mfma_f32_32x32x16_bf16 v[148:163], v[44:47], v[96:99], v[148:163]
    ds_read_b128 v[40:43], v1 offset:27648
    v_mul_f32 v21, 0xbacccccd, v21
    v_mfma_f32_32x32x16_bf16 v[164:179], v[48:51], v[96:99], v[164:179]
    buffer_load_dwordx4 v[96:99], v1, s[4:7], s45 offen offset:3072 sc1
    s_add_u32 s45, s45, 4096
    v_fma_f32 v21, -v20, v20, v21
    s_waitcnt vmcnt(15) lgkmcnt(3)
    v_mfma_f32_32x32x16_bf16 v[116:131], v[28:31], v[68:71], v[116:131]
    ds_read_b128 v[44:47], v1 offset:28672
    v_max_f32 v21, 0, v21
    s_waitcnt lgkmcnt(3)
    v_mfma_f32_32x32x16_bf16 v[132:147], v[32:35], v[68:71], v[132:147]
    buffer_load_dwordx4 v[68:71], v1, s[4:7], s44 offen offset:0 sc1
    v_cvt_pk_bf16_f32 v21, v21, v21
    s_waitcnt vmcnt(15)
    v_mfma_f32_32x32x16_bf16 v[148:163], v[28:31], v[100:103], v[148:163]
    ds_read_b128 v[48:51], v1 offset:29696
    v_and_b32 v21, 0xffff0000, v21
    v_mfma_f32_32x32x16_bf16 v[164:179], v[32:35], v[100:103], v[164:179]
    buffer_load_dwordx4 v[100:103], v1, s[4:7], s45 offen offset:0 sc1
    v_add_f32 v21, 0x3727c5ac, v21
    s_waitcnt vmcnt(15) lgkmcnt(3)
    v_mfma_f32_32x32x16_bf16 v[116:131], v[36:39], v[72:75], v[116:131]
    ds_read_b128 v[28:31], v1 offset:30720
    v_cvt_pk_bf16_f32 v21, v21, v21
    s_waitcnt lgkmcnt(3)
    v_mfma_f32_32x32x16_bf16 v[132:147], v[40:43], v[72:75], v[132:147]
    buffer_load_dwordx4 v[72:75], v1, s[4:7], s44 offen offset:1024 sc1
    v_and_b32 v21, 0xffff0000, v21
    s_waitcnt vmcnt(15)
    v_mfma_f32_32x32x16_bf16 v[148:163], v[36:39], v[104:107], v[148:163]
    ds_read_b128 v[32:35], v1 offset:31744
    v_sqrt_f32 v21, v21
    v_mfma_f32_32x32x16_bf16 v[164:179], v[40:43], v[104:107], v[164:179]
    buffer_load_dwordx4 v[104:107], v1, s[4:7], s45 offen offset:1024 sc1
    v_cvt_pk_bf16_f32 v8, v20, v20
    s_waitcnt vmcnt(15) lgkmcnt(3)
    v_mfma_f32_32x32x16_bf16 v[116:131], v[44:47], v[76:79], v[116:131]
    s_cmp_eq_u32 s39, 0
    s_cbranch_scc1 q0_24
q1_25:
    ds_read_b128 v[36:39], v1 offset:32768
    v_cvt_pk_bf16_f32 v9, v20, v21
    s_waitcnt lgkmcnt(3)
    v_mfma_f32_32x32x16_bf16 v[132:147], v[48:51], v[76:79], v[132:147]
    buffer_load_dwordx4 v[76:79], v1, s[4:7], s44 offen offset:2048 sc1
    v_mov_b32 v10, 0
    s_waitcnt vmcnt(15)
    v_mfma_f32_32x32x16_bf16 v[148:163], v[44:47], v[108:111], v[148:163]
    ds_read_b128 v[40:43], v1 offset:33792
    v_mov_b32 v11, 0
    v_mfma_f32_32x32x16_bf16 v[164:179], v[48:51], v[108:111], v[164:179]
    buffer_load_dwordx4 v[108:111], v1, s[4:7], s45 offen offset:2048 sc1
    v_and_b32 v21, 0xffff0000, v9
    s_waitcnt vmcnt(15) lgkmcnt(3)
    v_mfma_f32_32x32x16_bf16 v[116:131], v[28:31], v[80:83], v[116:131]
    ds_read_b128 v[44:47], v1 offset:34816
    v_rcp_f32 v22, v21
    s_waitcnt lgkmcnt(3)
    v_mfma_f32_32x32x16_bf16 v[132:147], v[32:35], v[80:83], v[132:147]
    buffer_load_dwordx4 v[80:83], v1, s[4:7], s44 offen offset:3072 sc1
    s_add_u32 s44, s44, 4096
    v_mov_b32 v23, v22
    s_waitcnt vmcnt(15)
    v_mfma_f32_32x32x16_bf16 v[148:163], v[28:31], v[112:115], v[148:163]
    ds_read_b128 v[48:51], v1 offset:35840
    v_mul_f32 v24, 0x3ea52b5c, v22
    v_mfma_f32_32x32x16_bf16 v[164:179], v[32:35], v[112:115], v[164:179]
    buffer_load_dwordx4 v[112:115], v1, s[4:7], s45 offen offset:3072 sc1
    s_add_u32 s45, s45, 4096
    v_mov_b32 v25, v24
    s_waitcnt vmcnt(15) lgkmcnt(3)
    v_mfma_f32_32x32x16_bf16 v[116:131], v[36:39], v[52:55], v[116:131]
    ds_read_b128 v[28:31], v1 offset:36864
    v_cndmask_b32 v26, v22, v24, s[32:33]
    s_waitcnt lgkmcnt(3)
    v_mfma_f32_32x32x16_bf16 v[132:147], v[40:43], v[52:55], v[132:147]
    buffer_load_dwordx4 v[52:55], v1, s[4:7], s44 offen offset:0 sc1
    v_mov_b32 v27, v26
    s_waitcnt vmcnt(15)
    v_mfma_f32_32x32x16_bf16 v[148:163], v[36:39], v[84:87], v[148:163]
    ds_read_b128 v[32:35], v1 offset:37888
    v_lshrrev_b32 v213, 5, v0
    v_mfma_f32_32x32x16_bf16 v[164:179], v[40:43], v[84:87], v[164:179]
    buffer_load_dwordx4 v[84:87], v1, s[4:7], s45 offen offset:0 sc1
    v_and_b32 v214, 31, v0
    s_waitcnt vmcnt(15) lgkmcnt(3)
    v_mfma_f32_32x32x16_bf16 v[116:131], v[44:47], v[56:59], v[116:131]
    ds_read_b128 v[36:39], v1 offset:38912
    v_lshlrev_b32 v213, 2, v213
    s_waitcnt lgkmcnt(3)
    v_mfma_f32_32x32x16_bf16 v[132:147], v[48:51], v[56:59], v[132:147]
    buffer_load_dwordx4 v[56:59], v1, s[4:7], s44 offen offset:1024 sc1
    v_sub_u32 v213, v214, v213
    s_waitcnt vmcnt(15)
    v_mfma_f32_32x32x16_bf16 v[148:163], v[44:47], v[88:91], v[148:163]
    ds_read_b128 v[40:43], v1 offset:39936
    v_mov_b32 v214, 0xff800000
    v_mfma_f32_32x32x16_bf16 v[164:179], v[48:51], v[88:91], v[164:179]
    buffer_load_dwordx4 v[88:91], v1, s[4:7], s45 offen offset:1024 sc1
    v_cmp_le_i32 vcc, 0, v213
    s_waitcnt vmcnt(15) lgkmcnt(3)
    v_mfma_f32_32x32x16_bf16 v[116:131], v[28:31], v[60:63], v[116:131]
    s_cmp_eq_u32 s39, 0
    s_cbranch_scc1 q0_26
q1_27:
    ds_read_b128 v[44:47], v212 offset:0
    v_cndmask_b32 v180, v214, 0, vcc
    s_waitcnt lgkmcnt(3)
    v_mfma_f32_32x32x16_bf16 v[132:147], v[32:35], v[60:63], v[132:147]
    buffer_load_dwordx4 v[60:63], v1, s[4:7], s44 offen offset:2048 sc1
    v_cndmask_b32 v196, 0, v214, vcc
    s_waitcnt vmcnt(15)
    v_mfma_f32_32x32x16_bf16 v[148:163], v[28:31], v[92:95], v[148:163]
    ds_read_b128 v[48:51], v212 offset:1024
    v_cmp_le_i32 vcc, 1, v213
    v_mfma_f32_32x32x16_bf16 v[164:179], v[32:35], v[92:95], v[164:179]
    buffer_load_dwordx4 v[92:95], v1, s[4:7], s45 offen offset:2048 sc1
    v_cndmask_b32 v181, v214, 0, vcc
    s_waitcnt vmcnt(15) lgkmcnt(3)
    v_mfma_f32_32x32x16_bf16 v[116:131], v[36:39], v[64:67], v[116:131]
    ds_read_b128 v[28:31], v212 offset:2048
    v_cndmask_b32 v197, 0, v214, vcc
    s_waitcnt lgkmcnt(3)
    v_mfma_f32_32x32x16_bf16 v[132:147], v[40:43], v[64:67], v[132:147]
    buffer_load_dwordx4 v[64:67], v1, s[4:7], s44 offen offset:3072 sc1
    s_add_u32 s44, s44, 4096
    v_cmp_le_i32 vcc, 2, v213
    s_waitcnt vmcnt(15)
    v_mfma_f32_32x32x16_bf16 v[148:163], v[36:39], v[96:99], v[148:163]
    ds_read_b128 v[32:35], v212 offset:3072
    v_cndmask_b32 v182, v214, 0, vcc
    v_mfma_f32_32x32x16_bf16 v[164:179], v[40:43], v[96:99], v[164:179]
    buffer_load_dwordx4 v[96:99], v1, s[4:7], s45 offen offset:3072 sc1
    s_add_u32 s45, s45, 4096
    v_cndmask_b32 v198, 0, v214, vcc
    s_waitcnt vmcnt(15) lgkmcnt(3)
    v_mfma_f32_32x32x16_bf16 v[116:131], v[44:47], v[68:71], v[116:131]
    ds_read_b128 v[36:39], v212 offset:4096
    v_cmp_le_i32 vcc, 3, v213
    s_waitcnt lgkmcnt(3)
    v_mfma_f32_32x32x16_bf16 v[132:147], v[48:51], v[68:71], v[132:147]
    buffer_load_dwordx4 v[68:71], v1, s[4:7], s44 offen offset:0 sc1
    v_cndmask_b32 v183, v214, 0, vcc
    s_waitcnt vmcnt(15)
    v_mfma_f32_32x32x16_bf16 v[148:163], v[44:47], v[100:103], v[148:163]
    ds_read_b128 v[40:43], v212 offset:5120
    v_cndmask_b32 v199, 0, v214, vcc
    v_mfma_f32_32x32x16_bf16 v[164:179], v[48:51], v[100:103], v[164:179]
    buffer_load_dwordx4 v[100:103], v1, s[4:7], s45 offen offset:0 sc1
    v_cmp_le_i32 vcc, 8, v213
    s_waitcnt vmcnt(15) lgkmcnt(3)
    v_mfma_f32_32x32x16_bf16 v[116:131], v[28:31], v[72:75], v[116:131]
    ds_read_b128 v[44:47], v212 offset:6144
    v_cndmask_b32 v184, v214, 0, vcc
    s_waitcnt lgkmcnt(3)
    v_mfma_f32_32x32x16_bf16 v[132:147], v[32:35], v[72:75], v[132:147]
    buffer_load_dwordx4 v[72:75], v1, s[4:7], s44 offen offset:1024 sc1
    v_cndmask_b32 v200, 0, v214, vcc
    s_waitcnt vmcnt(15)
    v_mfma_f32_32x32x16_bf16 v[148:163], v[28:31], v[104:107], v[148:163]
    ds_read_b128 v[48:51], v212 offset:7168
    v_cmp_le_i32 vcc, 9, v213
    v_mfma_f32_32x32x16_bf16 v[164:179], v[32:35], v[104:107], v[164:179]
    buffer_load_dwordx4 v[104:107], v1, s[4:7], s45 offen offset:1024 sc1
    v_cndmask_b32 v185, v214, 0, vcc
    s_waitcnt vmcnt(15) lgkmcnt(3)
    v_mfma_f32_32x32x16_bf16 v[116:131], v[36:39], v[76:79], v[116:131]
    s_cmp_eq_u32 s39, 0
    s_cbranch_scc1 q0_28
q1_29:
    ds_read_b128 v[28:31], v212 offset:8192
    v_cndmask_b32 v201, 0, v214, vcc
    s_waitcnt lgkmcnt(3)
    v_mfma_f32_32x32x16_bf16 v[132:147], v[40:43], v[76:79], v[132:147]
    buffer_load_dwordx4 v[76:79], v1, s[4:7], s44 offen offset:2048 sc1
    v_cmp_le_i32 vcc, 10, v213
    s_waitcnt vmcnt(15)
    v_mfma_f32_32x32x16_bf16 v[148:163], v[36:39], v[108:111], v[148:163]
    ds_read_b128 v[32:35], v212 offset:9216
    v_cndmask_b32 v186, v214, 0, vcc
    v_mfma_f32_32x32x16_bf16 v[164:179], v[40:43], v[108:111], v[164:179]
    buffer_load_dwordx4 v[108:111], v1, s[4:7], s45 offen offset:2048 sc1
    v_cndmask_b32 v202, 0, v214, vcc
    s_waitcnt vmcnt(15) lgkmcnt(3)
    v_mfma_f32_32x32x16_bf16 v[116:131], v[44:47], v[80:83], v[116:131]
    ds_read_b128 v[36:39], v212 offset:10240
    v_cmp_le_i32 vcc, 11, v213
    s_waitcnt lgkmcnt(3)
    v_mfma_f32_32x32x16_bf16 v[132:147], v[48:51], v[80:83], v[132:147]
    buffer_load_dwordx4 v[80:83], v1, s[4:7], s44 offen offset:3072 sc1
    s_add_u32 s44, s44, 4096
    v_cndmask_b32 v187, v214, 0, vcc
    s_waitcnt vmcnt(15)
    v_mfma_f32_32x32x16_bf16 v[148:163], v[44:47], v[112:115], v[148:163]
    ds_read_b128 v[40:43], v212 offset:11264
    v_cndmask_b32 v203, 0, v214, vcc
    v_mfma_f32_32x32x16_bf16 v[164:179], v[48:51], v[112:115], v[164:179]
    buffer_load_dwordx4 v[112:115], v1, s[4:7], s45 offen offset:3072 sc1
    s_add_u32 s45, s45, 4096
    v_cmp_le_i32 vcc, 16, v213
    s_waitcnt vmcnt(15) lgkmcnt(3)
    v_mfma_f32_32x32x16_bf16 v[116:131], v[28:31], v[52:55], v[116:131]
    ds_read_b128 v[44:47], v212 offset:12288
    v_cndmask_b32 v188, v214, 0, vcc
    s_waitcnt lgkmcnt(3)
    v_mfma_f32_32x32x16_bf16 v[132:147], v[32:35], v[52:55], v[132:147]
    buffer_load_dwordx4 v[52:55], v1, s[4:7], s44 offen offset:0 sc1
    v_cndmask_b32 v204, 0, v214, vcc
    s_waitcnt vmcnt(15)
    v_mfma_f32_32x32x16_bf16 v[148:163], v[28:31], v[84:87], v[148:163]
    ds_read_b128 v[48:51], v212 offset:13312
    v_cmp_le_i32 vcc, 17, v213
    v_mfma_f32_32x32x16_bf16 v[164:179], v[32:35], v[84:87], v[164:179]
    buffer_load_dwordx4 v[84:87], v1, s[4:7], s45 offen offset:0 sc1
    v_cndmask_b32 v189, v214, 0, vcc
    s_waitcnt vmcnt(15) lgkmcnt(3)
    v_mfma_f32_32x32x16_bf16 v[116:131], v[36:39], v[56:59], v[116:131]
    ds_read_b128 v[28:31], v212 offset:14336
    v_cndmask_b32 v205, 0, v214, vcc
    s_waitcnt lgkmcnt(3)
    v_mfma_f32_32x32x16_bf16 v[132:147], v[40:43], v[56:59], v[132:147]
    buffer_load_dwordx4 v[56:59], v1, s[4:7], s44 offen offset:1024 sc1
    v_cmp_le_i32 vcc, 18, v213
    s_waitcnt vmcnt(15)
    v_mfma_f32_32x32x16_bf16 v[148:163], v[36:39], v[88:91], v[148:163]
    ds_read_b128 v[32:35], v212 offset:15360
    v_cndmask_b32 v190, v214, 0, vcc
    v_mfma_f32_32x32x16_bf16 v[164:179], v[40:43], v[88:91], v[164:179]
    buffer_load_dwordx4 v[88:91], v1, s[4:7], s45 offen offset:1024 sc1
    v_cndmask_b32 v206, 0, v214, vcc
    s_waitcnt vmcnt(15) lgkmcnt(3)
    v_mfma_f32_32x32x16_bf16 v[116:131], v[44:47], v[60:63], v[116:131]
    s_cmp_eq_u32 s39, 0
    s_cbranch_scc1 q0_30
q1_31:
    ds_read_b128 v[36:39], v212 offset:16384
    v_cmp_le_i32 vcc, 19, v213
    s_waitcnt lgkmcnt(3)
    v_mfma_f32_32x32x16_bf16 v[132:147], v[48:51], v[60:63], v[132:147]
    buffer_load_dwordx4 v[60:63], v1, s[4:7], s44 offen offset:2048 sc1
    v_cndmask_b32 v191, v214, 0, vcc
    s_waitcnt vmcnt(15)
    v_mfma_f32_32x32x16_bf16 v[148:163], v[44:47], v[92:95], v[148:163]
    ds_read_b128 v[40:43], v212 offset:17408
    v_cndmask_b32 v207, 0, v214, vcc
    v_mfma_f32_32x32x16_bf16 v[164:179], v[48:51], v[92:95], v[164:179]
    buffer_load_dwordx4 v[92:95], v1, s[4:7], s45 offen offset:2048 sc1
    v_cmp_le_i32 vcc, 24, v213
    s_waitcnt vmcnt(15) lgkmcnt(3)
    v_mfma_f32_32x32x16_bf16 v[116:131], v[28:31], v[64:67], v[116:131]
    ds_read_b128 v[44:47], v212 offset:18432
    v_cndmask_b32 v192, v214, 0, vcc
    s_waitcnt lgkmcnt(3)
    v_mfma_f32_32x32x16_bf16 v[132:147], v[32:35], v[64:67], v[132:147]
    buffer_load_dwordx4 v[64:67], v1, s[4:7], s44 offen offset:3072 sc1
    s_add_u32 s44, s44, 4096
    v_cndmask_b32 v208, 0, v214, vcc
    s_waitcnt vmcnt(15)
    v_mfma_f32_32x32x16_bf16 v[148:163], v[28:31], v[96:99], v[148:163]
    ds_read_b128 v[48:51], v212 offset:19456
    v_cmp_le_i32 vcc, 25, v213
    v_mfma_f32_32x32x16_bf16 v[164:179], v[32:35], v[96:99], v[164:179]
    buffer_load_dwordx4 v[96:99], v1, s[4:7], s45 offen offset:3072 sc1
    s_add_u32 s45, s45, 4096
    v_cndmask_b32 v193, v214, 0, vcc
    s_waitcnt vmcnt(15) lgkmcnt(3)
    v_mfma_f32_32x32x16_bf16 v[116:131], v[36:39], v[68:71], v[116:131]
    ds_read_b128 v[28:31], v212 offset:20480
    v_cndmask_b32 v209, 0, v214, vcc
    s_waitcnt lgkmcnt(3)
    v_mfma_f32_32x32x16_bf16 v[132:147], v[40:43], v[68:71], v[132:147]
    buffer_load_dwordx4 v[68:71], v1, s[4:7], s44 offen offset:0 sc1
    v_cmp_le_i32 vcc, 26, v213
    s_waitcnt vmcnt(15)
    v_mfma_f32_32x32x16_bf16 v[148:163], v[36:39], v[100:103], v[148:163]
    ds_read_b128 v[32:35], v212 offset:21504
    v_cndmask_b32 v194, v214, 0, vcc
    v_mfma_f32_32x32x16_bf16 v[164:179], v[40:43], v[100:103], v[164:179]
    buffer_load_dwordx4 v[100:103], v1, s[4:7], s45 offen offset:0 sc1
    v_cndmask_b32 v210, 0, v214, vcc
    s_waitcnt vmcnt(15) lgkmcnt(3)
    v_mfma_f32_32x32x16_bf16 v[116:131], v[44:47], v[72:75], v[116:131]
    ds_read_b128 v[36:39], v212 offset:22528
    v_cmp_le_i32 vcc, 27, v213
    s_waitcnt lgkmcnt(3)
    v_mfma_f32_32x32x16_bf16 v[132:147], v[48:51], v[72:75], v[132:147]
    buffer_load_dwordx4 v[72:75], v1, s[4:7], s44 offen offset:1024 sc1
    v_cndmask_b32 v195, v214, 0, vcc
    s_waitcnt vmcnt(15)
    v_mfma_f32_32x32x16_bf16 v[148:163], v[44:47], v[104:107], v[148:163]
    ds_read_b128 v[40:43], v212 offset:23552
    v_cndmask_b32 v211, 0, v214, vcc
    v_mfma_f32_32x32x16_bf16 v[164:179], v[48:51], v[104:107], v[164:179]
    buffer_load_dwordx4 v[104:107], v1, s[4:7], s45 offen offset:1024 sc1
    s_waitcnt vmcnt(15) lgkmcnt(3)
    v_mfma_f32_32x32x16_bf16 v[116:131], v[28:31], v[76:79], v[116:131]
    s_cmp_eq_u32 s39, 0
    s_cbranch_scc1 q0_32
q1_33:
    ds_read_b128 v[44:47], v212 offset:24576
    s_waitcnt lgkmcnt(3)
    v_mfma_f32_32x32x16_bf16 v[132:147], v[32:35], v[76:79], v[132:147]
    buffer_load_dwordx4 v[76:79], v1, s[4:7], s44 offen offset:2048 sc1
    s_waitcnt vmcnt(15)
    v_mfma_f32_32x32x16_bf16 v[148:163], v[28:31], v[108:111], v[148:163]
    ds_read_b128 v[48:51], v212 offset:25600
    v_mfma_f32_32x32x16_bf16 v[164:179], v[32:35], v[108:111], v[164:179]
    buffer_load_dwordx4 v[108:111], v1, s[4:7], s45 offen offset:2048 sc1
    s_waitcnt vmcnt(15) lgkmcnt(3)
    v_mfma_f32_32x32x16_bf16 v[116:131], v[36:39], v[80:83], v[116:131]
    ds_read_b128 v[28:31], v212 offset:26624
    s_waitcnt lgkmcnt(3)
    v_mfma_f32_32x32x16_bf16 v[132:147], v[40:43], v[80:83], v[132:147]
    buffer_load_dwordx4 v[80:83], v1, s[4:7], s44 offen offset:3072 sc1
    s_add_u32 s44, s44, 4096
    s_waitcnt vmcnt(15)
    v_mfma_f32_32x32x16_bf16 v[148:163], v[36:39], v[112:115], v[148:163]
    ds_read_b128 v[32:35], v212 offset:27648
    v_mfma_f32_32x32x16_bf16 v[164:179], v[40:43], v[112:115], v[164:179]
    buffer_load_dwordx4 v[112:115], v1, s[4:7], s45 offen offset:3072 sc1
    s_add_u32 s45, s45, 4096
    s_waitcnt vmcnt(15) lgkmcnt(3)
    v_mfma_f32_32x32x16_bf16 v[116:131], v[44:47], v[52:55], v[116:131]
    ds_read_b128 v[36:39], v212 offset:28672
    s_waitcnt lgkmcnt(3)
    v_mfma_f32_32x32x16_bf16 v[132:147], v[48:51], v[52:55], v[132:147]
    s_waitcnt vmcnt(14)
    v_mfma_f32_32x32x16_bf16 v[148:163], v[44:47], v[84:87], v[148:163]
    ds_read_b128 v[40:43], v212 offset:29696
    v_mfma_f32_32x32x16_bf16 v[164:179], v[48:51], v[84:87], v[164:179]
    s_waitcnt vmcnt(13) lgkmcnt(3)
    v_mfma_f32_32x32x16_bf16 v[116:131], v[28:31], v[56:59], v[116:131]
    ds_read_b128 v[44:47], v212 offset:30720
    s_waitcnt lgkmcnt(3)
    v_mfma_f32_32x32x16_bf16 v[132:147], v[32:35], v[56:59], v[132:147]
    s_waitcnt vmcnt(12)
    v_mfma_f32_32x32x16_bf16 v[148:163], v[28:31], v[88:91], v[148:163]
    ds_read_b128 v[48:51], v212 offset:31744
    v_mfma_f32_32x32x16_bf16 v[164:179], v[32:35], v[88:91], v[164:179]
    s_barrier
    s_cmp_lg_u32 s39, 0
    s_cbranch_scc1 aq_34
    v_and_b32 v221, 31, v0
    v_lshlrev_b32 v221, 2, v221
    v_add_u32 v221, 160000, v221
    ds_read_b32 v225, v221 offset:0
    ds_read_b32 v226, v221 offset:256
    ds_read_b32 v227, v221 offset:512
    ds_read_b32 v228, v221 offset:768
    ds_read_b32 v215, v221 offset:128
    ds_read_b32 v216, v221 offset:384
    ds_read_b32 v217, v221 offset:640
    ds_read_b32 v218, v221 offset:896
    s_waitcnt lgkmcnt(6)
    v_add_f32 v225, v225, v226
    s_waitcnt lgkmcnt(4)
    v_add_f32 v227, v227, v228
    v_add_f32 v220, v225, v227
    s_waitcnt lgkmcnt(2)
    v_add_f32 v215, v215, v216
    s_waitcnt lgkmcnt(0)
    v_add_f32 v217, v217, v218
    v_add_f32 v222, v215, v217
    s_waitcnt lgkmcnt(0)
    v_sub_f32 v220, 0, v220
    v_cvt_pk_bf16_f32 v223, v220, v220
    v_and_b32 v223, 0xffff0000, v223
    v_sub_f32 v220, v220, v223
    v_cvt_pk_bf16_f32 v224, v220, v220
    v_and_b32 v224, 0xffff0000, v224
    v_sub_f32 v220, v220, v224
    v_cvt_pk_bf16_f32 v220, v220, v220
    v_and_b32 v220, 0xffff, v220
    v_lshrrev_b32 v223, 16, v223
    v_or_b32 v223, v223, v224
    v_cndmask_b32 v225, 0, v223, s[32:33]
    v_cndmask_b32 v226, 0, v220, s[32:33]
    v_sub_f32 v222, 0, v222
    v_cvt_pk_bf16_f32 v223, v222, v222
    v_and_b32 v223, 0xffff0000, v223
    v_sub_f32 v222, v222, v223
    v_cvt_pk_bf16_f32 v224, v222, v222
    v_and_b32 v224, 0xffff0000, v224
    v_sub_f32 v222, v222, v224
    v_cvt_pk_bf16_f32 v222, v222, v222
    v_and_b32 v222, 0xffff, v222
    v_lshrrev_b32 v223, 16, v223
    v_or_b32 v223, v223, v224
    v_cndmask_b32 v227, 0, v223, s[32:33]
    v_cndmask_b32 v228, 0, v222, s[32:33]
aq_34:
    s_nop 2
    s_waitcnt vmcnt(11) lgkmcnt(3)
    v_mfma_f32_32x32x16_bf16 v[116:131], v[36:39], v[60:63], v[116:131]
    s_cmp_eq_u32 s39, 0
    s_cbranch_scc1 q0_35
q1_36:
    ds_read_b128 v[28:31], v212 offset:32768
    s_waitcnt lgkmcnt(3)
    v_mfma_f32_32x32x16_bf16 v[132:147], v[40:43], v[60:63], v[132:147]
    s_waitcnt vmcnt(10)
    v_mfma_f32_32x32x16_bf16 v[148:163], v[36:39], v[92:95], v[148:163]
    ds_read_b128 v[32:35], v212 offset:33792
    v_mfma_f32_32x32x16_bf16 v[164:179], v[40:43], v[92:95], v[164:179]
    s_waitcnt vmcnt(9) lgkmcnt(3)
    v_mfma_f32_32x32x16_bf16 v[116:131], v[44:47], v[64:67], v[116:131]
    ds_read_b128 v[36:39], v212 offset:34816
    s_waitcnt lgkmcnt(3)
    v_mfma_f32_32x32x16_bf16 v[132:147], v[48:51], v[64:67], v[132:147]
    s_waitcnt vmcnt(8)
    v_mfma_f32_32x32x16_bf16 v[148:163], v[44:47], v[96:99], v[148:163]
    ds_read_b128 v[40:43], v212 offset:35840
    v_mfma_f32_32x32x16_bf16 v[164:179], v[48:51], v[96:99], v[164:179]
    s_waitcnt vmcnt(7) lgkmcnt(3)
    v_mfma_f32_32x32x16_bf16 v[116:131], v[28:31], v[68:71], v[116:131]
    ds_read_b128 v[44:47], v212 offset:36864
    s_waitcnt lgkmcnt(3)
    v_mfma_f32_32x32x16_bf16 v[132:147], v[32:35], v[68:71], v[132:147]
    s_waitcnt vmcnt(6)
    v_mfma_f32_32x32x16_bf16 v[148:163], v[28:31], v[100:103], v[148:163]
    ds_read_b128 v[48:51], v212 offset:37888
    v_mfma_f32_32x32x16_bf16 v[164:179], v[32:35], v[100:103], v[164:179]
    s_waitcnt vmcnt(5) lgkmcnt(3)
    v_mfma_f32_32x32x16_bf16 v[116:131], v[36:39], v[72:75], v[116:131]
    ds_read_b128 v[28:31], v212 offset:38912
    s_waitcnt lgkmcnt(3)
    v_mfma_f32_32x32x16_bf16 v[132:147], v[40:43], v[72:75], v[132:147]
    s_waitcnt vmcnt(4)
    v_mfma_f32_32x32x16_bf16 v[148:163], v[36:39], v[104:107], v[148:163]
    ds_read_b128 v[32:35], v212 offset:39936
    v_mfma_f32_32x32x16_bf16 v[164:179], v[40:43], v[104:107], v[164:179]
    v_mov_b32 v36, v225
    v_mov_b32 v37, v226
    v_mov_b32 v38, 0
    v_mov_b32 v39, 0
    v_mov_b32 v40, v227
    v_mov_b32 v41, v228
    v_mov_b32 v42, 0
    v_mov_b32 v43, 0
    s_mul_i32 s46, s27, 6144
    s_add_u32 s46, s46, s20
    s_add_u32 s48, s46, 3072
    s_lshl_b32 s47, s27, 7
    s_add_u32 s47, s47, s21
    s_add_u32 s47, s47, 278528
    v_mov_b32 v215, 0x3f803f80
    v_mov_b32 v216, s100
    v_mov_b32 v217, 0
    s_cmp_eq_u32 s16, 7
    s_cselect_b32 s40, 0x7fff0000, 0
    v_add_u32 v219, s40, v1
    s_waitcnt vmcnt(3) lgkmcnt(3)
    v_mfma_f32_32x32x16_bf16 v[116:131], v[44:47], v[76:79], v[116:131]
    s_waitcnt lgkmcnt(2)
    v_mfma_f32_32x32x16_bf16 v[132:147], v[48:51], v[76:79], v[132:147]
    s_waitcnt vmcnt(1) lgkmcnt(1)
    v_mfma_f32_32x32x16_bf16 v[116:131], v[28:31], v[80:83], v[116:131]
    s_waitcnt lgkmcnt(0)
    v_mfma_f32_32x32x16_bf16 v[132:147], v[32:35], v[80:83], v[132:147]
    v_mfma_f32_32x32x16_bf16 v[116:131], v[36:39], v[4:7], v[116:131]
    v_mfma_f32_32x32x16_bf16 v[132:147], v[40:43], v[4:7], v[132:147]
    v_mfma_f32_32x32x16_bf16 v[148:163], v[44:47], v[108:111], v[148:163]
    v_mfma_f32_32x32x16_bf16 v[164:179], v[48:51], v[108:111], v[164:179]
    s_nop 8
    v_pk_mul_f32 v[124:125], v[124:125], v[18:19]
    v_pk_mul_f32 v[126:127], v[126:127], v[18:19]
    v_pk_mul_f32 v[128:129], v[128:129], v[14:15]
    v_pk_mul_f32 v[130:131], v[130:131], v[14:15]
    v_cvt_pk_bf16_f32 v56, v124, v125
    v_cvt_pk_bf16_f32 v57, v126, v127
    s_waitcnt vmcnt(0)
    v_mfma_f32_32x32x16_bf16 v[148:163], v[28:31], v[112:115], v[148:163]
    v_cvt_pk_bf16_f32 v58, v128, v129
    v_cvt_pk_bf16_f32 v59, v130, v131
    buffer_store_dwordx4 v[56:59], v219, s[4:7], s46 offen sc1
    v_pk_mul_f32 v[132:133], v[132:133], v[14:15]
    v_pk_mul_f32 v[134:135], v[134:135], v[14:15]
    v_pk_mul_f32 v[136:137], v[136:137], v[14:15]
    v_mfma_f32_32x32x16_bf16 v[164:179], v[32:35], v[112:115], v[164:179]
    v_pk_mul_f32 v[138:139], v[138:139], v[14:15]
    v_cvt_pk_bf16_f32 v60, v132, v133
    v_cvt_pk_bf16_f32 v61, v134, v135
    v_cvt_pk_bf16_f32 v62, v136, v137
    v_cvt_pk_bf16_f32 v63, v138, v139
    buffer_store_dwordx4 v[60:63], v219, s[4:7], s46 offen offset:1024 sc1
    v_mfma_f32_32x32x16_bf16 v[148:163], v[36:39], v[8:11], v[148:163]
    v_pk_mul_f32 v[140:141], v[140:141], v[14:15]
    v_pk_mul_f32 v[142:143], v[142:143], v[14:15]
    v_pk_mul_f32 v[144:145], v[144:145], v[14:15]
    v_pk_mul_f32 v[146:147], v[146:147], v[14:15]
    v_cvt_pk_bf16_f32 v64, v140, v141
    v_cvt_pk_bf16_f32 v65, v142, v143
    v_mfma_f32_32x32x16_bf16 v[164:179], v[40:43], v[8:11], v[164:179]
    v_cvt_pk_bf16_f32 v66, v144, v145
    v_cvt_pk_bf16_f32 v67, v146, v147
    v_cndmask_b32 v66, v215, v66, s[32:33]
    v_cndmask_b32 v67, v215, v67, s[32:33]
    buffer_store_dwordx4 v[64:67], v219, s[4:7], s46 offen offset:2048 sc1
    v_pk_mul_f32 v[116:117], v[116:117], v[16:17]
    v_pk_mul_f32 v[118:119], v[118:119], v[16:17]
    v_pk_mul_f32 v[120:121], v[120:121], v[16:17]
    v_pk_mul_f32 v[122:123], v[122:123], v[16:17]
    v_cvt_pk_bf16_f32 v52, v116, v117
    v_cvt_pk_bf16_f32 v53, v118, v119
    v_cvt_pk_bf16_f32 v54, v120, v121
    v_cvt_pk_bf16_f32 v55, v122, v123
    v_pk_mul_f32 v[156:157], v[156:157], v[26:27]
    v_pk_mul_f32 v[158:159], v[158:159], v[26:27]
    v_pk_mul_f32 v[160:161], v[160:161], v[22:23]
    v_pk_mul_f32 v[162:163], v[162:163], v[22:23]
    v_cvt_pk_bf16_f32 v32, v156, v157
    v_cvt_pk_bf16_f32 v33, v158, v159
    v_cvt_pk_bf16_f32 v34, v160, v161
    v_cvt_pk_bf16_f32 v35, v162, v163
    buffer_store_dwordx4 v[32:35], v219, s[4:7], s48 offen sc1
    v_pk_mul_f32 v[164:165], v[164:165], v[22:23]
    v_pk_mul_f32 v[166:167], v[166:167], v[22:23]
    v_pk_mul_f32 v[168:169], v[168:169], v[22:23]
    v_pk_mul_f32 v[170:171], v[170:171], v[22:23]
    v_cvt_pk_bf16_f32 v36, v164, v165
    v_cvt_pk_bf16_f32 v37, v166, v167
    v_cvt_pk_bf16_f32 v38, v168, v169
    v_cvt_pk_bf16_f32 v39, v170, v171
    buffer_store_dwordx4 v[36:39], v219, s[4:7], s48 offen offset:1024 sc1
    v_pk_mul_f32 v[172:173], v[172:173], v[22:23]
    v_pk_mul_f32 v[174:175], v[174:175], v[22:23]
    v_pk_mul_f32 v[176:177], v[176:177], v[22:23]
    v_pk_mul_f32 v[178:179], v[178:179], v[22:23]
    v_cvt_pk_bf16_f32 v40, v172, v173
    v_cvt_pk_bf16_f32 v41, v174, v175
    v_cvt_pk_bf16_f32 v42, v176, v177
    v_cvt_pk_bf16_f32 v43, v178, v179
    v_cndmask_b32 v42, v215, v42, s[32:33]
    v_cndmask_b32 v43, v215, v43, s[32:33]
    buffer_store_dwordx4 v[40:43], v219, s[4:7], s48 offen offset:2048 sc1
    buffer_load_dword v218, v3, s[4:7], s63 offen sc1
    s_cmp_eq_u32 s26, 1
    s_cbranch_scc1 att1
    s_cmp_eq_u32 s26, 2
    s_cbranch_scc1 att2
    s_cmp_eq_u32 s26, 3
    s_cbranch_scc1 att3
    ds_write_b128 v236, v[60:63] offset:15360
    ds_write_b64 v238, v[56:57] offset:3840
    ds_write_b64 v239, v[58:59] offset:30720
    ds_write_b64 v240, v[64:65] offset:30720
    ds_write_b64 v241, v[66:67] offset:30720
    ds_write_b128 v236, v[36:39] offset:8192
    ds_write_b64 v238, v[32:33] offset:2048
    ds_write_b64 v239, v[34:35] offset:16384
    ds_write_b64 v240, v[40:41] offset:16384
    ds_write_b64 v241, v[42:43] offset:16384
    v_cndmask_b32 v44, 0, v56, s[32:33]
    v_cndmask_b32 v45, 0, v57, s[32:33]
    v_mov_b32 v46, 0
    v_mov_b32 v47, 0
    v_pk_mul_f32 v[148:149], v[148:149], v[24:25]
    v_pk_mul_f32 v[150:151], v[150:151], v[24:25]
    v_pk_mul_f32 v[152:153], v[152:153], v[24:25]
    v_pk_mul_f32 v[154:155], v[154:155], v[24:25]
    v_cvt_pk_bf16_f32 v28, v148, v149
    v_cvt_pk_bf16_f32 v29, v150, v151
    v_cvt_pk_bf16_f32 v30, v152, v153
    v_cvt_pk_bf16_f32 v31, v154, v155
    v_cndmask_b32 v48, 0, v32, s[32:33]
    v_cndmask_b32 v49, 0, v33, s[32:33]
    v_mov_b32 v50, 0
    v_mov_b32 v51, 0
    v_mov_b32 v106, 0x3f80
    v_mov_b32 v107, 0
    v_mov_b32 v114, 0x3f80
    v_mov_b32 v115, 0
    v_mfma_f32_32x32x16_bf16 v[68:83], v[60:63], v[52:55], v[180:195]
    v_mfma_f32_32x32x16_bf16 v[84:99], v[36:39], v[28:31], v[180:195]
    s_waitcnt lgkmcnt(0)
    ds_read_b64 v[104:105], v237 offset:3840
    ds_read_b64 v[112:113], v237 offset:2048
    ds_read_b64_tr_b16 v[148:149], v242 offset:30720
    ds_read_b64_tr_b16 v[150:151], v243 offset:31232
    ds_read_b64_tr_b16 v[152:153], v242 offset:31744
    ds_read_b64_tr_b16 v[154:155], v243 offset:32256
    s_waitcnt lgkmcnt(5)
    v_mfma_f32_32x32x16_bf16 v[68:83], v[104:107], v[44:47], v[68:83]
    s_waitcnt lgkmcnt(4)
    v_mfma_f32_32x32x16_bf16 v[84:99], v[112:115], v[48:51], v[84:99]
    s_lshl_b32 s40, s39, 5
    s_add_u32 s40, s40, 104448
    v_and_b32 v222, 3, v0
    v_lshl_add_u32 v222, v222, 2, s40
    s_waitcnt vmcnt(4)
    s_mov_b64 exec, 1
    buffer_store_dword v216, v217, s[4:7], s47 offen sc1
    s_mov_b64 exec, -1
    s_barrier
    s_nop 0
    v_max3_f32 v164, v68, v69, v70
    v_max3_f32 v165, v71, v72, v73
    v_max3_f32 v164, v164, v74, v75
    v_max3_f32 v165, v165, v76, v77
    v_max3_f32 v164, v164, v78, v79
    v_max3_f32 v165, v165, v80, v81
    v_max3_f32 v164, v164, v82, v83
    v_max_f32 v164, v164, v165
    v_mov_b32 v165, v164
    v_max3_f32 v168, v84, v85, v86
    v_max3_f32 v169, v87, v88, v89
    v_max3_f32 v168, v168, v90, v91
    v_max3_f32 v169, v169, v92, v93
    v_max3_f32 v168, v168, v94, v95
    v_max3_f32 v169, v169, v96, v97
    v_max3_f32 v168, v168, v98, v99
    v_max_f32 v168, v168, v169
    v_mov_b32 v169, v168
    v_permlane32_swap_b32 v164, v165
    s_nop 0
    v_permlane32_swap_b32 v168, v169
    v_max_f32 v164, v164, v165
    v_cvt_pk_bf16_f32 v164, -v164, 0
    v_cndmask_b32 v46, 0, v164, s[32:33]
    v_lshlrev_b32 v166, 16, v164
    v_mov_b32 v167, v166
    v_pk_add_f32 v[68:69], v[68:69], v[166:167]
    v_pk_add_f32 v[70:71], v[70:71], v[166:167]
    v_pk_add_f32 v[72:73], v[72:73], v[166:167]
    v_pk_add_f32 v[74:75], v[74:75], v[166:167]
    v_pk_add_f32 v[76:77], v[76:77], v[166:167]
    v_pk_add_f32 v[78:79], v[78:79], v[166:167]
    v_pk_add_f32 v[80:81], v[80:81], v[166:167]
    v_pk_add_f32 v[82:83], v[82:83], v[166:167]
    v_max_f32 v168, v168, v169
    v_cvt_pk_bf16_f32 v168, -v168, 0
    v_cndmask_b32 v50, 0, v168, s[32:33]
    v_lshlrev_b32 v170, 16, v168
    v_mov_b32 v171, v170
    v_pk_add_f32 v[84:85], v[84:85], v[170:171]
    v_pk_add_f32 v[86:87], v[86:87], v[170:171]
    v_pk_add_f32 v[88:89], v[88:89], v[170:171]
    v_pk_add_f32 v[90:91], v[90:91], v[170:171]
    v_pk_add_f32 v[92:93], v[92:93], v[170:171]
    v_pk_add_f32 v[94:95], v[94:95], v[170:171]
    v_pk_add_f32 v[96:97], v[96:97], v[170:171]
    v_pk_add_f32 v[98:99], v[98:99], v[170:171]
    v_exp_f32 v68, v68
    v_exp_f32 v69, v69
    v_exp_f32 v70, v70
    v_exp_f32 v71, v71
    v_exp_f32 v72, v72
    v_exp_f32 v73, v73
    v_exp_f32 v74, v74
    v_exp_f32 v75, v75
    v_cvt_pk_bf16_f32 v68, v68, v69
    v_cvt_pk_bf16_f32 v69, v70, v71
    v_cvt_pk_bf16_f32 v70, v72, v73
    v_cvt_pk_bf16_f32 v71, v74, v75
    v_exp_f32 v76, v76
    v_exp_f32 v77, v77
    ds_read_b128 v[100:103], v236 offset:14336
    ds_read_b64 v[104:105], v237 offset:3584
    v_exp_f32 v78, v78
    v_exp_f32 v79, v79
    v_exp_f32 v80, v80
    v_exp_f32 v81, v81
    s_waitcnt lgkmcnt(4)
    v_mfma_f32_32x32x16_bf16 v[116:131], v[148:151], v[68:71], 0
    v_exp_f32 v82, v82
    v_exp_f32 v83, v83
    v_cvt_pk_bf16_f32 v72, v76, v77
    v_cvt_pk_bf16_f32 v73, v78, v79
    v_cvt_pk_bf16_f32 v74, v80, v81
    v_cvt_pk_bf16_f32 v75, v82, v83
    ds_read_b64_tr_b16 v[156:157], v242 offset:16384
    ds_read_b64_tr_b16 v[158:159], v243 offset:16896
    ds_read_b64_tr_b16 v[160:161], v242 offset:17408
    ds_read_b64_tr_b16 v[162:163], v243 offset:17920
    s_waitcnt lgkmcnt(6)
    v_mfma_f32_32x32x16_bf16 v[116:131], v[152:155], v[72:75], v[116:131]
    v_exp_f32 v84, v84
    v_exp_f32 v85, v85
    v_exp_f32 v86, v86
    v_exp_f32 v87, v87
    v_exp_f32 v88, v88
    v_exp_f32 v89, v89
    v_exp_f32 v90, v90
    v_exp_f32 v91, v91
    s_waitcnt lgkmcnt(5)
    v_mfma_f32_32x32x16_bf16 v[68:83], v[100:103], v[52:55], 0
    v_cvt_pk_bf16_f32 v84, v84, v85
    v_cvt_pk_bf16_f32 v85, v86, v87
    v_cvt_pk_bf16_f32 v86, v88, v89
    v_cvt_pk_bf16_f32 v87, v90, v91
    v_exp_f32 v92, v92
    v_exp_f32 v93, v93
    s_waitcnt lgkmcnt(4)
    v_mfma_f32_32x32x16_bf16 v[68:83], v[104:107], v[44:47], v[68:83]
    ds_read_b128 v[108:111], v236 offset:13312
    ds_read_b64 v[112:113], v237 offset:3328
    v_exp_f32 v94, v94
    v_exp_f32 v95, v95
    v_exp_f32 v96, v96
    v_exp_f32 v97, v97
    s_waitcnt lgkmcnt(4)
    v_mfma_f32_32x32x16_bf16 v[132:147], v[156:159], v[84:87], 0
    v_exp_f32 v98, v98
    v_exp_f32 v99, v99
    v_cvt_pk_bf16_f32 v88, v92, v93
    v_cvt_pk_bf16_f32 v89, v94, v95
    v_cvt_pk_bf16_f32 v90, v96, v97
    v_cvt_pk_bf16_f32 v91, v98, v99
    ds_read_b64_tr_b16 v[148:149], v242 offset:28672
    ds_read_b64_tr_b16 v[150:151], v243 offset:29184
    ds_read_b64_tr_b16 v[152:153], v242 offset:29696
    ds_read_b64_tr_b16 v[154:155], v243 offset:30208
    s_waitcnt lgkmcnt(6)
    v_mfma_f32_32x32x16_bf16 v[132:147], v[160:163], v[88:91], v[132:147]
    v_exp_f32 v68, v68
    v_exp_f32 v69, v69
    v_exp_f32 v70, v70
    v_exp_f32 v71, v71
    v_exp_f32 v72, v72
    v_exp_f32 v73, v73
    v_exp_f32 v74, v74
    v_exp_f32 v75, v75
    s_waitcnt lgkmcnt(5)
    v_mfma_f32_32x32x16_bf16 v[84:99], v[108:111], v[52:55], 0
    v_cvt_pk_bf16_f32 v68, v68, v69
    v_cvt_pk_bf16_f32 v69, v70, v71
    v_cvt_pk_bf16_f32 v70, v72, v73
    v_cvt_pk_bf16_f32 v71, v74, v75
    v_exp_f32 v76, v76
    v_exp_f32 v77, v77
    s_waitcnt lgkmcnt(4)
    v_mfma_f32_32x32x16_bf16 v[84:99], v[112:115], v[44:47], v[84:99]
    ds_read_b128 v[100:103], v236 offset:12288
    ds_read_b64 v[104:105], v237 offset:3072
    v_exp_f32 v78, v78
    v_exp_f32 v79, v79
    v_exp_f32 v80, v80
    v_exp_f32 v81, v81
    s_waitcnt lgkmcnt(4)
    v_mfma_f32_32x32x16_bf16 v[116:131], v[148:151], v[68:71], v[116:131]
    v_exp_f32 v82, v82
    v_exp_f32 v83, v83
    v_cvt_pk_bf16_f32 v72, v76, v77
    v_cvt_pk_bf16_f32 v73, v78, v79
    v_cvt_pk_bf16_f32 v74, v80, v81
    v_cvt_pk_bf16_f32 v75, v82, v83
    ds_read_b64_tr_b16 v[156:157], v242 offset:26624
    ds_read_b64_tr_b16 v[158:159], v243 offset:27136
    ds_read_b64_tr_b16 v[160:161], v242 offset:27648
    ds_read_b64_tr_b16 v[162:163], v243 offset:28160
    s_waitcnt lgkmcnt(6)
    v_mfma_f32_32x32x16_bf16 v[116:131], v[152:155], v[72:75], v[116:131]
    s_waitcnt vmcnt(0)
    s_mov_b64 exec, 1
    buffer_store_dword v216, v217, s[4:7], s47 offen offset:64 sc1
    s_mov_b64 exec, -1
    v_exp_f32 v84, v84
    v_exp_f32 v85, v85
    v_exp_f32 v86, v86
    v_exp_f32 v87, v87
    v_exp_f32 v88, v88
    v_exp_f32 v89, v89
    v_exp_f32 v90, v90
    v_exp_f32 v91, v91
    s_waitcnt lgkmcnt(5)
    v_mfma_f32_32x32x16_bf16 v[68:83], v[100:103], v[52:55], 0
    v_cvt_pk_bf16_f32 v84, v84, v85
    v_cvt_pk_bf16_f32 v85, v86, v87
    v_cvt_pk_bf16_f32 v86, v88, v89
    v_cvt_pk_bf16_f32 v87, v90, v91
    v_exp_f32 v92, v92
    v_exp_f32 v93, v93
    s_waitcnt lgkmcnt(4)
    v_mfma_f32_32x32x16_bf16 v[68:83], v[104:107], v[44:47], v[68:83]
    ds_read_b128 v[108:111], v236 offset:11264
    ds_read_b64 v[112:113], v237 offset:2816
    v_exp_f32 v94, v94
    v_exp_f32 v95, v95
    v_exp_f32 v96, v96
    v_exp_f32 v97, v97
    s_waitcnt lgkmcnt(4)
    v_mfma_f32_32x32x16_bf16 v[116:131], v[156:159], v[84:87], v[116:131]
    v_exp_f32 v98, v98
    v_exp_f32 v99, v99
    v_cvt_pk_bf16_f32 v88, v92, v93
    v_cvt_pk_bf16_f32 v89, v94, v95
    v_cvt_pk_bf16_f32 v90, v96, v97
    v_cvt_pk_bf16_f32 v91, v98, v99
    ds_read_b64_tr_b16 v[148:149], v242 offset:24576
    ds_read_b64_tr_b16 v[150:151], v243 offset:25088
    ds_read_b64_tr_b16 v[152:153], v242 offset:25600
    ds_read_b64_tr_b16 v[154:155], v243 offset:26112
    s_waitcnt lgkmcnt(6)
    v_mfma_f32_32x32x16_bf16 v[116:131], v[160:163], v[88:91], v[116:131]
    v_exp_f32 v68, v68
    v_exp_f32 v69, v69
    v_exp_f32 v70, v70
    v_exp_f32 v71, v71
    v_exp_f32 v72, v72
    v_exp_f32 v73, v73
    v_exp_f32 v74, v74
    v_exp_f32 v75, v75
    s_waitcnt lgkmcnt(5)
    v_mfma_f32_32x32x16_bf16 v[84:99], v[108:111], v[52:55], 0
    v_cvt_pk_bf16_f32 v68, v68, v69
    v_cvt_pk_bf16_f32 v69, v70, v71
    v_cvt_pk_bf16_f32 v70, v72, v73
    v_cvt_pk_bf16_f32 v71, v74, v75
    v_exp_f32 v76, v76
    v_exp_f32 v77, v77
    s_waitcnt lgkmcnt(4)
    v_mfma_f32_32x32x16_bf16 v[84:99], v[112:115], v[44:47], v[84:99]
    ds_read_b128 v[100:103], v236 offset:10240
    ds_read_b64 v[104:105], v237 offset:2560
    v_exp_f32 v78, v78
    v_exp_f32 v79, v79
    v_exp_f32 v80, v80
    v_exp_f32 v81, v81
    s_waitcnt lgkmcnt(4)
    v_mfma_f32_32x32x16_bf16 v[116:131], v[148:151], v[68:71], v[116:131]
    v_exp_f32 v82, v82
    v_exp_f32 v83, v83
    v_cvt_pk_bf16_f32 v72, v76, v77
    v_cvt_pk_bf16_f32 v73, v78, v79
    v_cvt_pk_bf16_f32 v74, v80, v81
    v_cvt_pk_bf16_f32 v75, v82, v83
    ds_read_b64_tr_b16 v[156:157], v242 offset:22528
    ds_read_b64_tr_b16 v[158:159], v243 offset:23040
    ds_read_b64_tr_b16 v[160:161], v242 offset:23552
    ds_read_b64_tr_b16 v[162:163], v243 offset:24064
    s_waitcnt lgkmcnt(6)
    v_mfma_f32_32x32x16_bf16 v[116:131], v[152:155], v[72:75], v[116:131]
    v_exp_f32 v84, v84
    v_exp_f32 v85, v85
    v_exp_f32 v86, v86
    v_exp_f32 v87, v87
    v_exp_f32 v88, v88
    v_exp_f32 v89, v89
    v_exp_f32 v90, v90
    v_exp_f32 v91, v91
    s_waitcnt lgkmcnt(5)
    v_mfma_f32_32x32x16_bf16 v[68:83], v[100:103], v[52:55], 0
    v_cvt_pk_bf16_f32 v84, v84, v85
    v_cvt_pk_bf16_f32 v85, v86, v87
    v_cvt_pk_bf16_f32 v86, v88, v89
    v_cvt_pk_bf16_f32 v87, v90, v91
    v_exp_f32 v92, v92
    v_exp_f32 v93, v93
    s_waitcnt lgkmcnt(4)
    v_mfma_f32_32x32x16_bf16 v[68:83], v[104:107], v[44:47], v[68:83]
    ds_read_b128 v[108:111], v236 offset:9216
    ds_read_b64 v[112:113], v237 offset:2304
    v_exp_f32 v94, v94
    v_exp_f32 v95, v95
    v_exp_f32 v96, v96
    v_exp_f32 v97, v97
    s_waitcnt lgkmcnt(4)
    v_mfma_f32_32x32x16_bf16 v[116:131], v[156:159], v[84:87], v[116:131]
    v_exp_f32 v98, v98
    v_exp_f32 v99, v99
    v_cvt_pk_bf16_f32 v88, v92, v93
    v_cvt_pk_bf16_f32 v89, v94, v95
    v_cvt_pk_bf16_f32 v90, v96, v97
    v_cvt_pk_bf16_f32 v91, v98, v99
    ds_read_b64_tr_b16 v[148:149], v242 offset:20480
    ds_read_b64_tr_b16 v[150:151], v243 offset:20992
    ds_read_b64_tr_b16 v[152:153], v242 offset:21504
    ds_read_b64_tr_b16 v[154:155], v243 offset:22016
    s_waitcnt lgkmcnt(6)
    v_mfma_f32_32x32x16_bf16 v[116:131], v[160:163], v[88:91], v[116:131]
    v_exp_f32 v68, v68
    v_exp_f32 v69, v69
    v_exp_f32 v70, v70
    v_exp_f32 v71, v71
    v_exp_f32 v72, v72
    v_exp_f32 v73, v73
    v_exp_f32 v74, v74
    v_exp_f32 v75, v75
    s_waitcnt lgkmcnt(5)
    v_mfma_f32_32x32x16_bf16 v[84:99], v[108:111], v[52:55], 0
    v_cvt_pk_bf16_f32 v68, v68, v69
    v_cvt_pk_bf16_f32 v69, v70, v71
    v_cvt_pk_bf16_f32 v70, v72, v73
    v_cvt_pk_bf16_f32 v71, v74, v75
    v_exp_f32 v76, v76
    v_exp_f32 v77, v77
    s_waitcnt lgkmcnt(4)
    v_mfma_f32_32x32x16_bf16 v[84:99], v[112:115], v[44:47], v[84:99]
    ds_read_b128 v[100:103], v236 offset:8192
    ds_read_b64 v[104:105], v237 offset:2048
    v_exp_f32 v78, v78
    v_exp_f32 v79, v79
    v_exp_f32 v80, v80
    v_exp_f32 v81, v81
    s_waitcnt lgkmcnt(4)
    v_mfma_f32_32x32x16_bf16 v[116:131], v[148:151], v[68:71], v[116:131]
    v_exp_f32 v82, v82
    v_exp_f32 v83, v83
    v_cvt_pk_bf16_f32 v72, v76, v77
    v_cvt_pk_bf16_f32 v73, v78, v79
    v_cvt_pk_bf16_f32 v74, v80, v81
    v_cvt_pk_bf16_f32 v75, v82, v83
    ds_read_b64_tr_b16 v[156:157], v242 offset:18432
    ds_read_b64_tr_b16 v[158:159], v243 offset:18944
    ds_read_b64_tr_b16 v[160:161], v242 offset:19456
    ds_read_b64_tr_b16 v[162:163], v243 offset:19968
    s_waitcnt lgkmcnt(6)
    v_mfma_f32_32x32x16_bf16 v[116:131], v[152:155], v[72:75], v[116:131]
    ds_read_b32 v223, v222 offset:0
    v_exp_f32 v84, v84
    v_exp_f32 v85, v85
    v_exp_f32 v86, v86
    v_exp_f32 v87, v87
    v_exp_f32 v88, v88
    v_exp_f32 v89, v89
    v_exp_f32 v90, v90
    v_exp_f32 v91, v91
    s_waitcnt lgkmcnt(6)
    v_mfma_f32_32x32x16_bf16 v[68:83], v[100:103], v[52:55], 0
    v_cvt_pk_bf16_f32 v84, v84, v85
    v_cvt_pk_bf16_f32 v85, v86, v87
    v_cvt_pk_bf16_f32 v86, v88, v89
    v_cvt_pk_bf16_f32 v87, v90, v91
    v_exp_f32 v92, v92
    v_exp_f32 v93, v93
    s_waitcnt lgkmcnt(5)
    v_mfma_f32_32x32x16_bf16 v[68:83], v[104:107], v[44:47], v[68:83]
    v_exp_f32 v94, v94
    v_exp_f32 v95, v95
    v_exp_f32 v96, v96
    v_exp_f32 v97, v97
    s_waitcnt lgkmcnt(3)
    v_mfma_f32_32x32x16_bf16 v[116:131], v[156:159], v[84:87], v[116:131]
    v_exp_f32 v98, v98
    v_exp_f32 v99, v99
    v_cvt_pk_bf16_f32 v88, v92, v93
    v_cvt_pk_bf16_f32 v89, v94, v95
    v_cvt_pk_bf16_f32 v90, v96, v97
    v_cvt_pk_bf16_f32 v91, v98, v99
    ds_read_b64_tr_b16 v[148:149], v242 offset:16384
    ds_read_b64_tr_b16 v[150:151], v243 offset:16896
    ds_read_b64_tr_b16 v[152:153], v242 offset:17408
    ds_read_b64_tr_b16 v[154:155], v243 offset:17920
    s_waitcnt lgkmcnt(5)
    v_mfma_f32_32x32x16_bf16 v[116:131], v[160:163], v[88:91], v[116:131]
    s_mov_b64 exec, 0xffffffff
    s_mov_b32 s61, 0
xt_37:
    s_nop 9
    v_subrev_u32 v219, s100, v218
    v_subrev_u32 v219, 1, v219
    v_cmp_le_u32 vcc, 16, v219
    s_nop 4
    s_cbranch_vccz xtd_38
    buffer_load_dword v218, v3, s[4:7], s63 offen sc1
    s_waitcnt vmcnt(0)
    s_add_u32 s61, s61, 1
    s_cmp_lt_u32 s61, s23
    s_cbranch_scc1 xt_37
xtd_38:
    s_add_u32 s40, s62, s100
    v_cmp_ne_u32 vcc, s40, v218
    s_nop 1
    s_cmp_eq_u64 vcc, 0
    s_cselect_b32 s22, 1, 0
    s_mov_b64 exec, -1
    s_lshr_b32 s53, s17, 1
    s_mul_i32 s53, s53, 2560
    s_add_u32 s53, s53, 11091968
    s_and_b32 s52, s17, 1
    s_lshl_b32 s54, s52, 10
    s_lshl_b32 s55, s52, 3
    s_add_u32 s54, s54, s53
    s_add_u32 s55, s55, s53
    s_mul_i32 s52, s18, 40960
    s_add_u32 s48, s54, s52
    s_add_u32 s49, s55, s52
    s_mul_i32 s52, s19, 40960
    s_add_u32 s50, s54, s52
    s_add_u32 s51, s55, s52
    v_mov_b32 v172, 0x7fff0000
    v_cndmask_b32 v172, v172, v1, s[32:33]
    s_mov_b32 s56, 0x21800000
    s_mov_b32 s57, 0x71800000
    s_lshl_b32 s40, s18, 7
    s_lshl_b32 s41, s19, 7
    v_mov_b32 v217, s40
    v_writelane_b32 v217, s41, 1
    s_lshl_b32 s42, s17, 2
    s_add_u32 s42, s42, s21
    s_add_u32 s42, s42, 262144
    s_cmp_lg_u32 s39, 0
    s_cbranch_scc1 res_39
    buffer_load_dwordx2 v[246:247], v244, s[4:7], s34 offen sc1
    buffer_load_dwordx2 v[248:249], v244, s[4:7], s35 offen sc1
    buffer_load_dwordx2 v[250:251], v244, s[4:7], s36 offen sc1
    buffer_load_dwordx2 v[252:253], v244, s[4:7], s37 offen sc1
    buffer_load_dwordx2 v[254:255], v244, s[4:7], s38 offen sc1
    s_load_dwordx2 s[44:45], s[0:1], 40
    s_mov_b32 s46, 0xc00
    s_mov_b32 s47, 0x20000
    v_and_b32 v4, 31, v0
    v_lshlrev_b32 v24, 1, v4
    v_lshrrev_b32 v5, 5, v0
    v_mul_u32_u24 v5, 640, v5
    v_lshl_add_u32 v4, v4, 2, v5
    s_mul_i32 s40, s30, 3840
    s_add_u32 s40, s40, 5242880
    buffer_load_dword v6, v4, s[4:7], s40 offen offset:0 sc1
    buffer_load_dword v7, v4, s[4:7], s40 offen offset:128 sc1
    buffer_load_dword v8, v4, s[4:7], s40 offen offset:256 sc1
    buffer_load_dword v9, v4, s[4:7], s40 offen offset:384 sc1
    buffer_load_dword v10, v4, s[4:7], s40 offen offset:512 sc1
    buffer_load_dword v11, v4, s[4:7], s40 offen offset:1280 sc1
    buffer_load_dword v12, v4, s[4:7], s40 offen offset:1408 sc1
    buffer_load_dword v13, v4, s[4:7], s40 offen offset:1536 sc1
    buffer_load_dword v14, v4, s[4:7], s40 offen offset:1664 sc1
    buffer_load_dword v15, v4, s[4:7], s40 offen offset:1792 sc1
    buffer_load_dword v16, v4, s[4:7], s40 offen offset:2560 sc1
    buffer_load_dword v17, v4, s[4:7], s40 offen offset:2688 sc1
    buffer_load_dword v18, v4, s[4:7], s40 offen offset:2816 sc1
    buffer_load_dword v19, v4, s[4:7], s40 offen offset:2944 sc1
    buffer_load_dword v20, v4, s[4:7], s40 offen offset:3072 sc1
    s_mul_i32 s41, s30, 192
    s_waitcnt lgkmcnt(0)
    buffer_load_ushort v21, v24, s[44:47], s41 offen offset:0
    buffer_load_ushort v22, v24, s[44:47], s41 offen offset:64
    buffer_load_ushort v23, v24, s[44:47], s41 offen offset:128
res_39:
    s_cmp_eq_u32 s16, 0
    s_cbranch_scc1 att0_g0
    s_waitcnt lgkmcnt(4)
    v_cmp_ne_u32 vcc, s100, v223
    s_nop 4
    s_cbranch_vccnz hc_40
hcr_41:
    ds_read_b128 v[108:111], v236 offset:7168
    ds_read_b64 v[112:113], v237 offset:1792
    v_exp_f32 v68, v68
    v_exp_f32 v69, v69
    v_exp_f32 v70, v70
    v_exp_f32 v71, v71
    v_exp_f32 v72, v72
    v_exp_f32 v73, v73
    v_exp_f32 v74, v74
    v_exp_f32 v75, v75
    s_waitcnt lgkmcnt(1)
    v_mfma_f32_32x32x16_bf16 v[84:99], v[108:111], v[52:55], v[196:211]
    v_cvt_pk_bf16_f32 v68, v68, v69
    v_cvt_pk_bf16_f32 v69, v70, v71
    v_cvt_pk_bf16_f32 v70, v72, v73
    v_cvt_pk_bf16_f32 v71, v74, v75
    v_exp_f32 v76, v76
    v_exp_f32 v77, v77
    s_waitcnt lgkmcnt(0)
    v_mfma_f32_32x32x16_bf16 v[84:99], v[112:115], v[44:47], v[84:99]
    ds_read_b128 v[100:103], v236 offset:7168
    ds_read_b64 v[104:105], v237 offset:1792
    v_exp_f32 v78, v78
    v_exp_f32 v79, v79
    v_exp_f32 v80, v80
    v_exp_f32 v81, v81
    v_mfma_f32_32x32x16_bf16 v[116:131], v[148:151], v[68:71], v[116:131]
    v_exp_f32 v82, v82
    v_exp_f32 v83, v83
    v_cvt_pk_bf16_f32 v72, v76, v77
    v_cvt_pk_bf16_f32 v73, v78, v79
    v_cvt_pk_bf16_f32 v74, v80, v81
    v_cvt_pk_bf16_f32 v75, v82, v83
    ds_read_b64_tr_b16 v[156:157], v242 offset:14336
    ds_read_b64_tr_b16 v[158:159], v243 offset:14848
    ds_read_b64_tr_b16 v[160:161], v242 offset:15360
    ds_read_b64_tr_b16 v[162:163], v243 offset:15872
    v_mfma_f32_32x32x16_bf16 v[116:131], v[152:155], v[72:75], v[116:131]
    v_exp_f32 v84, v84
    v_exp_f32 v85, v85
    v_exp_f32 v86, v86
    v_exp_f32 v87, v87
    v_exp_f32 v88, v88
    v_exp_f32 v89, v89
    v_exp_f32 v90, v90
    v_exp_f32 v91, v91
    s_waitcnt lgkmcnt(5)
    v_mfma_f32_32x32x16_bf16 v[68:83], v[100:103], v[28:31], 0
    v_cvt_pk_bf16_f32 v84, v84, v85
    v_cvt_pk_bf16_f32 v85, v86, v87
    v_cvt_pk_bf16_f32 v86, v88, v89
    v_cvt_pk_bf16_f32 v87, v90, v91
    v_exp_f32 v92, v92
    v_exp_f32 v93, v93
    s_waitcnt lgkmcnt(4)
    v_mfma_f32_32x32x16_bf16 v[68:83], v[104:107], v[48:51], v[68:83]
    ds_read_b128 v[108:111], v236 offset:6144
    ds_read_b64 v[112:113], v237 offset:1536
    v_exp_f32 v94, v94
    v_exp_f32 v95, v95
    v_exp_f32 v96, v96
    v_exp_f32 v97, v97
    s_waitcnt lgkmcnt(4)
    v_mfma_f32_32x32x16_bf16 v[116:131], v[156:159], v[84:87], v[116:131]
    v_exp_f32 v98, v98
    v_exp_f32 v99, v99
    v_cvt_pk_bf16_f32 v88, v92, v93
    v_cvt_pk_bf16_f32 v89, v94, v95
    v_cvt_pk_bf16_f32 v90, v96, v97
    v_cvt_pk_bf16_f32 v91, v98, v99
    ds_read_b64_tr_b16 v[148:149], v242 offset:14336
    ds_read_b64_tr_b16 v[150:151], v243 offset:14848
    ds_read_b64_tr_b16 v[152:153], v242 offset:15360
    ds_read_b64_tr_b16 v[154:155], v243 offset:15872
    s_waitcnt lgkmcnt(6)
    v_mfma_f32_32x32x16_bf16 v[116:131], v[160:163], v[88:91], v[116:131]
    v_exp_f32 v68, v68
    v_exp_f32 v69, v69
    v_exp_f32 v70, v70
    v_exp_f32 v71, v71
    v_exp_f32 v72, v72
    v_exp_f32 v73, v73
    v_exp_f32 v74, v74
    v_exp_f32 v75, v75
    s_waitcnt lgkmcnt(5)
    v_mfma_f32_32x32x16_bf16 v[84:99], v[108:111], v[28:31], 0
    v_cvt_pk_bf16_f32 v68, v68, v69
    v_cvt_pk_bf16_f32 v69, v70, v71
    v_cvt_pk_bf16_f32 v70, v72, v73
    v_cvt_pk_bf16_f32 v71, v74, v75
    v_exp_f32 v76, v76
    v_exp_f32 v77, v77
    s_waitcnt lgkmcnt(4)
    v_mfma_f32_32x32x16_bf16 v[84:99], v[112:115], v[48:51], v[84:99]
    ds_read_b128 v[100:103], v236 offset:5120
    ds_read_b64 v[104:105], v237 offset:1280
    v_exp_f32 v78, v78
    v_exp_f32 v79, v79
    v_exp_f32 v80, v80
    v_exp_f32 v81, v81
    s_waitcnt lgkmcnt(4)
    v_mfma_f32_32x32x16_bf16 v[132:147], v[148:151], v[68:71], v[132:147]
    v_exp_f32 v82, v82
    v_exp_f32 v83, v83
    v_cvt_pk_bf16_f32 v72, v76, v77
    v_cvt_pk_bf16_f32 v73, v78, v79
    v_cvt_pk_bf16_f32 v74, v80, v81
    v_cvt_pk_bf16_f32 v75, v82, v83
    ds_read_b64_tr_b16 v[156:157], v242 offset:12288
    ds_read_b64_tr_b16 v[158:159], v243 offset:12800
    ds_read_b64_tr_b16 v[160:161], v242 offset:13312
    ds_read_b64_tr_b16 v[162:163], v243 offset:13824
    s_waitcnt lgkmcnt(6)
    v_mfma_f32_32x32x16_bf16 v[132:147], v[152:155], v[72:75], v[132:147]
    v_exp_f32 v84, v84
    v_exp_f32 v85, v85
    v_exp_f32 v86, v86
    v_exp_f32 v87, v87
    v_exp_f32 v88, v88
    v_exp_f32 v89, v89
    v_exp_f32 v90, v90
    v_exp_f32 v91, v91
    s_waitcnt lgkmcnt(5)
    v_mfma_f32_32x32x16_bf16 v[68:83], v[100:103], v[28:31], 0
    v_cvt_pk_bf16_f32 v84, v84, v85
    v_cvt_pk_bf16_f32 v85, v86, v87
    v_cvt_pk_bf16_f32 v86, v88, v89
    v_cvt_pk_bf16_f32 v87, v90, v91
    v_exp_f32 v92, v92
    v_exp_f32 v93, v93
    s_waitcnt lgkmcnt(4)
    v_mfma_f32_32x32x16_bf16 v[68:83], v[104:107], v[48:51], v[68:83]
    ds_read_b128 v[108:111], v236 offset:4096
    ds_read_b64 v[112:113], v237 offset:1024
    v_exp_f32 v94, v94
    v_exp_f32 v95, v95
    v_exp_f32 v96, v96
    v_exp_f32 v97, v97
    s_waitcnt lgkmcnt(4)
    v_mfma_f32_32x32x16_bf16 v[132:147], v[156:159], v[84:87], v[132:147]
    v_exp_f32 v98, v98
    v_exp_f32 v99, v99
    v_cvt_pk_bf16_f32 v88, v92, v93
    v_cvt_pk_bf16_f32 v89, v94, v95
    v_cvt_pk_bf16_f32 v90, v96, v97
    v_cvt_pk_bf16_f32 v91, v98, v99
    ds_read_b64_tr_b16 v[148:149], v242 offset:10240
    ds_read_b64_tr_b16 v[150:151], v243 offset:10752
    ds_read_b64_tr_b16 v[152:153], v242 offset:11264
    ds_read_b64_tr_b16 v[154:155], v243 offset:11776
    s_waitcnt lgkmcnt(6)
    v_mfma_f32_32x32x16_bf16 v[132:147], v[160:163], v[88:91], v[132:147]
    ds_read_b32 v223, v222 offset:16
    v_exp_f32 v68, v68
    v_exp_f32 v69, v69
    v_exp_f32 v70, v70
    v_exp_f32 v71, v71
    v_exp_f32 v72, v72
    v_exp_f32 v73, v73
    v_exp_f32 v74, v74
    v_exp_f32 v75, v75
    s_waitcnt lgkmcnt(6)
    v_mfma_f32_32x32x16_bf16 v[84:99], v[108:111], v[28:31], 0
    v_cvt_pk_bf16_f32 v68, v68, v69
    v_cvt_pk_bf16_f32 v69, v70, v71
    v_cvt_pk_bf16_f32 v70, v72, v73
    v_cvt_pk_bf16_f32 v71, v74, v75
    v_exp_f32 v76, v76
    v_exp_f32 v77, v77
    s_waitcnt lgkmcnt(5)
    v_mfma_f32_32x32x16_bf16 v[84:99], v[112:115], v[48:51], v[84:99]
    v_exp_f32 v78, v78
    v_exp_f32 v79, v79
    v_exp_f32 v80, v80
    v_exp_f32 v81, v81
    s_waitcnt lgkmcnt(3)
    v_mfma_f32_32x32x16_bf16 v[132:147], v[148:151], v[68:71], v[132:147]
    v_exp_f32 v82, v82
    v_exp_f32 v83, v83
    v_cvt_pk_bf16_f32 v72, v76, v77
    v_cvt_pk_bf16_f32 v73, v78, v79
    v_cvt_pk_bf16_f32 v74, v80, v81
    v_cvt_pk_bf16_f32 v75, v82, v83
    ds_read_b64_tr_b16 v[156:157], v242 offset:8192
    ds_read_b64_tr_b16 v[158:159], v243 offset:8704
    ds_read_b64_tr_b16 v[160:161], v242 offset:9216
    ds_read_b64_tr_b16 v[162:163], v243 offset:9728
    s_waitcnt lgkmcnt(5)
    v_mfma_f32_32x32x16_bf16 v[132:147], v[152:155], v[72:75], v[132:147]
    s_waitcnt lgkmcnt(4)
    v_cmp_ne_u32 vcc, s100, v223
    s_nop 4
    s_cbranch_vccnz hc_42
hcr_43:
    ds_read_b128 v[100:103], v236 offset:3072
    ds_read_b64 v[104:105], v237 offset:768
    v_exp_f32 v84, v84
    v_exp_f32 v85, v85
    v_exp_f32 v86, v86
    v_exp_f32 v87, v87
    v_exp_f32 v88, v88
    v_exp_f32 v89, v89
    v_exp_f32 v90, v90
    v_exp_f32 v91, v91
    s_waitcnt lgkmcnt(1)
    v_mfma_f32_32x32x16_bf16 v[68:83], v[100:103], v[28:31], 0
    v_cvt_pk_bf16_f32 v84, v84, v85
    v_cvt_pk_bf16_f32 v85, v86, v87
    v_cvt_pk_bf16_f32 v86, v88, v89
    v_cvt_pk_bf16_f32 v87, v90, v91
    v_exp_f32 v92, v92
    v_exp_f32 v93, v93
    s_waitcnt lgkmcnt(0)
    v_mfma_f32_32x32x16_bf16 v[68:83], v[104:107], v[48:51], v[68:83]
    ds_read_b128 v[108:111], v236 offset:2048
    ds_read_b64 v[112:113], v237 offset:512
    v_exp_f32 v94, v94
    v_exp_f32 v95, v95
    v_exp_f32 v96, v96
    v_exp_f32 v97, v97
    v_mfma_f32_32x32x16_bf16 v[132:147], v[156:159], v[84:87], v[132:147]
    v_exp_f32 v98, v98
    v_exp_f32 v99, v99
    v_cvt_pk_bf16_f32 v88, v92, v93
    v_cvt_pk_bf16_f32 v89, v94, v95
    v_cvt_pk_bf16_f32 v90, v96, v97
    v_cvt_pk_bf16_f32 v91, v98, v99
    ds_read_b64_tr_b16 v[148:149], v242 offset:6144
    ds_read_b64_tr_b16 v[150:151], v243 offset:6656
    ds_read_b64_tr_b16 v[152:153], v242 offset:7168
    ds_read_b64_tr_b16 v[154:155], v243 offset:7680
    v_mfma_f32_32x32x16_bf16 v[132:147], v[160:163], v[88:91], v[132:147]
    v_exp_f32 v68, v68
    v_exp_f32 v69, v69
    v_exp_f32 v70, v70
    v_exp_f32 v71, v71
    v_exp_f32 v72, v72
    v_exp_f32 v73, v73
    v_exp_f32 v74, v74
    v_exp_f32 v75, v75
    s_waitcnt lgkmcnt(5)
    v_mfma_f32_32x32x16_bf16 v[84:99], v[108:111], v[28:31], 0
    v_cvt_pk_bf16_f32 v68, v68, v69
    v_cvt_pk_bf16_f32 v69, v70, v71
    v_cvt_pk_bf16_f32 v70, v72, v73
    v_cvt_pk_bf16_f32 v71, v74, v75
    v_exp_f32 v76, v76
    v_exp_f32 v77, v77
    s_waitcnt lgkmcnt(4)
    v_mfma_f32_32x32x16_bf16 v[84:99], v[112:115], v[48:51], v[84:99]
    ds_read_b128 v[100:103], v236 offset:1024
    ds_read_b64 v[104:105], v237 offset:256
    v_exp_f32 v78, v78
    v_exp_f32 v79, v79
    v_exp_f32 v80, v80
    v_exp_f32 v81, v81
    s_waitcnt lgkmcnt(4)
    v_mfma_f32_32x32x16_bf16 v[132:147], v[148:151], v[68:71], v[132:147]
    v_exp_f32 v82, v82
    v_exp_f32 v83, v83
    v_cvt_pk_bf16_f32 v72, v76, v77
    v_cvt_pk_bf16_f32 v73, v78, v79
    v_cvt_pk_bf16_f32 v74, v80, v81
    v_cvt_pk_bf16_f32 v75, v82, v83
    ds_read_b64_tr_b16 v[156:157], v242 offset:4096
    ds_read_b64_tr_b16 v[158:159], v243 offset:4608
    ds_read_b64_tr_b16 v[160:161], v242 offset:5120
    ds_read_b64_tr_b16 v[162:163], v243 offset:5632
    s_waitcnt lgkmcnt(6)
    v_mfma_f32_32x32x16_bf16 v[132:147], v[152:155], v[72:75], v[132:147]
    v_exp_f32 v84, v84
    v_exp_f32 v85, v85
    v_exp_f32 v86, v86
    v_exp_f32 v87, v87
    v_exp_f32 v88, v88
    v_exp_f32 v89, v89
    v_exp_f32 v90, v90
    v_exp_f32 v91, v91
    s_waitcnt lgkmcnt(5)
    v_mfma_f32_32x32x16_bf16 v[68:83], v[100:103], v[28:31], 0
    v_cvt_pk_bf16_f32 v84, v84, v85
    v_cvt_pk_bf16_f32 v85, v86, v87
    v_cvt_pk_bf16_f32 v86, v88, v89
    v_cvt_pk_bf16_f32 v87, v90, v91
    v_exp_f32 v92, v92
    v_exp_f32 v93, v93
    s_waitcnt lgkmcnt(4)
    v_mfma_f32_32x32x16_bf16 v[68:83], v[104:107], v[48:51], v[68:83]
    ds_read_b128 v[108:111], v236 offset:0
    ds_read_b64 v[112:113], v237 offset:0
    v_exp_f32 v94, v94
    v_exp_f32 v95, v95
    v_exp_f32 v96, v96
    v_exp_f32 v97, v97
    s_waitcnt lgkmcnt(4)
    v_mfma_f32_32x32x16_bf16 v[132:147], v[156:159], v[84:87], v[132:147]
    v_exp_f32 v98, v98
    v_exp_f32 v99, v99
    v_cvt_pk_bf16_f32 v88, v92, v93
    v_cvt_pk_bf16_f32 v89, v94, v95
    v_cvt_pk_bf16_f32 v90, v96, v97
    v_cvt_pk_bf16_f32 v91, v98, v99
    ds_read_b64_tr_b16 v[148:149], v242 offset:2048
    ds_read_b64_tr_b16 v[150:151], v243 offset:2560
    ds_read_b64_tr_b16 v[152:153], v242 offset:3072
    ds_read_b64_tr_b16 v[154:155], v243 offset:3584
    s_waitcnt lgkmcnt(6)
    v_mfma_f32_32x32x16_bf16 v[132:147], v[160:163], v[88:91], v[132:147]
    v_exp_f32 v68, v68
    v_exp_f32 v69, v69
    v_exp_f32 v70, v70
    v_exp_f32 v71, v71
    v_exp_f32 v72, v72
    v_exp_f32 v73, v73
    v_exp_f32 v74, v74
    v_exp_f32 v75, v75
    s_waitcnt lgkmcnt(5)
    v_mfma_f32_32x32x16_bf16 v[84:99], v[108:111], v[28:31], v[196:211]
    v_cvt_pk_bf16_f32 v68, v68, v69
    v_cvt_pk_bf16_f32 v69, v70, v71
    v_cvt_pk_bf16_f32 v70, v72, v73
    v_cvt_pk_bf16_f32 v71, v74, v75
    v_exp_f32 v76, v76
    v_exp_f32 v77, v77
    s_waitcnt lgkmcnt(4)
    v_mfma_f32_32x32x16_bf16 v[84:99], v[112:115], v[48:51], v[84:99]
    v_exp_f32 v78, v78
    v_exp_f32 v79, v79
    v_exp_f32 v80, v80
    v_exp_f32 v81, v81
    s_waitcnt lgkmcnt(2)
    v_mfma_f32_32x32x16_bf16 v[132:147], v[148:151], v[68:71], v[132:147]
    v_exp_f32 v82, v82
    v_exp_f32 v83, v83
    v_cvt_pk_bf16_f32 v72, v76, v77
    v_cvt_pk_bf16_f32 v73, v78, v79
    v_cvt_pk_bf16_f32 v74, v80, v81
    v_cvt_pk_bf16_f32 v75, v82, v83
    ds_read_b64_tr_b16 v[156:157], v242 offset:0
    ds_read_b64_tr_b16 v[158:159], v243 offset:512
    ds_read_b64_tr_b16 v[160:161], v242 offset:1024
    ds_read_b64_tr_b16 v[162:163], v243 offset:1536
    s_waitcnt lgkmcnt(4)
    v_mfma_f32_32x32x16_bf16 v[132:147], v[152:155], v[72:75], v[132:147]
    v_exp_f32 v84, v84
    v_exp_f32 v85, v85
    v_exp_f32 v86, v86
    v_exp_f32 v87, v87
    v_exp_f32 v88, v88
    v_exp_f32 v89, v89
    v_exp_f32 v90, v90
    v_exp_f32 v91, v91
    v_cvt_pk_bf16_f32 v84, v84, v85
    v_cvt_pk_bf16_f32 v85, v86, v87
    v_cvt_pk_bf16_f32 v86, v88, v89
    v_cvt_pk_bf16_f32 v87, v90, v91
    v_exp_f32 v92, v92
    v_exp_f32 v93, v93
    v_exp_f32 v94, v94
    v_exp_f32 v95, v95
    v_exp_f32 v96, v96
    v_exp_f32 v97, v97
    s_waitcnt lgkmcnt(2)
    v_mfma_f32_32x32x16_bf16 v[132:147], v[156:159], v[84:87], v[132:147]
    v_exp_f32 v98, v98
    v_exp_f32 v99, v99
    v_cvt_pk_bf16_f32 v88, v92, v93
    v_cvt_pk_bf16_f32 v89, v94, v95
    v_cvt_pk_bf16_f32 v90, v96, v97
    v_cvt_pk_bf16_f32 v91, v98, v99
    s_waitcnt lgkmcnt(0)
    s_nop 0
    v_mfma_f32_32x32x16_bf16 v[132:147], v[160:163], v[88:91], v[132:147]
    s_branch att_done
att1:
    ds_write_b128 v236, v[60:63] offset:14336
    ds_write_b64 v238, v[56:57] offset:3584
    ds_write_b64 v239, v[58:59] offset:28672
    ds_write_b64 v240, v[64:65] offset:28672
    ds_write_b64 v241, v[66:67] offset:28672
    ds_write_b128 v236, v[36:39] offset:9216
    ds_write_b64 v238, v[32:33] offset:2304
    ds_write_b64 v239, v[34:35] offset:18432
    ds_write_b64 v240, v[40:41] offset:18432
    ds_write_b64 v241, v[42:43] offset:18432
    v_cndmask_b32 v44, 0, v56, s[32:33]
    v_cndmask_b32 v45, 0, v57, s[32:33]
    v_mov_b32 v46, 0
    v_mov_b32 v47, 0
    v_pk_mul_f32 v[148:149], v[148:149], v[24:25]
    v_pk_mul_f32 v[150:151], v[150:151], v[24:25]
    v_pk_mul_f32 v[152:153], v[152:153], v[24:25]
    v_pk_mul_f32 v[154:155], v[154:155], v[24:25]
    v_cvt_pk_bf16_f32 v28, v148, v149
    v_cvt_pk_bf16_f32 v29, v150, v151
    v_cvt_pk_bf16_f32 v30, v152, v153
    v_cvt_pk_bf16_f32 v31, v154, v155
    v_cndmask_b32 v48, 0, v32, s[32:33]
    v_cndmask_b32 v49, 0, v33, s[32:33]
    v_mov_b32 v50, 0
    v_mov_b32 v51, 0
    v_mov_b32 v106, 0x3f80
    v_mov_b32 v107, 0
    v_mov_b32 v114, 0x3f80
    v_mov_b32 v115, 0
    v_mfma_f32_32x32x16_bf16 v[68:83], v[60:63], v[52:55], v[180:195]
    v_mfma_f32_32x32x16_bf16 v[84:99], v[36:39], v[28:31], v[180:195]
    s_waitcnt lgkmcnt(0)
    ds_read_b64 v[104:105], v237 offset:3584
    ds_read_b64 v[112:113], v237 offset:2304
    ds_read_b64_tr_b16 v[148:149], v242 offset:28672
    ds_read_b64_tr_b16 v[150:151], v243 offset:29184
    ds_read_b64_tr_b16 v[152:153], v242 offset:29696
    ds_read_b64_tr_b16 v[154:155], v243 offset:30208
    s_waitcnt lgkmcnt(5)
    v_mfma_f32_32x32x16_bf16 v[68:83], v[104:107], v[44:47], v[68:83]
    s_waitcnt lgkmcnt(4)
    v_mfma_f32_32x32x16_bf16 v[84:99], v[112:115], v[48:51], v[84:99]
    s_lshl_b32 s40, s39, 5
    s_add_u32 s40, s40, 104448
    v_and_b32 v222, 3, v0
    v_lshl_add_u32 v222, v222, 2, s40
    s_waitcnt vmcnt(4)
    s_mov_b64 exec, 1
    buffer_store_dword v216, v217, s[4:7], s47 offen sc1
    s_mov_b64 exec, -1
    s_barrier
    s_nop 0
    v_max3_f32 v164, v68, v69, v70
    v_max3_f32 v165, v71, v72, v73
    v_max3_f32 v164, v164, v74, v75
    v_max3_f32 v165, v165, v76, v77
    v_max3_f32 v164, v164, v78, v79
    v_max3_f32 v165, v165, v80, v81
    v_max3_f32 v164, v164, v82, v83
    v_max_f32 v164, v164, v165
    v_mov_b32 v165, v164
    v_max3_f32 v168, v84, v85, v86
    v_max3_f32 v169, v87, v88, v89
    v_max3_f32 v168, v168, v90, v91
    v_max3_f32 v169, v169, v92, v93
    v_max3_f32 v168, v168, v94, v95
    v_max3_f32 v169, v169, v96, v97
    v_max3_f32 v168, v168, v98, v99
    v_max_f32 v168, v168, v169
    v_mov_b32 v169, v168
    v_permlane32_swap_b32 v164, v165
    s_nop 0
    v_permlane32_swap_b32 v168, v169
    v_max_f32 v164, v164, v165
    v_cvt_pk_bf16_f32 v164, -v164, 0
    v_cndmask_b32 v46, 0, v164, s[32:33]
    v_lshlrev_b32 v166, 16, v164
    v_mov_b32 v167, v166
    v_pk_add_f32 v[68:69], v[68:69], v[166:167]
    v_pk_add_f32 v[70:71], v[70:71], v[166:167]
    v_pk_add_f32 v[72:73], v[72:73], v[166:167]
    v_pk_add_f32 v[74:75], v[74:75], v[166:167]
    v_pk_add_f32 v[76:77], v[76:77], v[166:167]
    v_pk_add_f32 v[78:79], v[78:79], v[166:167]
    v_pk_add_f32 v[80:81], v[80:81], v[166:167]
    v_pk_add_f32 v[82:83], v[82:83], v[166:167]
    v_max_f32 v168, v168, v169
    v_cvt_pk_bf16_f32 v168, -v168, 0
    v_cndmask_b32 v50, 0, v168, s[32:33]
    v_lshlrev_b32 v170, 16, v168
    v_mov_b32 v171, v170
    v_pk_add_f32 v[84:85], v[84:85], v[170:171]
    v_pk_add_f32 v[86:87], v[86:87], v[170:171]
    v_pk_add_f32 v[88:89], v[88:89], v[170:171]
    v_pk_add_f32 v[90:91], v[90:91], v[170:171]
    v_pk_add_f32 v[92:93], v[92:93], v[170:171]
    v_pk_add_f32 v[94:95], v[94:95], v[170:171]
    v_pk_add_f32 v[96:97], v[96:97], v[170:171]
    v_pk_add_f32 v[98:99], v[98:99], v[170:171]
    v_exp_f32 v68, v68
    v_exp_f32 v69, v69
    v_exp_f32 v70, v70
    v_exp_f32 v71, v71
    v_exp_f32 v72, v72
    v_exp_f32 v73, v73
    v_exp_f32 v74, v74
    v_exp_f32 v75, v75
    v_cvt_pk_bf16_f32 v68, v68, v69
    v_cvt_pk_bf16_f32 v69, v70, v71
    v_cvt_pk_bf16_f32 v70, v72, v73
    v_cvt_pk_bf16_f32 v71, v74, v75
    v_exp_f32 v76, v76
    v_exp_f32 v77, v77
    ds_read_b128 v[100:103], v236 offset:13312
    ds_read_b64 v[104:105], v237 offset:3328
    v_exp_f32 v78, v78
    v_exp_f32 v79, v79
    v_exp_f32 v80, v80
    v_exp_f32 v81, v81
    s_waitcnt lgkmcnt(4)
    v_mfma_f32_32x32x16_bf16 v[116:131], v[148:151], v[68:71], 0
    v_exp_f32 v82, v82
    v_exp_f32 v83, v83
    v_cvt_pk_bf16_f32 v72, v76, v77
    v_cvt_pk_bf16_f32 v73, v78, v79
    v_cvt_pk_bf16_f32 v74, v80, v81
    v_cvt_pk_bf16_f32 v75, v82, v83
    ds_read_b64_tr_b16 v[156:157], v242 offset:18432
    ds_read_b64_tr_b16 v[158:159], v243 offset:18944
    ds_read_b64_tr_b16 v[160:161], v242 offset:19456
    ds_read_b64_tr_b16 v[162:163], v243 offset:19968
    s_waitcnt lgkmcnt(6)
    v_mfma_f32_32x32x16_bf16 v[116:131], v[152:155], v[72:75], v[116:131]
    v_exp_f32 v84, v84
    v_exp_f32 v85, v85
    v_exp_f32 v86, v86
    v_exp_f32 v87, v87
    v_exp_f32 v88, v88
    v_exp_f32 v89, v89
    v_exp_f32 v90, v90
    v_exp_f32 v91, v91
    s_waitcnt lgkmcnt(5)
    v_mfma_f32_32x32x16_bf16 v[68:83], v[100:103], v[52:55], 0
    v_cvt_pk_bf16_f32 v84, v84, v85
    v_cvt_pk_bf16_f32 v85, v86, v87
    v_cvt_pk_bf16_f32 v86, v88, v89
    v_cvt_pk_bf16_f32 v87, v90, v91
    v_exp_f32 v92, v92
    v_exp_f32 v93, v93
    s_waitcnt lgkmcnt(4)
    v_mfma_f32_32x32x16_bf16 v[68:83], v[104:107], v[44:47], v[68:83]
    ds_read_b128 v[108:111], v236 offset:12288
    ds_read_b64 v[112:113], v237 offset:3072
    v_exp_f32 v94, v94
    v_exp_f32 v95, v95
    v_exp_f32 v96, v96
    v_exp_f32 v97, v97
    s_waitcnt lgkmcnt(4)
    v_mfma_f32_32x32x16_bf16 v[132:147], v[156:159], v[84:87], 0
    v_exp_f32 v98, v98
    v_exp_f32 v99, v99
    v_cvt_pk_bf16_f32 v88, v92, v93
    v_cvt_pk_bf16_f32 v89, v94, v95
    v_cvt_pk_bf16_f32 v90, v96, v97
    v_cvt_pk_bf16_f32 v91, v98, v99
    ds_read_b64_tr_b16 v[148:149], v242 offset:26624
    ds_read_b64_tr_b16 v[150:151], v243 offset:27136
    ds_read_b64_tr_b16 v[152:153], v242 offset:27648
    ds_read_b64_tr_b16 v[154:155], v243 offset:28160
    s_waitcnt lgkmcnt(6)
    v_mfma_f32_32x32x16_bf16 v[132:147], v[160:163], v[88:91], v[132:147]
    v_exp_f32 v68, v68
    v_exp_f32 v69, v69
    v_exp_f32 v70, v70
    v_exp_f32 v71, v71
    v_exp_f32 v72, v72
    v_exp_f32 v73, v73
    v_exp_f32 v74, v74
    v_exp_f32 v75, v75
    s_waitcnt lgkmcnt(5)
    v_mfma_f32_32x32x16_bf16 v[84:99], v[108:111], v[52:55], 0
    v_cvt_pk_bf16_f32 v68, v68, v69
    v_cvt_pk_bf16_f32 v69, v70, v71
    v_cvt_pk_bf16_f32 v70, v72, v73
    v_cvt_pk_bf16_f32 v71, v74, v75
    v_exp_f32 v76, v76
    v_exp_f32 v77, v77
    s_waitcnt lgkmcnt(4)
    v_mfma_f32_32x32x16_bf16 v[84:99], v[112:115], v[44:47], v[84:99]
    ds_read_b128 v[100:103], v236 offset:11264
    ds_read_b64 v[104:105], v237 offset:2816
    v_exp_f32 v78, v78
    v_exp_f32 v79, v79
    v_exp_f32 v80, v80
    v_exp_f32 v81, v81
    s_waitcnt lgkmcnt(4)
    v_mfma_f32_32x32x16_bf16 v[116:131], v[148:151], v[68:71], v[116:131]
    v_exp_f32 v82, v82
    v_exp_f32 v83, v83
    v_cvt_pk_bf16_f32 v72, v76, v77
    v_cvt_pk_bf16_f32 v73, v78, v79
    v_cvt_pk_bf16_f32 v74, v80, v81
    v_cvt_pk_bf16_f32 v75, v82, v83
    ds_read_b64_tr_b16 v[156:157], v242 offset:24576
    ds_read_b64_tr_b16 v[158:159], v243 offset:25088
    ds_read_b64_tr_b16 v[160:161], v242 offset:25600
    ds_read_b64_tr_b16 v[162:163], v243 offset:26112
    s_waitcnt lgkmcnt(6)
    v_mfma_f32_32x32x16_bf16 v[116:131], v[152:155], v[72:75], v[116:131]
    s_waitcnt vmcnt(0)
    s_mov_b64 exec, 1
    buffer_store_dword v216, v217, s[4:7], s47 offen offset:64 sc1
    s_mov_b64 exec, -1
    v_exp_f32 v84, v84
    v_exp_f32 v85, v85
    v_exp_f32 v86, v86
    v_exp_f32 v87, v87
    v_exp_f32 v88, v88
    v_exp_f32 v89, v89
    v_exp_f32 v90, v90
    v_exp_f32 v91, v91
    s_waitcnt lgkmcnt(5)
    v_mfma_f32_32x32x16_bf16 v[68:83], v[100:103], v[52:55], 0
    v_cvt_pk_bf16_f32 v84, v84, v85
    v_cvt_pk_bf16_f32 v85, v86, v87
    v_cvt_pk_bf16_f32 v86, v88, v89
    v_cvt_pk_bf16_f32 v87, v90, v91
    v_exp_f32 v92, v92
    v_exp_f32 v93, v93
    s_waitcnt lgkmcnt(4)
    v_mfma_f32_32x32x16_bf16 v[68:83], v[104:107], v[44:47], v[68:83]
    ds_read_b128 v[108:111], v236 offset:10240
    ds_read_b64 v[112:113], v237 offset:2560
    v_exp_f32 v94, v94
    v_exp_f32 v95, v95
    v_exp_f32 v96, v96
    v_exp_f32 v97, v97
    s_waitcnt lgkmcnt(4)
    v_mfma_f32_32x32x16_bf16 v[116:131], v[156:159], v[84:87], v[116:131]
    v_exp_f32 v98, v98
    v_exp_f32 v99, v99
    v_cvt_pk_bf16_f32 v88, v92, v93
    v_cvt_pk_bf16_f32 v89, v94, v95
    v_cvt_pk_bf16_f32 v90, v96, v97
    v_cvt_pk_bf16_f32 v91, v98, v99
    ds_read_b64_tr_b16 v[148:149], v242 offset:22528
    ds_read_b64_tr_b16 v[150:151], v243 offset:23040
    ds_read_b64_tr_b16 v[152:153], v242 offset:23552
    ds_read_b64_tr_b16 v[154:155], v243 offset:24064
    s_waitcnt lgkmcnt(6)
    v_mfma_f32_32x32x16_bf16 v[116:131], v[160:163], v[88:91], v[116:131]
    v_exp_f32 v68, v68
    v_exp_f32 v69, v69
    v_exp_f32 v70, v70
    v_exp_f32 v71, v71
    v_exp_f32 v72, v72
    v_exp_f32 v73, v73
    v_exp_f32 v74, v74
    v_exp_f32 v75, v75
    s_waitcnt lgkmcnt(5)
    v_mfma_f32_32x32x16_bf16 v[84:99], v[108:111], v[52:55], 0
    v_cvt_pk_bf16_f32 v68, v68, v69
    v_cvt_pk_bf16_f32 v69, v70, v71
    v_cvt_pk_bf16_f32 v70, v72, v73
    v_cvt_pk_bf16_f32 v71, v74, v75
    v_exp_f32 v76, v76
    v_exp_f32 v77, v77
    s_waitcnt lgkmcnt(4)
    v_mfma_f32_32x32x16_bf16 v[84:99], v[112:115], v[44:47], v[84:99]
    ds_read_b128 v[100:103], v236 offset:9216
    ds_read_b64 v[104:105], v237 offset:2304
    v_exp_f32 v78, v78
    v_exp_f32 v79, v79
    v_exp_f32 v80, v80
    v_exp_f32 v81, v81
    s_waitcnt lgkmcnt(4)
    v_mfma_f32_32x32x16_bf16 v[116:131], v[148:151], v[68:71], v[116:131]
    v_exp_f32 v82, v82
    v_exp_f32 v83, v83
    v_cvt_pk_bf16_f32 v72, v76, v77
    v_cvt_pk_bf16_f32 v73, v78, v79
    v_cvt_pk_bf16_f32 v74, v80, v81
    v_cvt_pk_bf16_f32 v75, v82, v83
    ds_read_b64_tr_b16 v[156:157], v242 offset:20480
    ds_read_b64_tr_b16 v[158:159], v243 offset:20992
    ds_read_b64_tr_b16 v[160:161], v242 offset:21504
    ds_read_b64_tr_b16 v[162:163], v243 offset:22016
    s_waitcnt lgkmcnt(6)
    v_mfma_f32_32x32x16_bf16 v[116:131], v[152:155], v[72:75], v[116:131]
    v_exp_f32 v84, v84
    v_exp_f32 v85, v85
    v_exp_f32 v86, v86
    v_exp_f32 v87, v87
    v_exp_f32 v88, v88
    v_exp_f32 v89, v89
    v_exp_f32 v90, v90
    v_exp_f32 v91, v91
    s_waitcnt lgkmcnt(5)
    v_mfma_f32_32x32x16_bf16 v[68:83], v[100:103], v[52:55], 0
    v_cvt_pk_bf16_f32 v84, v84, v85
    v_cvt_pk_bf16_f32 v85, v86, v87
    v_cvt_pk_bf16_f32 v86, v88, v89
    v_cvt_pk_bf16_f32 v87, v90, v91
    v_exp_f32 v92, v92
    v_exp_f32 v93, v93
    s_waitcnt lgkmcnt(4)
    v_mfma_f32_32x32x16_bf16 v[68:83], v[104:107], v[44:47], v[68:83]
    ds_read_b128 v[108:111], v236 offset:8192
    ds_read_b64 v[112:113], v237 offset:2048
    v_exp_f32 v94, v94
    v_exp_f32 v95, v95
    v_exp_f32 v96, v96
    v_exp_f32 v97, v97
    s_waitcnt lgkmcnt(4)
    v_mfma_f32_32x32x16_bf16 v[116:131], v[156:159], v[84:87], v[116:131]
    v_exp_f32 v98, v98
    v_exp_f32 v99, v99
    v_cvt_pk_bf16_f32 v88, v92, v93
    v_cvt_pk_bf16_f32 v89, v94, v95
    v_cvt_pk_bf16_f32 v90, v96, v97
    v_cvt_pk_bf16_f32 v91, v98, v99
    ds_read_b64_tr_b16 v[148:149], v242 offset:18432
    ds_read_b64_tr_b16 v[150:151], v243 offset:18944
    ds_read_b64_tr_b16 v[152:153], v242 offset:19456
    ds_read_b64_tr_b16 v[154:155], v243 offset:19968
    s_waitcnt lgkmcnt(6)
    v_mfma_f32_32x32x16_bf16 v[116:131], v[160:163], v[88:91], v[116:131]
    v_exp_f32 v68, v68
    v_exp_f32 v69, v69
    v_exp_f32 v70, v70
    v_exp_f32 v71, v71
    v_exp_f32 v72, v72
    v_exp_f32 v73, v73
    v_exp_f32 v74, v74
    v_exp_f32 v75, v75
    s_waitcnt lgkmcnt(5)
    v_mfma_f32_32x32x16_bf16 v[84:99], v[108:111], v[52:55], 0
    v_cvt_pk_bf16_f32 v68, v68, v69
    v_cvt_pk_bf16_f32 v69, v70, v71
    v_cvt_pk_bf16_f32 v70, v72, v73
    v_cvt_pk_bf16_f32 v71, v74, v75
    v_exp_f32 v76, v76
    v_exp_f32 v77, v77
    s_waitcnt lgkmcnt(4)
    v_mfma_f32_32x32x16_bf16 v[84:99], v[112:115], v[44:47], v[84:99]
    ds_read_b128 v[100:103], v236 offset:8192
    ds_read_b64 v[104:105], v237 offset:2048
    v_exp_f32 v78, v78
    v_exp_f32 v79, v79
    v_exp_f32 v80, v80
    v_exp_f32 v81, v81
    s_waitcnt lgkmcnt(4)
    v_mfma_f32_32x32x16_bf16 v[116:131], v[148:151], v[68:71], v[116:131]
    v_exp_f32 v82, v82
    v_exp_f32 v83, v83
    v_cvt_pk_bf16_f32 v72, v76, v77
    v_cvt_pk_bf16_f32 v73, v78, v79
    v_cvt_pk_bf16_f32 v74, v80, v81
    v_cvt_pk_bf16_f32 v75, v82, v83
    ds_read_b64_tr_b16 v[156:157], v242 offset:16384
    ds_read_b64_tr_b16 v[158:159], v243 offset:16896
    ds_read_b64_tr_b16 v[160:161], v242 offset:17408
    ds_read_b64_tr_b16 v[162:163], v243 offset:17920
    s_waitcnt lgkmcnt(6)
    v_mfma_f32_32x32x16_bf16 v[116:131], v[152:155], v[72:75], v[116:131]
    ds_read_b32 v223, v222 offset:0
    v_exp_f32 v84, v84
    v_exp_f32 v85, v85
    v_exp_f32 v86, v86
    v_exp_f32 v87, v87
    v_exp_f32 v88, v88
    v_exp_f32 v89, v89
    v_exp_f32 v90, v90
    v_exp_f32 v91, v91
    s_waitcnt lgkmcnt(6)
    v_mfma_f32_32x32x16_bf16 v[68:83], v[100:103], v[28:31], 0
    v_cvt_pk_bf16_f32 v84, v84, v85
    v_cvt_pk_bf16_f32 v85, v86, v87
    v_cvt_pk_bf16_f32 v86, v88, v89
    v_cvt_pk_bf16_f32 v87, v90, v91
    v_exp_f32 v92, v92
    v_exp_f32 v93, v93
    s_waitcnt lgkmcnt(5)
    v_mfma_f32_32x32x16_bf16 v[68:83], v[104:107], v[48:51], v[68:83]
    v_exp_f32 v94, v94
    v_exp_f32 v95, v95
    v_exp_f32 v96, v96
    v_exp_f32 v97, v97
    s_waitcnt lgkmcnt(3)
    v_mfma_f32_32x32x16_bf16 v[116:131], v[156:159], v[84:87], v[116:131]
    v_exp_f32 v98, v98
    v_exp_f32 v99, v99
    v_cvt_pk_bf16_f32 v88, v92, v93
    v_cvt_pk_bf16_f32 v89, v94, v95
    v_cvt_pk_bf16_f32 v90, v96, v97
    v_cvt_pk_bf16_f32 v91, v98, v99
    ds_read_b64_tr_b16 v[148:149], v242 offset:16384
    ds_read_b64_tr_b16 v[150:151], v243 offset:16896
    ds_read_b64_tr_b16 v[152:153], v242 offset:17408
    ds_read_b64_tr_b16 v[154:155], v243 offset:17920
    s_waitcnt lgkmcnt(5)
    v_mfma_f32_32x32x16_bf16 v[116:131], v[160:163], v[88:91], v[116:131]
    s_mov_b64 exec, 0xffffffff
    s_mov_b32 s61, 0
xt_44:
    s_nop 9
    v_subrev_u32 v219, s100, v218
    v_subrev_u32 v219, 1, v219
    v_cmp_le_u32 vcc, 16, v219
    s_nop 4
    s_cbranch_vccz xtd_45
    buffer_load_dword v218, v3, s[4:7], s63 offen sc1
    s_waitcnt vmcnt(0)
    s_add_u32 s61, s61, 1
    s_cmp_lt_u32 s61, s23
    s_cbranch_scc1 xt_44
xtd_45:
    s_add_u32 s40, s62, s100
    v_cmp_ne_u32 vcc, s40, v218
    s_nop 1
    s_cmp_eq_u64 vcc, 0
    s_cselect_b32 s22, 1, 0
    s_mov_b64 exec, -1
    s_lshr_b32 s53, s17, 1
    s_mul_i32 s53, s53, 2560
    s_add_u32 s53, s53, 11091968
    s_and_b32 s52, s17, 1
    s_lshl_b32 s54, s52, 10
    s_lshl_b32 s55, s52, 3
    s_add_u32 s54, s54, s53
    s_add_u32 s55, s55, s53
    s_mul_i32 s52, s18, 40960
    s_add_u32 s48, s54, s52
    s_add_u32 s49, s55, s52
    s_mul_i32 s52, s19, 40960
    s_add_u32 s50, s54, s52
    s_add_u32 s51, s55, s52
    v_mov_b32 v172, 0x7fff0000
    v_cndmask_b32 v172, v172, v1, s[32:33]
    s_mov_b32 s56, 0x21800000
    s_mov_b32 s57, 0x71800000
    s_lshl_b32 s40, s18, 7
    s_lshl_b32 s41, s19, 7
    v_mov_b32 v217, s40
    v_writelane_b32 v217, s41, 1
    s_lshl_b32 s42, s17, 2
    s_add_u32 s42, s42, s21
    s_add_u32 s42, s42, 262144
    s_cmp_lg_u32 s39, 0
    s_cbranch_scc1 res_46
    buffer_load_dwordx2 v[246:247], v244, s[4:7], s34 offen sc1
    buffer_load_dwordx2 v[248:249], v244, s[4:7], s35 offen sc1
    buffer_load_dwordx2 v[250:251], v244, s[4:7], s36 offen sc1
    buffer_load_dwordx2 v[252:253], v244, s[4:7], s37 offen sc1
    buffer_load_dwordx2 v[254:255], v244, s[4:7], s38 offen sc1
    s_load_dwordx2 s[44:45], s[0:1], 40
    s_mov_b32 s46, 0xc00
    s_mov_b32 s47, 0x20000
    v_and_b32 v4, 31, v0
    v_lshlrev_b32 v24, 1, v4
    v_lshrrev_b32 v5, 5, v0
    v_mul_u32_u24 v5, 640, v5
    v_lshl_add_u32 v4, v4, 2, v5
    s_mul_i32 s40, s30, 3840
    s_add_u32 s40, s40, 5242880
    buffer_load_dword v6, v4, s[4:7], s40 offen offset:0 sc1
    buffer_load_dword v7, v4, s[4:7], s40 offen offset:128 sc1
    buffer_load_dword v8, v4, s[4:7], s40 offen offset:256 sc1
    buffer_load_dword v9, v4, s[4:7], s40 offen offset:384 sc1
    buffer_load_dword v10, v4, s[4:7], s40 offen offset:512 sc1
    buffer_load_dword v11, v4, s[4:7], s40 offen offset:1280 sc1
    buffer_load_dword v12, v4, s[4:7], s40 offen offset:1408 sc1
    buffer_load_dword v13, v4, s[4:7], s40 offen offset:1536 sc1
    buffer_load_dword v14, v4, s[4:7], s40 offen offset:1664 sc1
    buffer_load_dword v15, v4, s[4:7], s40 offen offset:1792 sc1
    buffer_load_dword v16, v4, s[4:7], s40 offen offset:2560 sc1
    buffer_load_dword v17, v4, s[4:7], s40 offen offset:2688 sc1
    buffer_load_dword v18, v4, s[4:7], s40 offen offset:2816 sc1
    buffer_load_dword v19, v4, s[4:7], s40 offen offset:2944 sc1
    buffer_load_dword v20, v4, s[4:7], s40 offen offset:3072 sc1
    s_mul_i32 s41, s30, 192
    s_waitcnt lgkmcnt(0)
    buffer_load_ushort v21, v24, s[44:47], s41 offen offset:0
    buffer_load_ushort v22, v24, s[44:47], s41 offen offset:64
    buffer_load_ushort v23, v24, s[44:47], s41 offen offset:128
res_46:
    s_cmp_eq_u32 s16, 0
    s_cbranch_scc1 att1_g0
    s_waitcnt lgkmcnt(4)
    v_cmp_ne_u32 vcc, s100, v223
    s_nop 4
    s_cbranch_vccnz hc_47
hcr_48:
    ds_read_b128 v[108:111], v236 offset:7168
    ds_read_b64 v[112:113], v237 offset:1792
    v_exp_f32 v68, v68
    v_exp_f32 v69, v69
    v_exp_f32 v70, v70
    v_exp_f32 v71, v71
    v_exp_f32 v72, v72
    v_exp_f32 v73, v73
    v_exp_f32 v74, v74
    v_exp_f32 v75, v75
    s_waitcnt lgkmcnt(1)
    v_mfma_f32_32x32x16_bf16 v[84:99], v[108:111], v[52:55], 0
    v_cvt_pk_bf16_f32 v68, v68, v69
    v_cvt_pk_bf16_f32 v69, v70, v71
    v_cvt_pk_bf16_f32 v70, v72, v73
    v_cvt_pk_bf16_f32 v71, v74, v75
    v_exp_f32 v76, v76
    v_exp_f32 v77, v77
    s_waitcnt lgkmcnt(0)
    v_mfma_f32_32x32x16_bf16 v[84:99], v[112:115], v[44:47], v[84:99]
    ds_read_b128 v[100:103], v236 offset:6144
    ds_read_b64 v[104:105], v237 offset:1536
    v_exp_f32 v78, v78
    v_exp_f32 v79, v79
    v_exp_f32 v80, v80
    v_exp_f32 v81, v81
    v_mfma_f32_32x32x16_bf16 v[132:147], v[148:151], v[68:71], v[132:147]
    v_exp_f32 v82, v82
    v_exp_f32 v83, v83
    v_cvt_pk_bf16_f32 v72, v76, v77
    v_cvt_pk_bf16_f32 v73, v78, v79
    v_cvt_pk_bf16_f32 v74, v80, v81
    v_cvt_pk_bf16_f32 v75, v82, v83
    ds_read_b64_tr_b16 v[156:157], v242 offset:14336
    ds_read_b64_tr_b16 v[158:159], v243 offset:14848
    ds_read_b64_tr_b16 v[160:161], v242 offset:15360
    ds_read_b64_tr_b16 v[162:163], v243 offset:15872
    v_mfma_f32_32x32x16_bf16 v[132:147], v[152:155], v[72:75], v[132:147]
    v_exp_f32 v84, v84
    v_exp_f32 v85, v85
    v_exp_f32 v86, v86
    v_exp_f32 v87, v87
    v_exp_f32 v88, v88
    v_exp_f32 v89, v89
    v_exp_f32 v90, v90
    v_exp_f32 v91, v91
    s_waitcnt lgkmcnt(5)
    v_mfma_f32_32x32x16_bf16 v[68:83], v[100:103], v[52:55], v[196:211]
    v_cvt_pk_bf16_f32 v84, v84, v85
    v_cvt_pk_bf16_f32 v85, v86, v87
    v_cvt_pk_bf16_f32 v86, v88, v89
    v_cvt_pk_bf16_f32 v87, v90, v91
    v_exp_f32 v92, v92
    v_exp_f32 v93, v93
    s_waitcnt lgkmcnt(4)
    v_mfma_f32_32x32x16_bf16 v[68:83], v[104:107], v[44:47], v[68:83]
    ds_read_b128 v[108:111], v236 offset:7168
    ds_read_b64 v[112:113], v237 offset:1792
    v_exp_f32 v94, v94
    v_exp_f32 v95, v95
    v_exp_f32 v96, v96
    v_exp_f32 v97, v97
    s_waitcnt lgkmcnt(4)
    v_mfma_f32_32x32x16_bf16 v[116:131], v[156:159], v[84:87], v[116:131]
    v_exp_f32 v98, v98
    v_exp_f32 v99, v99
    v_cvt_pk_bf16_f32 v88, v92, v93
    v_cvt_pk_bf16_f32 v89, v94, v95
    v_cvt_pk_bf16_f32 v90, v96, v97
    v_cvt_pk_bf16_f32 v91, v98, v99
    ds_read_b64_tr_b16 v[148:149], v242 offset:12288
    ds_read_b64_tr_b16 v[150:151], v243 offset:12800
    ds_read_b64_tr_b16 v[152:153], v242 offset:13312
    ds_read_b64_tr_b16 v[154:155], v243 offset:13824
    s_waitcnt lgkmcnt(6)
    v_mfma_f32_32x32x16_bf16 v[116:131], v[160:163], v[88:91], v[116:131]
    v_exp_f32 v68, v68
    v_exp_f32 v69, v69
    v_exp_f32 v70, v70
    v_exp_f32 v71, v71
    v_exp_f32 v72, v72
    v_exp_f32 v73, v73
    v_exp_f32 v74, v74
    v_exp_f32 v75, v75
    s_waitcnt lgkmcnt(5)
    v_mfma_f32_32x32x16_bf16 v[84:99], v[108:111], v[28:31], 0
    v_cvt_pk_bf16_f32 v68, v68, v69
    v_cvt_pk_bf16_f32 v69, v70, v71
    v_cvt_pk_bf16_f32 v70, v72, v73
    v_cvt_pk_bf16_f32 v71, v74, v75
    v_exp_f32 v76, v76
    v_exp_f32 v77, v77
    s_waitcnt lgkmcnt(4)
    v_mfma_f32_32x32x16_bf16 v[84:99], v[112:115], v[48:51], v[84:99]
    ds_read_b128 v[100:103], v236 offset:6144
    ds_read_b64 v[104:105], v237 offset:1536
    v_exp_f32 v78, v78
    v_exp_f32 v79, v79
    v_exp_f32 v80, v80
    v_exp_f32 v81, v81
    s_waitcnt lgkmcnt(4)
    v_mfma_f32_32x32x16_bf16 v[116:131], v[148:151], v[68:71], v[116:131]
    v_exp_f32 v82, v82
    v_exp_f32 v83, v83
    v_cvt_pk_bf16_f32 v72, v76, v77
    v_cvt_pk_bf16_f32 v73, v78, v79
    v_cvt_pk_bf16_f32 v74, v80, v81
    v_cvt_pk_bf16_f32 v75, v82, v83
    ds_read_b64_tr_b16 v[156:157], v242 offset:14336
    ds_read_b64_tr_b16 v[158:159], v243 offset:14848
    ds_read_b64_tr_b16 v[160:161], v242 offset:15360
    ds_read_b64_tr_b16 v[162:163], v243 offset:15872
    s_waitcnt lgkmcnt(6)
    v_mfma_f32_32x32x16_bf16 v[116:131], v[152:155], v[72:75], v[116:131]
    v_exp_f32 v84, v84
    v_exp_f32 v85, v85
    v_exp_f32 v86, v86
    v_exp_f32 v87, v87
    v_exp_f32 v88, v88
    v_exp_f32 v89, v89
    v_exp_f32 v90, v90
    v_exp_f32 v91, v91
    s_waitcnt lgkmcnt(5)
    v_mfma_f32_32x32x16_bf16 v[68:83], v[100:103], v[28:31], 0
    v_cvt_pk_bf16_f32 v84, v84, v85
    v_cvt_pk_bf16_f32 v85, v86, v87
    v_cvt_pk_bf16_f32 v86, v88, v89
    v_cvt_pk_bf16_f32 v87, v90, v91
    v_exp_f32 v92, v92
    v_exp_f32 v93, v93
    s_waitcnt lgkmcnt(4)
    v_mfma_f32_32x32x16_bf16 v[68:83], v[104:107], v[48:51], v[68:83]
    ds_read_b128 v[108:111], v236 offset:5120
    ds_read_b64 v[112:113], v237 offset:1280
    v_exp_f32 v94, v94
    v_exp_f32 v95, v95
    v_exp_f32 v96, v96
    v_exp_f32 v97, v97
    s_waitcnt lgkmcnt(4)
    v_mfma_f32_32x32x16_bf16 v[132:147], v[156:159], v[84:87], v[132:147]
    v_exp_f32 v98, v98
    v_exp_f32 v99, v99
    v_cvt_pk_bf16_f32 v88, v92, v93
    v_cvt_pk_bf16_f32 v89, v94, v95
    v_cvt_pk_bf16_f32 v90, v96, v97
    v_cvt_pk_bf16_f32 v91, v98, v99
    ds_read_b64_tr_b16 v[148:149], v242 offset:12288
    ds_read_b64_tr_b16 v[150:151], v243 offset:12800
    ds_read_b64_tr_b16 v[152:153], v242 offset:13312
    ds_read_b64_tr_b16 v[154:155], v243 offset:13824
    s_waitcnt lgkmcnt(6)
    v_mfma_f32_32x32x16_bf16 v[132:147], v[160:163], v[88:91], v[132:147]
    ds_read_b32 v223, v222 offset:16
    v_exp_f32 v68, v68
    v_exp_f32 v69, v69
    v_exp_f32 v70, v70
    v_exp_f32 v71, v71
    v_exp_f32 v72, v72
    v_exp_f32 v73, v73
    v_exp_f32 v74, v74
    v_exp_f32 v75, v75
    s_waitcnt lgkmcnt(6)
    v_mfma_f32_32x32x16_bf16 v[84:99], v[108:111], v[28:31], 0
    v_cvt_pk_bf16_f32 v68, v68, v69
    v_cvt_pk_bf16_f32 v69, v70, v71
    v_cvt_pk_bf16_f32 v70, v72, v73
    v_cvt_pk_bf16_f32 v71, v74, v75
    v_exp_f32 v76, v76
    v_exp_f32 v77, v77
    s_waitcnt lgkmcnt(5)
    v_mfma_f32_32x32x16_bf16 v[84:99], v[112:115], v[48:51], v[84:99]
    v_exp_f32 v78, v78
    v_exp_f32 v79, v79
    v_exp_f32 v80, v80
    v_exp_f32 v81, v81
    s_waitcnt lgkmcnt(3)
    v_mfma_f32_32x32x16_bf16 v[132:147], v[148:151], v[68:71], v[132:147]
    v_exp_f32 v82, v82
    v_exp_f32 v83, v83
    v_cvt_pk_bf16_f32 v72, v76, v77
    v_cvt_pk_bf16_f32 v73, v78, v79
    v_cvt_pk_bf16_f32 v74, v80, v81
    v_cvt_pk_bf16_f32 v75, v82, v83
    ds_read_b64_tr_b16 v[156:157], v242 offset:10240
    ds_read_b64_tr_b16 v[158:159], v243 offset:10752
    ds_read_b64_tr_b16 v[160:161], v242 offset:11264
    ds_read_b64_tr_b16 v[162:163], v243 offset:11776
    s_waitcnt lgkmcnt(5)
    v_mfma_f32_32x32x16_bf16 v[132:147], v[152:155], v[72:75], v[132:147]
    s_waitcnt lgkmcnt(4)
    v_cmp_ne_u32 vcc, s100, v223
    s_nop 4
    s_cbranch_vccnz hc_49
hcr_50:
    ds_read_b128 v[100:103], v236 offset:4096
    ds_read_b64 v[104:105], v237 offset:1024
    v_exp_f32 v84, v84
    v_exp_f32 v85, v85
    v_exp_f32 v86, v86
    v_exp_f32 v87, v87
    v_exp_f32 v88, v88
    v_exp_f32 v89, v89
    v_exp_f32 v90, v90
    v_exp_f32 v91, v91
    s_waitcnt lgkmcnt(1)
    v_mfma_f32_32x32x16_bf16 v[68:83], v[100:103], v[28:31], 0
    v_cvt_pk_bf16_f32 v84, v84, v85
    v_cvt_pk_bf16_f32 v85, v86, v87
    v_cvt_pk_bf16_f32 v86, v88, v89
    v_cvt_pk_bf16_f32 v87, v90, v91
    v_exp_f32 v92, v92
    v_exp_f32 v93, v93
    s_waitcnt lgkmcnt(0)
    v_mfma_f32_32x32x16_bf16 v[68:83], v[104:107], v[48:51], v[68:83]
    ds_read_b128 v[108:111], v236 offset:3072
    ds_read_b64 v[112:113], v237 offset:768
    v_exp_f32 v94, v94
    v_exp_f32 v95, v95
    v_exp_f32 v96, v96
    v_exp_f32 v97, v97
    v_mfma_f32_32x32x16_bf16 v[132:147], v[156:159], v[84:87], v[132:147]
    v_exp_f32 v98, v98
    v_exp_f32 v99, v99
    v_cvt_pk_bf16_f32 v88, v92, v93
    v_cvt_pk_bf16_f32 v89, v94, v95
    v_cvt_pk_bf16_f32 v90, v96, v97
    v_cvt_pk_bf16_f32 v91, v98, v99
    ds_read_b64_tr_b16 v[148:149], v242 offset:8192
    ds_read_b64_tr_b16 v[150:151], v243 offset:8704
    ds_read_b64_tr_b16 v[152:153], v242 offset:9216
    ds_read_b64_tr_b16 v[154:155], v243 offset:9728
    v_mfma_f32_32x32x16_bf16 v[132:147], v[160:163], v[88:91], v[132:147]
    v_exp_f32 v68, v68
    v_exp_f32 v69, v69
    v_exp_f32 v70, v70
    v_exp_f32 v71, v71
    v_exp_f32 v72, v72
    v_exp_f32 v73, v73
    v_exp_f32 v74, v74
    v_exp_f32 v75, v75
    s_waitcnt lgkmcnt(5)
    v_mfma_f32_32x32x16_bf16 v[84:99], v[108:111], v[28:31], 0
    v_cvt_pk_bf16_f32 v68, v68, v69
    v_cvt_pk_bf16_f32 v69, v70, v71
    v_cvt_pk_bf16_f32 v70, v72, v73
    v_cvt_pk_bf16_f32 v71, v74, v75
    v_exp_f32 v76, v76
    v_exp_f32 v77, v77
    s_waitcnt lgkmcnt(4)
    v_mfma_f32_32x32x16_bf16 v[84:99], v[112:115], v[48:51], v[84:99]
    ds_read_b128 v[100:103], v236 offset:2048
    ds_read_b64 v[104:105], v237 offset:512
    v_exp_f32 v78, v78
    v_exp_f32 v79, v79
    v_exp_f32 v80, v80
    v_exp_f32 v81, v81
    s_waitcnt lgkmcnt(4)
    v_mfma_f32_32x32x16_bf16 v[132:147], v[148:151], v[68:71], v[132:147]
    v_exp_f32 v82, v82
    v_exp_f32 v83, v83
    v_cvt_pk_bf16_f32 v72, v76, v77
    v_cvt_pk_bf16_f32 v73, v78, v79
    v_cvt_pk_bf16_f32 v74, v80, v81
    v_cvt_pk_bf16_f32 v75, v82, v83
    ds_read_b64_tr_b16 v[156:157], v242 offset:6144
    ds_read_b64_tr_b16 v[158:159], v243 offset:6656
    ds_read_b64_tr_b16 v[160:161], v242 offset:7168
    ds_read_b64_tr_b16 v[162:163], v243 offset:7680
    s_waitcnt lgkmcnt(6)
    v_mfma_f32_32x32x16_bf16 v[132:147], v[152:155], v[72:75], v[132:147]
    v_exp_f32 v84, v84
    v_exp_f32 v85, v85
    v_exp_f32 v86, v86
    v_exp_f32 v87, v87
    v_exp_f32 v88, v88
    v_exp_f32 v89, v89
    v_exp_f32 v90, v90
    v_exp_f32 v91, v91
    s_waitcnt lgkmcnt(5)
    v_mfma_f32_32x32x16_bf16 v[68:83], v[100:103], v[28:31], 0
    v_cvt_pk_bf16_f32 v84, v84, v85
    v_cvt_pk_bf16_f32 v85, v86, v87
    v_cvt_pk_bf16_f32 v86, v88, v89
    v_cvt_pk_bf16_f32 v87, v90, v91
    v_exp_f32 v92, v92
    v_exp_f32 v93, v93
    s_waitcnt lgkmcnt(4)
    v_mfma_f32_32x32x16_bf16 v[68:83], v[104:107], v[48:51], v[68:83]
    ds_read_b128 v[108:111], v236 offset:1024
    ds_read_b64 v[112:113], v237 offset:256
    v_exp_f32 v94, v94
    v_exp_f32 v95, v95
    v_exp_f32 v96, v96
    v_exp_f32 v97, v97
    s_waitcnt lgkmcnt(4)
    v_mfma_f32_32x32x16_bf16 v[132:147], v[156:159], v[84:87], v[132:147]
    v_exp_f32 v98, v98
    v_exp_f32 v99, v99
    v_cvt_pk_bf16_f32 v88, v92, v93
    v_cvt_pk_bf16_f32 v89, v94, v95
    v_cvt_pk_bf16_f32 v90, v96, v97
    v_cvt_pk_bf16_f32 v91, v98, v99
    ds_read_b64_tr_b16 v[148:149], v242 offset:4096
    ds_read_b64_tr_b16 v[150:151], v243 offset:4608
    ds_read_b64_tr_b16 v[152:153], v242 offset:5120
    ds_read_b64_tr_b16 v[154:155], v243 offset:5632
    s_waitcnt lgkmcnt(6)
    v_mfma_f32_32x32x16_bf16 v[132:147], v[160:163], v[88:91], v[132:147]
    v_exp_f32 v68, v68
    v_exp_f32 v69, v69
    v_exp_f32 v70, v70
    v_exp_f32 v71, v71
    v_exp_f32 v72, v72
    v_exp_f32 v73, v73
    v_exp_f32 v74, v74
    v_exp_f32 v75, v75
    s_waitcnt lgkmcnt(5)
    v_mfma_f32_32x32x16_bf16 v[84:99], v[108:111], v[28:31], v[196:211]
    v_cvt_pk_bf16_f32 v68, v68, v69
    v_cvt_pk_bf16_f32 v69, v70, v71
    v_cvt_pk_bf16_f32 v70, v72, v73
    v_cvt_pk_bf16_f32 v71, v74, v75
    v_exp_f32 v76, v76
    v_exp_f32 v77, v77
    s_waitcnt lgkmcnt(4)
    v_mfma_f32_32x32x16_bf16 v[84:99], v[112:115], v[48:51], v[84:99]
    v_exp_f32 v78, v78
    v_exp_f32 v79, v79
    v_exp_f32 v80, v80
    v_exp_f32 v81, v81
    s_waitcnt lgkmcnt(2)
    v_mfma_f32_32x32x16_bf16 v[132:147], v[148:151], v[68:71], v[132:147]
    v_exp_f32 v82, v82
    v_exp_f32 v83, v83
    v_cvt_pk_bf16_f32 v72, v76, v77
    v_cvt_pk_bf16_f32 v73, v78, v79
    v_cvt_pk_bf16_f32 v74, v80, v81
    v_cvt_pk_bf16_f32 v75, v82, v83
    ds_read_b64_tr_b16 v[156:157], v242 offset:2048
    ds_read_b64_tr_b16 v[158:159], v243 offset:2560
    ds_read_b64_tr_b16 v[160:161], v242 offset:3072
    ds_read_b64_tr_b16 v[162:163], v243 offset:3584
    s_waitcnt lgkmcnt(4)
    v_mfma_f32_32x32x16_bf16 v[132:147], v[152:155], v[72:75], v[132:147]
    v_exp_f32 v84, v84
    v_exp_f32 v85, v85
    v_exp_f32 v86, v86
    v_exp_f32 v87, v87
    v_exp_f32 v88, v88
    v_exp_f32 v89, v89
    v_exp_f32 v90, v90
    v_exp_f32 v91, v91
    v_cvt_pk_bf16_f32 v84, v84, v85
    v_cvt_pk_bf16_f32 v85, v86, v87
    v_cvt_pk_bf16_f32 v86, v88, v89
    v_cvt_pk_bf16_f32 v87, v90, v91
    v_exp_f32 v92, v92
    v_exp_f32 v93, v93
    v_exp_f32 v94, v94
    v_exp_f32 v95, v95
    v_exp_f32 v96, v96
    v_exp_f32 v97, v97
    s_waitcnt lgkmcnt(2)
    v_mfma_f32_32x32x16_bf16 v[132:147], v[156:159], v[84:87], v[132:147]
    v_exp_f32 v98, v98
    v_exp_f32 v99, v99
    v_cvt_pk_bf16_f32 v88, v92, v93
    v_cvt_pk_bf16_f32 v89, v94, v95
    v_cvt_pk_bf16_f32 v90, v96, v97
    v_cvt_pk_bf16_f32 v91, v98, v99
    s_waitcnt lgkmcnt(0)
    s_nop 0
    v_mfma_f32_32x32x16_bf16 v[132:147], v[160:163], v[88:91], v[132:147]
    s_branch att_done
att2:
    ds_write_b128 v236, v[60:63] offset:13312
    ds_write_b64 v238, v[56:57] offset:3328
    ds_write_b64 v239, v[58:59] offset:26624
    ds_write_b64 v240, v[64:65] offset:26624
    ds_write_b64 v241, v[66:67] offset:26624
    ds_write_b128 v236, v[36:39] offset:10240
    ds_write_b64 v238, v[32:33] offset:2560
    ds_write_b64 v239, v[34:35] offset:20480
    ds_write_b64 v240, v[40:41] offset:20480
    ds_write_b64 v241, v[42:43] offset:20480
    v_cndmask_b32 v44, 0, v56, s[32:33]
    v_cndmask_b32 v45, 0, v57, s[32:33]
    v_mov_b32 v46, 0
    v_mov_b32 v47, 0
    v_pk_mul_f32 v[148:149], v[148:149], v[24:25]
    v_pk_mul_f32 v[150:151], v[150:151], v[24:25]
    v_pk_mul_f32 v[152:153], v[152:153], v[24:25]
    v_pk_mul_f32 v[154:155], v[154:155], v[24:25]
    v_cvt_pk_bf16_f32 v28, v148, v149
    v_cvt_pk_bf16_f32 v29, v150, v151
    v_cvt_pk_bf16_f32 v30, v152, v153
    v_cvt_pk_bf16_f32 v31, v154, v155
    v_cndmask_b32 v48, 0, v32, s[32:33]
    v_cndmask_b32 v49, 0, v33, s[32:33]
    v_mov_b32 v50, 0
    v_mov_b32 v51, 0
    v_mov_b32 v106, 0x3f80
    v_mov_b32 v107, 0
    v_mov_b32 v114, 0x3f80
    v_mov_b32 v115, 0
    v_mfma_f32_32x32x16_bf16 v[68:83], v[60:63], v[52:55], v[180:195]
    v_mfma_f32_32x32x16_bf16 v[84:99], v[36:39], v[28:31], v[180:195]
    s_waitcnt lgkmcnt(0)
    ds_read_b64 v[104:105], v237 offset:3328
    ds_read_b64 v[112:113], v237 offset:2560
    ds_read_b64_tr_b16 v[148:149], v242 offset:26624
    ds_read_b64_tr_b16 v[150:151], v243 offset:27136
    ds_read_b64_tr_b16 v[152:153], v242 offset:27648
    ds_read_b64_tr_b16 v[154:155], v243 offset:28160
    s_waitcnt lgkmcnt(5)
    v_mfma_f32_32x32x16_bf16 v[68:83], v[104:107], v[44:47], v[68:83]
    s_waitcnt lgkmcnt(4)
    v_mfma_f32_32x32x16_bf16 v[84:99], v[112:115], v[48:51], v[84:99]
    s_lshl_b32 s40, s39, 5
    s_add_u32 s40, s40, 104448
    v_and_b32 v222, 3, v0
    v_lshl_add_u32 v222, v222, 2, s40
    s_waitcnt vmcnt(4)
    s_mov_b64 exec, 1
    buffer_store_dword v216, v217, s[4:7], s47 offen sc1
    s_mov_b64 exec, -1
    s_barrier
    s_nop 0
    v_max3_f32 v164, v68, v69, v70
    v_max3_f32 v165, v71, v72, v73
    v_max3_f32 v164, v164, v74, v75
    v_max3_f32 v165, v165, v76, v77
    v_max3_f32 v164, v164, v78, v79
    v_max3_f32 v165, v165, v80, v81
    v_max3_f32 v164, v164, v82, v83
    v_max_f32 v164, v164, v165
    v_mov_b32 v165, v164
    v_max3_f32 v168, v84, v85, v86
    v_max3_f32 v169, v87, v88, v89
    v_max3_f32 v168, v168, v90, v91
    v_max3_f32 v169, v169, v92, v93
    v_max3_f32 v168, v168, v94, v95
    v_max3_f32 v169, v169, v96, v97
    v_max3_f32 v168, v168, v98, v99
    v_max_f32 v168, v168, v169
    v_mov_b32 v169, v168
    v_permlane32_swap_b32 v164, v165
    s_nop 0
    v_permlane32_swap_b32 v168, v169
    v_max_f32 v164, v164, v165
    v_cvt_pk_bf16_f32 v164, -v164, 0
    v_cndmask_b32 v46, 0, v164, s[32:33]
    v_lshlrev_b32 v166, 16, v164
    v_mov_b32 v167, v166
    v_pk_add_f32 v[68:69], v[68:69], v[166:167]
    v_pk_add_f32 v[70:71], v[70:71], v[166:167]
    v_pk_add_f32 v[72:73], v[72:73], v[166:167]
    v_pk_add_f32 v[74:75], v[74:75], v[166:167]
    v_pk_add_f32 v[76:77], v[76:77], v[166:167]
    v_pk_add_f32 v[78:79], v[78:79], v[166:167]
    v_pk_add_f32 v[80:81], v[80:81], v[166:167]
    v_pk_add_f32 v[82:83], v[82:83], v[166:167]
    v_max_f32 v168, v168, v169
    v_cvt_pk_bf16_f32 v168, -v168, 0
    v_cndmask_b32 v50, 0, v168, s[32:33]
    v_lshlrev_b32 v170, 16, v168
    v_mov_b32 v171, v170
    v_pk_add_f32 v[84:85], v[84:85], v[170:171]
    v_pk_add_f32 v[86:87], v[86:87], v[170:171]
    v_pk_add_f32 v[88:89], v[88:89], v[170:171]
    v_pk_add_f32 v[90:91], v[90:91], v[170:171]
    v_pk_add_f32 v[92:93], v[92:93], v[170:171]
    v_pk_add_f32 v[94:95], v[94:95], v[170:171]
    v_pk_add_f32 v[96:97], v[96:97], v[170:171]
    v_pk_add_f32 v[98:99], v[98:99], v[170:171]
    v_exp_f32 v68, v68
    v_exp_f32 v69, v69
    v_exp_f32 v70, v70
    v_exp_f32 v71, v71
    v_exp_f32 v72, v72
    v_exp_f32 v73, v73
    v_exp_f32 v74, v74
    v_exp_f32 v75, v75
    v_cvt_pk_bf16_f32 v68, v68, v69
    v_cvt_pk_bf16_f32 v69, v70, v71
    v_cvt_pk_bf16_f32 v70, v72, v73
    v_cvt_pk_bf16_f32 v71, v74, v75
    v_exp_f32 v76, v76
    v_exp_f32 v77, v77
    ds_read_b128 v[100:103], v236 offset:12288
    ds_read_b64 v[104:105], v237 offset:3072
    v_exp_f32 v78, v78
    v_exp_f32 v79, v79
    v_exp_f32 v80, v80
    v_exp_f32 v81, v81
    s_waitcnt lgkmcnt(4)
    v_mfma_f32_32x32x16_bf16 v[116:131], v[148:151], v[68:71], 0
    v_exp_f32 v82, v82
    v_exp_f32 v83, v83
    v_cvt_pk_bf16_f32 v72, v76, v77
    v_cvt_pk_bf16_f32 v73, v78, v79
    v_cvt_pk_bf16_f32 v74, v80, v81
    v_cvt_pk_bf16_f32 v75, v82, v83
    ds_read_b64_tr_b16 v[156:157], v242 offset:20480
    ds_read_b64_tr_b16 v[158:159], v243 offset:20992
    ds_read_b64_tr_b16 v[160:161], v242 offset:21504
    ds_read_b64_tr_b16 v[162:163], v243 offset:22016
    s_waitcnt lgkmcnt(6)
    v_mfma_f32_32x32x16_bf16 v[116:131], v[152:155], v[72:75], v[116:131]
    v_exp_f32 v84, v84
    v_exp_f32 v85, v85
    v_exp_f32 v86, v86
    v_exp_f32 v87, v87
    v_exp_f32 v88, v88
    v_exp_f32 v89, v89
    v_exp_f32 v90, v90
    v_exp_f32 v91, v91
    s_waitcnt lgkmcnt(5)
    v_mfma_f32_32x32x16_bf16 v[68:83], v[100:103], v[52:55], 0
    v_cvt_pk_bf16_f32 v84, v84, v85
    v_cvt_pk_bf16_f32 v85, v86, v87
    v_cvt_pk_bf16_f32 v86, v88, v89
    v_cvt_pk_bf16_f32 v87, v90, v91
    v_exp_f32 v92, v92
    v_exp_f32 v93, v93
    s_waitcnt lgkmcnt(4)
    v_mfma_f32_32x32x16_bf16 v[68:83], v[104:107], v[44:47], v[68:83]
    ds_read_b128 v[108:111], v236 offset:11264
    ds_read_b64 v[112:113], v237 offset:2816
    v_exp_f32 v94, v94
    v_exp_f32 v95, v95
    v_exp_f32 v96, v96
    v_exp_f32 v97, v97
    s_waitcnt lgkmcnt(4)
    v_mfma_f32_32x32x16_bf16 v[132:147], v[156:159], v[84:87], 0
    v_exp_f32 v98, v98
    v_exp_f32 v99, v99
    v_cvt_pk_bf16_f32 v88, v92, v93
    v_cvt_pk_bf16_f32 v89, v94, v95
    v_cvt_pk_bf16_f32 v90, v96, v97
    v_cvt_pk_bf16_f32 v91, v98, v99
    ds_read_b64_tr_b16 v[148:149], v242 offset:24576
    ds_read_b64_tr_b16 v[150:151], v243 offset:25088
    ds_read_b64_tr_b16 v[152:153], v242 offset:25600
    ds_read_b64_tr_b16 v[154:155], v243 offset:26112
    s_waitcnt lgkmcnt(6)
    v_mfma_f32_32x32x16_bf16 v[132:147], v[160:163], v[88:91], v[132:147]
    v_exp_f32 v68, v68
    v_exp_f32 v69, v69
    v_exp_f32 v70, v70
    v_exp_f32 v71, v71
    v_exp_f32 v72, v72
    v_exp_f32 v73, v73
    v_exp_f32 v74, v74
    v_exp_f32 v75, v75
    s_waitcnt lgkmcnt(5)
    v_mfma_f32_32x32x16_bf16 v[84:99], v[108:111], v[52:55], 0
    v_cvt_pk_bf16_f32 v68, v68, v69
    v_cvt_pk_bf16_f32 v69, v70, v71
    v_cvt_pk_bf16_f32 v70, v72, v73
    v_cvt_pk_bf16_f32 v71, v74, v75
    v_exp_f32 v76, v76
    v_exp_f32 v77, v77
    s_waitcnt lgkmcnt(4)
    v_mfma_f32_32x32x16_bf16 v[84:99], v[112:115], v[44:47], v[84:99]
    ds_read_b128 v[100:103], v236 offset:10240
    ds_read_b64 v[104:105], v237 offset:2560
    v_exp_f32 v78, v78
    v_exp_f32 v79, v79
    v_exp_f32 v80, v80
    v_exp_f32 v81, v81
    s_waitcnt lgkmcnt(4)
    v_mfma_f32_32x32x16_bf16 v[116:131], v[148:151], v[68:71], v[116:131]
    v_exp_f32 v82, v82
    v_exp_f32 v83, v83
    v_cvt_pk_bf16_f32 v72, v76, v77
    v_cvt_pk_bf16_f32 v73, v78, v79
    v_cvt_pk_bf16_f32 v74, v80, v81
    v_cvt_pk_bf16_f32 v75, v82, v83
    ds_read_b64_tr_b16 v[156:157], v242 offset:22528
    ds_read_b64_tr_b16 v[158:159], v243 offset:23040
    ds_read_b64_tr_b16 v[160:161], v242 offset:23552
    ds_read_b64_tr_b16 v[162:163], v243 offset:24064
    s_waitcnt lgkmcnt(6)
    v_mfma_f32_32x32x16_bf16 v[116:131], v[152:155], v[72:75], v[116:131]
    s_waitcnt vmcnt(0)
    s_mov_b64 exec, 1
    buffer_store_dword v216, v217, s[4:7], s47 offen offset:64 sc1
    s_mov_b64 exec, -1
    v_exp_f32 v84, v84
    v_exp_f32 v85, v85
    v_exp_f32 v86, v86
    v_exp_f32 v87, v87
    v_exp_f32 v88, v88
    v_exp_f32 v89, v89
    v_exp_f32 v90, v90
    v_exp_f32 v91, v91
    s_waitcnt lgkmcnt(5)
    v_mfma_f32_32x32x16_bf16 v[68:83], v[100:103], v[52:55], 0
    v_cvt_pk_bf16_f32 v84, v84, v85
    v_cvt_pk_bf16_f32 v85, v86, v87
    v_cvt_pk_bf16_f32 v86, v88, v89
    v_cvt_pk_bf16_f32 v87, v90, v91
    v_exp_f32 v92, v92
    v_exp_f32 v93, v93
    s_waitcnt lgkmcnt(4)
    v_mfma_f32_32x32x16_bf16 v[68:83], v[104:107], v[44:47], v[68:83]
    ds_read_b128 v[108:111], v236 offset:9216
    ds_read_b64 v[112:113], v237 offset:2304
    v_exp_f32 v94, v94
    v_exp_f32 v95, v95
    v_exp_f32 v96, v96
    v_exp_f32 v97, v97
    s_waitcnt lgkmcnt(4)
    v_mfma_f32_32x32x16_bf16 v[116:131], v[156:159], v[84:87], v[116:131]
    v_exp_f32 v98, v98
    v_exp_f32 v99, v99
    v_cvt_pk_bf16_f32 v88, v92, v93
    v_cvt_pk_bf16_f32 v89, v94, v95
    v_cvt_pk_bf16_f32 v90, v96, v97
    v_cvt_pk_bf16_f32 v91, v98, v99
    ds_read_b64_tr_b16 v[148:149], v242 offset:20480
    ds_read_b64_tr_b16 v[150:151], v243 offset:20992
    ds_read_b64_tr_b16 v[152:153], v242 offset:21504
    ds_read_b64_tr_b16 v[154:155], v243 offset:22016
    s_waitcnt lgkmcnt(6)
    v_mfma_f32_32x32x16_bf16 v[116:131], v[160:163], v[88:91], v[116:131]
    v_exp_f32 v68, v68
    v_exp_f32 v69, v69
    v_exp_f32 v70, v70
    v_exp_f32 v71, v71
    v_exp_f32 v72, v72
    v_exp_f32 v73, v73
    v_exp_f32 v74, v74
    v_exp_f32 v75, v75
    s_waitcnt lgkmcnt(5)
    v_mfma_f32_32x32x16_bf16 v[84:99], v[108:111], v[52:55], 0
    v_cvt_pk_bf16_f32 v68, v68, v69
    v_cvt_pk_bf16_f32 v69, v70, v71
    v_cvt_pk_bf16_f32 v70, v72, v73
    v_cvt_pk_bf16_f32 v71, v74, v75
    v_exp_f32 v76, v76
    v_exp_f32 v77, v77
    s_waitcnt lgkmcnt(4)
    v_mfma_f32_32x32x16_bf16 v[84:99], v[112:115], v[44:47], v[84:99]
    ds_read_b128 v[100:103], v236 offset:8192
    ds_read_b64 v[104:105], v237 offset:2048
    v_exp_f32 v78, v78
    v_exp_f32 v79, v79
    v_exp_f32 v80, v80
    v_exp_f32 v81, v81
    s_waitcnt lgkmcnt(4)
    v_mfma_f32_32x32x16_bf16 v[116:131], v[148:151], v[68:71], v[116:131]
    v_exp_f32 v82, v82
    v_exp_f32 v83, v83
    v_cvt_pk_bf16_f32 v72, v76, v77
    v_cvt_pk_bf16_f32 v73, v78, v79
    v_cvt_pk_bf16_f32 v74, v80, v81
    v_cvt_pk_bf16_f32 v75, v82, v83
    ds_read_b64_tr_b16 v[156:157], v242 offset:18432
    ds_read_b64_tr_b16 v[158:159], v243 offset:18944
    ds_read_b64_tr_b16 v[160:161], v242 offset:19456
    ds_read_b64_tr_b16 v[162:163], v243 offset:19968
    s_waitcnt lgkmcnt(6)
    v_mfma_f32_32x32x16_bf16 v[116:131], v[152:155], v[72:75], v[116:131]
    v_exp_f32 v84, v84
    v_exp_f32 v85, v85
    v_exp_f32 v86, v86
    v_exp_f32 v87, v87
    v_exp_f32 v88, v88
    v_exp_f32 v89, v89
    v_exp_f32 v90, v90
    v_exp_f32 v91, v91
    s_waitcnt lgkmcnt(5)
    v_mfma_f32_32x32x16_bf16 v[68:83], v[100:103], v[52:55], 0
    v_cvt_pk_bf16_f32 v84, v84, v85
    v_cvt_pk_bf16_f32 v85, v86, v87
    v_cvt_pk_bf16_f32 v86, v88, v89
    v_cvt_pk_bf16_f32 v87, v90, v91
    v_exp_f32 v92, v92
    v_exp_f32 v93, v93
    s_waitcnt lgkmcnt(4)
    v_mfma_f32_32x32x16_bf16 v[68:83], v[104:107], v[44:47], v[68:83]
    ds_read_b128 v[108:111], v236 offset:9216
    ds_read_b64 v[112:113], v237 offset:2304
    v_exp_f32 v94, v94
    v_exp_f32 v95, v95
    v_exp_f32 v96, v96
    v_exp_f32 v97, v97
    s_waitcnt lgkmcnt(4)
    v_mfma_f32_32x32x16_bf16 v[116:131], v[156:159], v[84:87], v[116:131]
    v_exp_f32 v98, v98
    v_exp_f32 v99, v99
    v_cvt_pk_bf16_f32 v88, v92, v93
    v_cvt_pk_bf16_f32 v89, v94, v95
    v_cvt_pk_bf16_f32 v90, v96, v97
    v_cvt_pk_bf16_f32 v91, v98, v99
    ds_read_b64_tr_b16 v[148:149], v242 offset:16384
    ds_read_b64_tr_b16 v[150:151], v243 offset:16896
    ds_read_b64_tr_b16 v[152:153], v242 offset:17408
    ds_read_b64_tr_b16 v[154:155], v243 offset:17920
    s_waitcnt lgkmcnt(6)
    v_mfma_f32_32x32x16_bf16 v[116:131], v[160:163], v[88:91], v[116:131]
    v_exp_f32 v68, v68
    v_exp_f32 v69, v69
    v_exp_f32 v70, v70
    v_exp_f32 v71, v71
    v_exp_f32 v72, v72
    v_exp_f32 v73, v73
    v_exp_f32 v74, v74
    v_exp_f32 v75, v75
    s_waitcnt lgkmcnt(5)
    v_mfma_f32_32x32x16_bf16 v[84:99], v[108:111], v[28:31], 0
    v_cvt_pk_bf16_f32 v68, v68, v69
    v_cvt_pk_bf16_f32 v69, v70, v71
    v_cvt_pk_bf16_f32 v70, v72, v73
    v_cvt_pk_bf16_f32 v71, v74, v75
    v_exp_f32 v76, v76
    v_exp_f32 v77, v77
    s_waitcnt lgkmcnt(4)
    v_mfma_f32_32x32x16_bf16 v[84:99], v[112:115], v[48:51], v[84:99]
    ds_read_b128 v[100:103], v236 offset:8192
    ds_read_b64 v[104:105], v237 offset:2048
    v_exp_f32 v78, v78
    v_exp_f32 v79, v79
    v_exp_f32 v80, v80
    v_exp_f32 v81, v81
    s_waitcnt lgkmcnt(4)
    v_mfma_f32_32x32x16_bf16 v[116:131], v[148:151], v[68:71], v[116:131]
    v_exp_f32 v82, v82
    v_exp_f32 v83, v83
    v_cvt_pk_bf16_f32 v72, v76, v77
    v_cvt_pk_bf16_f32 v73, v78, v79
    v_cvt_pk_bf16_f32 v74, v80, v81
    v_cvt_pk_bf16_f32 v75, v82, v83
    ds_read_b64_tr_b16 v[156:157], v242 offset:18432
    ds_read_b64_tr_b16 v[158:159], v243 offset:18944
    ds_read_b64_tr_b16 v[160:161], v242 offset:19456
    ds_read_b64_tr_b16 v[162:163], v243 offset:19968
    s_waitcnt lgkmcnt(6)
    v_mfma_f32_32x32x16_bf16 v[116:131], v[152:155], v[72:75], v[116:131]
    ds_read_b32 v223, v222 offset:0
    v_exp_f32 v84, v84
    v_exp_f32 v85, v85
    v_exp_f32 v86, v86
    v_exp_f32 v87, v87
    v_exp_f32 v88, v88
    v_exp_f32 v89, v89
    v_exp_f32 v90, v90
    v_exp_f32 v91, v91
    s_waitcnt lgkmcnt(6)
    v_mfma_f32_32x32x16_bf16 v[68:83], v[100:103], v[28:31], 0
    v_cvt_pk_bf16_f32 v84, v84, v85
    v_cvt_pk_bf16_f32 v85, v86, v87
    v_cvt_pk_bf16_f32 v86, v88, v89
    v_cvt_pk_bf16_f32 v87, v90, v91
    v_exp_f32 v92, v92
    v_exp_f32 v93, v93
    s_waitcnt lgkmcnt(5)
    v_mfma_f32_32x32x16_bf16 v[68:83], v[104:107], v[48:51], v[68:83]
    v_exp_f32 v94, v94
    v_exp_f32 v95, v95
    v_exp_f32 v96, v96
    v_exp_f32 v97, v97
    s_waitcnt lgkmcnt(3)
    v_mfma_f32_32x32x16_bf16 v[132:147], v[156:159], v[84:87], v[132:147]
    v_exp_f32 v98, v98
    v_exp_f32 v99, v99
    v_cvt_pk_bf16_f32 v88, v92, v93
    v_cvt_pk_bf16_f32 v89, v94, v95
    v_cvt_pk_bf16_f32 v90, v96, v97
    v_cvt_pk_bf16_f32 v91, v98, v99
    ds_read_b64_tr_b16 v[148:149], v242 offset:16384
    ds_read_b64_tr_b16 v[150:151], v243 offset:16896
    ds_read_b64_tr_b16 v[152:153], v242 offset:17408
    ds_read_b64_tr_b16 v[154:155], v243 offset:17920
    s_waitcnt lgkmcnt(5)
    v_mfma_f32_32x32x16_bf16 v[132:147], v[160:163], v[88:91], v[132:147]
    s_mov_b64 exec, 0xffffffff
    s_mov_b32 s61, 0
xt_51:
    s_nop 9
    v_subrev_u32 v219, s100, v218
    v_subrev_u32 v219, 1, v219
    v_cmp_le_u32 vcc, 16, v219
    s_nop 4
    s_cbranch_vccz xtd_52
    buffer_load_dword v218, v3, s[4:7], s63 offen sc1
    s_waitcnt vmcnt(0)
    s_add_u32 s61, s61, 1
    s_cmp_lt_u32 s61, s23
    s_cbranch_scc1 xt_51
xtd_52:
    s_add_u32 s40, s62, s100
    v_cmp_ne_u32 vcc, s40, v218
    s_nop 1
    s_cmp_eq_u64 vcc, 0
    s_cselect_b32 s22, 1, 0
    s_mov_b64 exec, -1
    s_lshr_b32 s53, s17, 1
    s_mul_i32 s53, s53, 2560
    s_add_u32 s53, s53, 11091968
    s_and_b32 s52, s17, 1
    s_lshl_b32 s54, s52, 10
    s_lshl_b32 s55, s52, 3
    s_add_u32 s54, s54, s53
    s_add_u32 s55, s55, s53
    s_mul_i32 s52, s18, 40960
    s_add_u32 s48, s54, s52
    s_add_u32 s49, s55, s52
    s_mul_i32 s52, s19, 40960
    s_add_u32 s50, s54, s52
    s_add_u32 s51, s55, s52
    v_mov_b32 v172, 0x7fff0000
    v_cndmask_b32 v172, v172, v1, s[32:33]
    s_mov_b32 s56, 0x21800000
    s_mov_b32 s57, 0x71800000
    s_lshl_b32 s40, s18, 7
    s_lshl_b32 s41, s19, 7
    v_mov_b32 v217, s40
    v_writelane_b32 v217, s41, 1
    s_lshl_b32 s42, s17, 2
    s_add_u32 s42, s42, s21
    s_add_u32 s42, s42, 262144
    s_cmp_lg_u32 s39, 0
    s_cbranch_scc1 res_53
    buffer_load_dwordx2 v[246:247], v244, s[4:7], s34 offen sc1
    buffer_load_dwordx2 v[248:249], v244, s[4:7], s35 offen sc1
    buffer_load_dwordx2 v[250:251], v244, s[4:7], s36 offen sc1
    buffer_load_dwordx2 v[252:253], v244, s[4:7], s37 offen sc1
    buffer_load_dwordx2 v[254:255], v244, s[4:7], s38 offen sc1
    s_load_dwordx2 s[44:45], s[0:1], 40
    s_mov_b32 s46, 0xc00
    s_mov_b32 s47, 0x20000
    v_and_b32 v4, 31, v0
    v_lshlrev_b32 v24, 1, v4
    v_lshrrev_b32 v5, 5, v0
    v_mul_u32_u24 v5, 640, v5
    v_lshl_add_u32 v4, v4, 2, v5
    s_mul_i32 s40, s30, 3840
    s_add_u32 s40, s40, 5242880
    buffer_load_dword v6, v4, s[4:7], s40 offen offset:0 sc1
    buffer_load_dword v7, v4, s[4:7], s40 offen offset:128 sc1
    buffer_load_dword v8, v4, s[4:7], s40 offen offset:256 sc1
    buffer_load_dword v9, v4, s[4:7], s40 offen offset:384 sc1
    buffer_load_dword v10, v4, s[4:7], s40 offen offset:512 sc1
    buffer_load_dword v11, v4, s[4:7], s40 offen offset:1280 sc1
    buffer_load_dword v12, v4, s[4:7], s40 offen offset:1408 sc1
    buffer_load_dword v13, v4, s[4:7], s40 offen offset:1536 sc1
    buffer_load_dword v14, v4, s[4:7], s40 offen offset:1664 sc1
    buffer_load_dword v15, v4, s[4:7], s40 offen offset:1792 sc1
    buffer_load_dword v16, v4, s[4:7], s40 offen offset:2560 sc1
    buffer_load_dword v17, v4, s[4:7], s40 offen offset:2688 sc1
    buffer_load_dword v18, v4, s[4:7], s40 offen offset:2816 sc1
    buffer_load_dword v19, v4, s[4:7], s40 offen offset:2944 sc1
    buffer_load_dword v20, v4, s[4:7], s40 offen offset:3072 sc1
    s_mul_i32 s41, s30, 192
    s_waitcnt lgkmcnt(0)
    buffer_load_ushort v21, v24, s[44:47], s41 offen offset:0
    buffer_load_ushort v22, v24, s[44:47], s41 offen offset:64
    buffer_load_ushort v23, v24, s[44:47], s41 offen offset:128
res_53:
    s_cmp_eq_u32 s16, 0
    s_cbranch_scc1 att2_g0
    s_waitcnt lgkmcnt(4)
    v_cmp_ne_u32 vcc, s100, v223
    s_nop 4
    s_cbranch_vccnz hc_54
hcr_55:
    ds_read_b128 v[108:111], v236 offset:7168
    ds_read_b64 v[112:113], v237 offset:1792
    v_exp_f32 v68, v68
    v_exp_f32 v69, v69
    v_exp_f32 v70, v70
    v_exp_f32 v71, v71
    v_exp_f32 v72, v72
    v_exp_f32 v73, v73
    v_exp_f32 v74, v74
    v_exp_f32 v75, v75
    s_waitcnt lgkmcnt(1)
    v_mfma_f32_32x32x16_bf16 v[84:99], v[108:111], v[52:55], 0
    v_cvt_pk_bf16_f32 v68, v68, v69
    v_cvt_pk_bf16_f32 v69, v70, v71
    v_cvt_pk_bf16_f32 v70, v72, v73
    v_cvt_pk_bf16_f32 v71, v74, v75
    v_exp_f32 v76, v76
    v_exp_f32 v77, v77
    s_waitcnt lgkmcnt(0)
    v_mfma_f32_32x32x16_bf16 v[84:99], v[112:115], v[44:47], v[84:99]
    ds_read_b128 v[100:103], v236 offset:6144
    ds_read_b64 v[104:105], v237 offset:1536
    v_exp_f32 v78, v78
    v_exp_f32 v79, v79
    v_exp_f32 v80, v80
    v_exp_f32 v81, v81
    v_mfma_f32_32x32x16_bf16 v[132:147], v[148:151], v[68:71], v[132:147]
    v_exp_f32 v82, v82
    v_exp_f32 v83, v83
    v_cvt_pk_bf16_f32 v72, v76, v77
    v_cvt_pk_bf16_f32 v73, v78, v79
    v_cvt_pk_bf16_f32 v74, v80, v81
    v_cvt_pk_bf16_f32 v75, v82, v83
    ds_read_b64_tr_b16 v[156:157], v242 offset:14336
    ds_read_b64_tr_b16 v[158:159], v243 offset:14848
    ds_read_b64_tr_b16 v[160:161], v242 offset:15360
    ds_read_b64_tr_b16 v[162:163], v243 offset:15872
    v_mfma_f32_32x32x16_bf16 v[132:147], v[152:155], v[72:75], v[132:147]
    v_exp_f32 v84, v84
    v_exp_f32 v85, v85
    v_exp_f32 v86, v86
    v_exp_f32 v87, v87
    v_exp_f32 v88, v88
    v_exp_f32 v89, v89
    v_exp_f32 v90, v90
    v_exp_f32 v91, v91
    s_waitcnt lgkmcnt(5)
    v_mfma_f32_32x32x16_bf16 v[68:83], v[100:103], v[52:55], 0
    v_cvt_pk_bf16_f32 v84, v84, v85
    v_cvt_pk_bf16_f32 v85, v86, v87
    v_cvt_pk_bf16_f32 v86, v88, v89
    v_cvt_pk_bf16_f32 v87, v90, v91
    v_exp_f32 v92, v92
    v_exp_f32 v93, v93
    s_waitcnt lgkmcnt(4)
    v_mfma_f32_32x32x16_bf16 v[68:83], v[104:107], v[44:47], v[68:83]
    ds_read_b128 v[108:111], v236 offset:5120
    ds_read_b64 v[112:113], v237 offset:1280
    v_exp_f32 v94, v94
    v_exp_f32 v95, v95
    v_exp_f32 v96, v96
    v_exp_f32 v97, v97
    s_waitcnt lgkmcnt(4)
    v_mfma_f32_32x32x16_bf16 v[116:131], v[156:159], v[84:87], v[116:131]
    v_exp_f32 v98, v98
    v_exp_f32 v99, v99
    v_cvt_pk_bf16_f32 v88, v92, v93
    v_cvt_pk_bf16_f32 v89, v94, v95
    v_cvt_pk_bf16_f32 v90, v96, v97
    v_cvt_pk_bf16_f32 v91, v98, v99
    ds_read_b64_tr_b16 v[148:149], v242 offset:12288
    ds_read_b64_tr_b16 v[150:151], v243 offset:12800
    ds_read_b64_tr_b16 v[152:153], v242 offset:13312
    ds_read_b64_tr_b16 v[154:155], v243 offset:13824
    s_waitcnt lgkmcnt(6)
    v_mfma_f32_32x32x16_bf16 v[116:131], v[160:163], v[88:91], v[116:131]
    v_exp_f32 v68, v68
    v_exp_f32 v69, v69
    v_exp_f32 v70, v70
    v_exp_f32 v71, v71
    v_exp_f32 v72, v72
    v_exp_f32 v73, v73
    v_exp_f32 v74, v74
    v_exp_f32 v75, v75
    s_waitcnt lgkmcnt(5)
    v_mfma_f32_32x32x16_bf16 v[84:99], v[108:111], v[52:55], v[196:211]
    v_cvt_pk_bf16_f32 v68, v68, v69
    v_cvt_pk_bf16_f32 v69, v70, v71
    v_cvt_pk_bf16_f32 v70, v72, v73
    v_cvt_pk_bf16_f32 v71, v74, v75
    v_exp_f32 v76, v76
    v_exp_f32 v77, v77
    s_waitcnt lgkmcnt(4)
    v_mfma_f32_32x32x16_bf16 v[84:99], v[112:115], v[44:47], v[84:99]
    ds_read_b128 v[100:103], v236 offset:7168
    ds_read_b64 v[104:105], v237 offset:1792
    v_exp_f32 v78, v78
    v_exp_f32 v79, v79
    v_exp_f32 v80, v80
    v_exp_f32 v81, v81
    s_waitcnt lgkmcnt(4)
    v_mfma_f32_32x32x16_bf16 v[116:131], v[148:151], v[68:71], v[116:131]
    v_exp_f32 v82, v82
    v_exp_f32 v83, v83
    v_cvt_pk_bf16_f32 v72, v76, v77
    v_cvt_pk_bf16_f32 v73, v78, v79
    v_cvt_pk_bf16_f32 v74, v80, v81
    v_cvt_pk_bf16_f32 v75, v82, v83
    ds_read_b64_tr_b16 v[156:157], v242 offset:10240
    ds_read_b64_tr_b16 v[158:159], v243 offset:10752
    ds_read_b64_tr_b16 v[160:161], v242 offset:11264
    ds_read_b64_tr_b16 v[162:163], v243 offset:11776
    s_waitcnt lgkmcnt(6)
    v_mfma_f32_32x32x16_bf16 v[116:131], v[152:155], v[72:75], v[116:131]
    v_exp_f32 v84, v84
    v_exp_f32 v85, v85
    v_exp_f32 v86, v86
    v_exp_f32 v87, v87
    v_exp_f32 v88, v88
    v_exp_f32 v89, v89
    v_exp_f32 v90, v90
    v_exp_f32 v91, v91
    s_waitcnt lgkmcnt(5)
    v_mfma_f32_32x32x16_bf16 v[68:83], v[100:103], v[28:31], 0
    v_cvt_pk_bf16_f32 v84, v84, v85
    v_cvt_pk_bf16_f32 v85, v86, v87
    v_cvt_pk_bf16_f32 v86, v88, v89
    v_cvt_pk_bf16_f32 v87, v90, v91
    v_exp_f32 v92, v92
    v_exp_f32 v93, v93
    s_waitcnt lgkmcnt(4)
    v_mfma_f32_32x32x16_bf16 v[68:83], v[104:107], v[48:51], v[68:83]
    ds_read_b128 v[108:111], v236 offset:6144
    ds_read_b64 v[112:113], v237 offset:1536
    v_exp_f32 v94, v94
    v_exp_f32 v95, v95
    v_exp_f32 v96, v96
    v_exp_f32 v97, v97
    s_waitcnt lgkmcnt(4)
    v_mfma_f32_32x32x16_bf16 v[116:131], v[156:159], v[84:87], v[116:131]
    v_exp_f32 v98, v98
    v_exp_f32 v99, v99
    v_cvt_pk_bf16_f32 v88, v92, v93
    v_cvt_pk_bf16_f32 v89, v94, v95
    v_cvt_pk_bf16_f32 v90, v96, v97
    v_cvt_pk_bf16_f32 v91, v98, v99
    ds_read_b64_tr_b16 v[148:149], v242 offset:14336
    ds_read_b64_tr_b16 v[150:151], v243 offset:14848
    ds_read_b64_tr_b16 v[152:153], v242 offset:15360
    ds_read_b64_tr_b16 v[154:155], v243 offset:15872
    s_waitcnt lgkmcnt(6)
    v_mfma_f32_32x32x16_bf16 v[116:131], v[160:163], v[88:91], v[116:131]
    ds_read_b32 v223, v222 offset:16
    v_exp_f32 v68, v68
    v_exp_f32 v69, v69
    v_exp_f32 v70, v70
    v_exp_f32 v71, v71
    v_exp_f32 v72, v72
    v_exp_f32 v73, v73
    v_exp_f32 v74, v74
    v_exp_f32 v75, v75
    s_waitcnt lgkmcnt(6)
    v_mfma_f32_32x32x16_bf16 v[84:99], v[108:111], v[28:31], 0
    v_cvt_pk_bf16_f32 v68, v68, v69
    v_cvt_pk_bf16_f32 v69, v70, v71
    v_cvt_pk_bf16_f32 v70, v72, v73
    v_cvt_pk_bf16_f32 v71, v74, v75
    v_exp_f32 v76, v76
    v_exp_f32 v77, v77
    s_waitcnt lgkmcnt(5)
    v_mfma_f32_32x32x16_bf16 v[84:99], v[112:115], v[48:51], v[84:99]
    v_exp_f32 v78, v78
    v_exp_f32 v79, v79
    v_exp_f32 v80, v80
    v_exp_f32 v81, v81
    s_waitcnt lgkmcnt(3)
    v_mfma_f32_32x32x16_bf16 v[132:147], v[148:151], v[68:71], v[132:147]
    v_exp_f32 v82, v82
    v_exp_f32 v83, v83
    v_cvt_pk_bf16_f32 v72, v76, v77
    v_cvt_pk_bf16_f32 v73, v78, v79
    v_cvt_pk_bf16_f32 v74, v80, v81
    v_cvt_pk_bf16_f32 v75, v82, v83
    ds_read_b64_tr_b16 v[156:157], v242 offset:12288
    ds_read_b64_tr_b16 v[158:159], v243 offset:12800
    ds_read_b64_tr_b16 v[160:161], v242 offset:13312
    ds_read_b64_tr_b16 v[162:163], v243 offset:13824
    s_waitcnt lgkmcnt(5)
    v_mfma_f32_32x32x16_bf16 v[132:147], v[152:155], v[72:75], v[132:147]
    s_waitcnt lgkmcnt(4)
    v_cmp_ne_u32 vcc, s100, v223
    s_nop 4
    s_cbranch_vccnz hc_56
hcr_57:
    ds_read_b128 v[100:103], v236 offset:5120
    ds_read_b64 v[104:105], v237 offset:1280
    v_exp_f32 v84, v84
    v_exp_f32 v85, v85
    v_exp_f32 v86, v86
    v_exp_f32 v87, v87
    v_exp_f32 v88, v88
    v_exp_f32 v89, v89
    v_exp_f32 v90, v90
    v_exp_f32 v91, v91
    s_waitcnt lgkmcnt(1)
    v_mfma_f32_32x32x16_bf16 v[68:83], v[100:103], v[28:31], 0
    v_cvt_pk_bf16_f32 v84, v84, v85
    v_cvt_pk_bf16_f32 v85, v86, v87
    v_cvt_pk_bf16_f32 v86, v88, v89
    v_cvt_pk_bf16_f32 v87, v90, v91
    v_exp_f32 v92, v92
    v_exp_f32 v93, v93
    s_waitcnt lgkmcnt(0)
    v_mfma_f32_32x32x16_bf16 v[68:83], v[104:107], v[48:51], v[68:83]
    ds_read_b128 v[108:111], v236 offset:4096
    ds_read_b64 v[112:113], v237 offset:1024
    v_exp_f32 v94, v94
    v_exp_f32 v95, v95
    v_exp_f32 v96, v96
    v_exp_f32 v97, v97
    v_mfma_f32_32x32x16_bf16 v[132:147], v[156:159], v[84:87], v[132:147]
    v_exp_f32 v98, v98
    v_exp_f32 v99, v99
    v_cvt_pk_bf16_f32 v88, v92, v93
    v_cvt_pk_bf16_f32 v89, v94, v95
    v_cvt_pk_bf16_f32 v90, v96, v97
    v_cvt_pk_bf16_f32 v91, v98, v99
    ds_read_b64_tr_b16 v[148:149], v242 offset:10240
    ds_read_b64_tr_b16 v[150:151], v243 offset:10752
    ds_read_b64_tr_b16 v[152:153], v242 offset:11264
    ds_read_b64_tr_b16 v[154:155], v243 offset:11776
    v_mfma_f32_32x32x16_bf16 v[132:147], v[160:163], v[88:91], v[132:147]
    v_exp_f32 v68, v68
    v_exp_f32 v69, v69
    v_exp_f32 v70, v70
    v_exp_f32 v71, v71
    v_exp_f32 v72, v72
    v_exp_f32 v73, v73
    v_exp_f32 v74, v74
    v_exp_f32 v75, v75
    s_waitcnt lgkmcnt(5)
    v_mfma_f32_32x32x16_bf16 v[84:99], v[108:111], v[28:31], 0
    v_cvt_pk_bf16_f32 v68, v68, v69
    v_cvt_pk_bf16_f32 v69, v70, v71
    v_cvt_pk_bf16_f32 v70, v72, v73
    v_cvt_pk_bf16_f32 v71, v74, v75
    v_exp_f32 v76, v76
    v_exp_f32 v77, v77
    s_waitcnt lgkmcnt(4)
    v_mfma_f32_32x32x16_bf16 v[84:99], v[112:115], v[48:51], v[84:99]
    ds_read_b128 v[100:103], v236 offset:3072
    ds_read_b64 v[104:105], v237 offset:768
    v_exp_f32 v78, v78
    v_exp_f32 v79, v79
    v_exp_f32 v80, v80
    v_exp_f32 v81, v81
    s_waitcnt lgkmcnt(4)
    v_mfma_f32_32x32x16_bf16 v[132:147], v[148:151], v[68:71], v[132:147]
    v_exp_f32 v82, v82
    v_exp_f32 v83, v83
    v_cvt_pk_bf16_f32 v72, v76, v77
    v_cvt_pk_bf16_f32 v73, v78, v79
    v_cvt_pk_bf16_f32 v74, v80, v81
    v_cvt_pk_bf16_f32 v75, v82, v83
    ds_read_b64_tr_b16 v[156:157], v242 offset:8192
    ds_read_b64_tr_b16 v[158:159], v243 offset:8704
    ds_read_b64_tr_b16 v[160:161], v242 offset:9216
    ds_read_b64_tr_b16 v[162:163], v243 offset:9728
    s_waitcnt lgkmcnt(6)
    v_mfma_f32_32x32x16_bf16 v[132:147], v[152:155], v[72:75], v[132:147]
    v_exp_f32 v84, v84
    v_exp_f32 v85, v85
    v_exp_f32 v86, v86
    v_exp_f32 v87, v87
    v_exp_f32 v88, v88
    v_exp_f32 v89, v89
    v_exp_f32 v90, v90
    v_exp_f32 v91, v91
    s_waitcnt lgkmcnt(5)
    v_mfma_f32_32x32x16_bf16 v[68:83], v[100:103], v[28:31], 0
    v_cvt_pk_bf16_f32 v84, v84, v85
    v_cvt_pk_bf16_f32 v85, v86, v87
    v_cvt_pk_bf16_f32 v86, v88, v89
    v_cvt_pk_bf16_f32 v87, v90, v91
    v_exp_f32 v92, v92
    v_exp_f32 v93, v93
    s_waitcnt lgkmcnt(4)
    v_mfma_f32_32x32x16_bf16 v[68:83], v[104:107], v[48:51], v[68:83]
    ds_read_b128 v[108:111], v236 offset:2048
    ds_read_b64 v[112:113], v237 offset:512
    v_exp_f32 v94, v94
    v_exp_f32 v95, v95
    v_exp_f32 v96, v96
    v_exp_f32 v97, v97
    s_waitcnt lgkmcnt(4)
    v_mfma_f32_32x32x16_bf16 v[132:147], v[156:159], v[84:87], v[132:147]
    v_exp_f32 v98, v98
    v_exp_f32 v99, v99
    v_cvt_pk_bf16_f32 v88, v92, v93
    v_cvt_pk_bf16_f32 v89, v94, v95
    v_cvt_pk_bf16_f32 v90, v96, v97
    v_cvt_pk_bf16_f32 v91, v98, v99
    ds_read_b64_tr_b16 v[148:149], v242 offset:6144
    ds_read_b64_tr_b16 v[150:151], v243 offset:6656
    ds_read_b64_tr_b16 v[152:153], v242 offset:7168
    ds_read_b64_tr_b16 v[154:155], v243 offset:7680
    s_waitcnt lgkmcnt(6)
    v_mfma_f32_32x32x16_bf16 v[132:147], v[160:163], v[88:91], v[132:147]
    v_exp_f32 v68, v68
    v_exp_f32 v69, v69
    v_exp_f32 v70, v70
    v_exp_f32 v71, v71
    v_exp_f32 v72, v72
    v_exp_f32 v73, v73
    v_exp_f32 v74, v74
    v_exp_f32 v75, v75
    s_waitcnt lgkmcnt(5)
    v_mfma_f32_32x32x16_bf16 v[84:99], v[108:111], v[28:31], v[196:211]
    v_cvt_pk_bf16_f32 v68, v68, v69
    v_cvt_pk_bf16_f32 v69, v70, v71
    v_cvt_pk_bf16_f32 v70, v72, v73
    v_cvt_pk_bf16_f32 v71, v74, v75
    v_exp_f32 v76, v76
    v_exp_f32 v77, v77
    s_waitcnt lgkmcnt(4)
    v_mfma_f32_32x32x16_bf16 v[84:99], v[112:115], v[48:51], v[84:99]
    v_exp_f32 v78, v78
    v_exp_f32 v79, v79
    v_exp_f32 v80, v80
    v_exp_f32 v81, v81
    s_waitcnt lgkmcnt(2)
    v_mfma_f32_32x32x16_bf16 v[132:147], v[148:151], v[68:71], v[132:147]
    v_exp_f32 v82, v82
    v_exp_f32 v83, v83
    v_cvt_pk_bf16_f32 v72, v76, v77
    v_cvt_pk_bf16_f32 v73, v78, v79
    v_cvt_pk_bf16_f32 v74, v80, v81
    v_cvt_pk_bf16_f32 v75, v82, v83
    ds_read_b64_tr_b16 v[156:157], v242 offset:4096
    ds_read_b64_tr_b16 v[158:159], v243 offset:4608
    ds_read_b64_tr_b16 v[160:161], v242 offset:5120
    ds_read_b64_tr_b16 v[162:163], v243 offset:5632
    s_waitcnt lgkmcnt(4)
    v_mfma_f32_32x32x16_bf16 v[132:147], v[152:155], v[72:75], v[132:147]
    v_exp_f32 v84, v84
    v_exp_f32 v85, v85
    v_exp_f32 v86, v86
    v_exp_f32 v87, v87
    v_exp_f32 v88, v88
    v_exp_f32 v89, v89
    v_exp_f32 v90, v90
    v_exp_f32 v91, v91
    v_cvt_pk_bf16_f32 v84, v84, v85
    v_cvt_pk_bf16_f32 v85, v86, v87
    v_cvt_pk_bf16_f32 v86, v88, v89
    v_cvt_pk_bf16_f32 v87, v90, v91
    v_exp_f32 v92, v92
    v_exp_f32 v93, v93
    v_exp_f32 v94, v94
    v_exp_f32 v95, v95
    v_exp_f32 v96, v96
    v_exp_f32 v97, v97
    s_waitcnt lgkmcnt(2)
    v_mfma_f32_32x32x16_bf16 v[132:147], v[156:159], v[84:87], v[132:147]
    v_exp_f32 v98, v98
    v_exp_f32 v99, v99
    v_cvt_pk_bf16_f32 v88, v92, v93
    v_cvt_pk_bf16_f32 v89, v94, v95
    v_cvt_pk_bf16_f32 v90, v96, v97
    v_cvt_pk_bf16_f32 v91, v98, v99
    s_waitcnt lgkmcnt(0)
    s_nop 0
    v_mfma_f32_32x32x16_bf16 v[132:147], v[160:163], v[88:91], v[132:147]
    s_branch att_done
att3:
    ds_write_b128 v236, v[60:63] offset:12288
    ds_write_b64 v238, v[56:57] offset:3072
    ds_write_b64 v239, v[58:59] offset:24576
    ds_write_b64 v240, v[64:65] offset:24576
    ds_write_b64 v241, v[66:67] offset:24576
    ds_write_b128 v236, v[36:39] offset:11264
    ds_write_b64 v238, v[32:33] offset:2816
    ds_write_b64 v239, v[34:35] offset:22528
    ds_write_b64 v240, v[40:41] offset:22528
    ds_write_b64 v241, v[42:43] offset:22528
    v_cndmask_b32 v44, 0, v56, s[32:33]
    v_cndmask_b32 v45, 0, v57, s[32:33]
    v_mov_b32 v46, 0
    v_mov_b32 v47, 0
    v_pk_mul_f32 v[148:149], v[148:149], v[24:25]
    v_pk_mul_f32 v[150:151], v[150:151], v[24:25]
    v_pk_mul_f32 v[152:153], v[152:153], v[24:25]
    v_pk_mul_f32 v[154:155], v[154:155], v[24:25]
    v_cvt_pk_bf16_f32 v28, v148, v149
    v_cvt_pk_bf16_f32 v29, v150, v151
    v_cvt_pk_bf16_f32 v30, v152, v153
    v_cvt_pk_bf16_f32 v31, v154, v155
    v_cndmask_b32 v48, 0, v32, s[32:33]
    v_cndmask_b32 v49, 0, v33, s[32:33]
    v_mov_b32 v50, 0
    v_mov_b32 v51, 0
    v_mov_b32 v106, 0x3f80
    v_mov_b32 v107, 0
    v_mov_b32 v114, 0x3f80
    v_mov_b32 v115, 0
    v_mfma_f32_32x32x16_bf16 v[68:83], v[60:63], v[52:55], v[180:195]
    v_mfma_f32_32x32x16_bf16 v[84:99], v[36:39], v[28:31], v[180:195]
    s_waitcnt lgkmcnt(0)
    ds_read_b64 v[104:105], v237 offset:3072
    ds_read_b64 v[112:113], v237 offset:2816
    ds_read_b64_tr_b16 v[148:149], v242 offset:24576
    ds_read_b64_tr_b16 v[150:151], v243 offset:25088
    ds_read_b64_tr_b16 v[152:153], v242 offset:25600
    ds_read_b64_tr_b16 v[154:155], v243 offset:26112
    s_waitcnt lgkmcnt(5)
    v_mfma_f32_32x32x16_bf16 v[68:83], v[104:107], v[44:47], v[68:83]
    s_waitcnt lgkmcnt(4)
    v_mfma_f32_32x32x16_bf16 v[84:99], v[112:115], v[48:51], v[84:99]
    s_lshl_b32 s40, s39, 5
    s_add_u32 s40, s40, 104448
    v_and_b32 v222, 3, v0
    v_lshl_add_u32 v222, v222, 2, s40
    s_waitcnt vmcnt(4)
    s_mov_b64 exec, 1
    buffer_store_dword v216, v217, s[4:7], s47 offen sc1
    s_mov_b64 exec, -1
    s_barrier
    s_nop 0
    v_max3_f32 v164, v68, v69, v70
    v_max3_f32 v165, v71, v72, v73
    v_max3_f32 v164, v164, v74, v75
    v_max3_f32 v165, v165, v76, v77
    v_max3_f32 v164, v164, v78, v79
    v_max3_f32 v165, v165, v80, v81
    v_max3_f32 v164, v164, v82, v83
    v_max_f32 v164, v164, v165
    v_mov_b32 v165, v164
    v_max3_f32 v168, v84, v85, v86
    v_max3_f32 v169, v87, v88, v89
    v_max3_f32 v168, v168, v90, v91
    v_max3_f32 v169, v169, v92, v93
    v_max3_f32 v168, v168, v94, v95
    v_max3_f32 v169, v169, v96, v97
    v_max3_f32 v168, v168, v98, v99
    v_max_f32 v168, v168, v169
    v_mov_b32 v169, v168
    v_permlane32_swap_b32 v164, v165
    s_nop 0
    v_permlane32_swap_b32 v168, v169
    v_max_f32 v164, v164, v165
    v_cvt_pk_bf16_f32 v164, -v164, 0
    v_cndmask_b32 v46, 0, v164, s[32:33]
    v_lshlrev_b32 v166, 16, v164
    v_mov_b32 v167, v166
    v_pk_add_f32 v[68:69], v[68:69], v[166:167]
    v_pk_add_f32 v[70:71], v[70:71], v[166:167]
    v_pk_add_f32 v[72:73], v[72:73], v[166:167]
    v_pk_add_f32 v[74:75], v[74:75], v[166:167]
    v_pk_add_f32 v[76:77], v[76:77], v[166:167]
    v_pk_add_f32 v[78:79], v[78:79], v[166:167]
    v_pk_add_f32 v[80:81], v[80:81], v[166:167]
    v_pk_add_f32 v[82:83], v[82:83], v[166:167]
    v_max_f32 v168, v168, v169
    v_cvt_pk_bf16_f32 v168, -v168, 0
    v_cndmask_b32 v50, 0, v168, s[32:33]
    v_lshlrev_b32 v170, 16, v168
    v_mov_b32 v171, v170
    v_pk_add_f32 v[84:85], v[84:85], v[170:171]
    v_pk_add_f32 v[86:87], v[86:87], v[170:171]
    v_pk_add_f32 v[88:89], v[88:89], v[170:171]
    v_pk_add_f32 v[90:91], v[90:91], v[170:171]
    v_pk_add_f32 v[92:93], v[92:93], v[170:171]
    v_pk_add_f32 v[94:95], v[94:95], v[170:171]
    v_pk_add_f32 v[96:97], v[96:97], v[170:171]
    v_pk_add_f32 v[98:99], v[98:99], v[170:171]
    v_exp_f32 v68, v68
    v_exp_f32 v69, v69
    v_exp_f32 v70, v70
    v_exp_f32 v71, v71
    v_exp_f32 v72, v72
    v_exp_f32 v73, v73
    v_exp_f32 v74, v74
    v_exp_f32 v75, v75
    v_cvt_pk_bf16_f32 v68, v68, v69
    v_cvt_pk_bf16_f32 v69, v70, v71
    v_cvt_pk_bf16_f32 v70, v72, v73
    v_cvt_pk_bf16_f32 v71, v74, v75
    v_exp_f32 v76, v76
    v_exp_f32 v77, v77
    ds_read_b128 v[100:103], v236 offset:11264
    ds_read_b64 v[104:105], v237 offset:2816
    v_exp_f32 v78, v78
    v_exp_f32 v79, v79
    v_exp_f32 v80, v80
    v_exp_f32 v81, v81
    s_waitcnt lgkmcnt(4)
    v_mfma_f32_32x32x16_bf16 v[116:131], v[148:151], v[68:71], 0
    v_exp_f32 v82, v82
    v_exp_f32 v83, v83
    v_cvt_pk_bf16_f32 v72, v76, v77
    v_cvt_pk_bf16_f32 v73, v78, v79
    v_cvt_pk_bf16_f32 v74, v80, v81
    v_cvt_pk_bf16_f32 v75, v82, v83
    ds_read_b64_tr_b16 v[156:157], v242 offset:22528
    ds_read_b64_tr_b16 v[158:159], v243 offset:23040
    ds_read_b64_tr_b16 v[160:161], v242 offset:23552
    ds_read_b64_tr_b16 v[162:163], v243 offset:24064
    s_waitcnt lgkmcnt(6)
    v_mfma_f32_32x32x16_bf16 v[116:131], v[152:155], v[72:75], v[116:131]
    v_exp_f32 v84, v84
    v_exp_f32 v85, v85
    v_exp_f32 v86, v86
    v_exp_f32 v87, v87
    v_exp_f32 v88, v88
    v_exp_f32 v89, v89
    v_exp_f32 v90, v90
    v_exp_f32 v91, v91
    s_waitcnt lgkmcnt(5)
    v_mfma_f32_32x32x16_bf16 v[68:83], v[100:103], v[52:55], 0
    v_cvt_pk_bf16_f32 v84, v84, v85
    v_cvt_pk_bf16_f32 v85, v86, v87
    v_cvt_pk_bf16_f32 v86, v88, v89
    v_cvt_pk_bf16_f32 v87, v90, v91
    v_exp_f32 v92, v92
    v_exp_f32 v93, v93
    s_waitcnt lgkmcnt(4)
    v_mfma_f32_32x32x16_bf16 v[68:83], v[104:107], v[44:47], v[68:83]
    ds_read_b128 v[108:111], v236 offset:10240
    ds_read_b64 v[112:113], v237 offset:2560
    v_exp_f32 v94, v94
    v_exp_f32 v95, v95
    v_exp_f32 v96, v96
    v_exp_f32 v97, v97
    s_waitcnt lgkmcnt(4)
    v_mfma_f32_32x32x16_bf16 v[132:147], v[156:159], v[84:87], 0
    v_exp_f32 v98, v98
    v_exp_f32 v99, v99
    v_cvt_pk_bf16_f32 v88, v92, v93
    v_cvt_pk_bf16_f32 v89, v94, v95
    v_cvt_pk_bf16_f32 v90, v96, v97
    v_cvt_pk_bf16_f32 v91, v98, v99
    ds_read_b64_tr_b16 v[148:149], v242 offset:22528
    ds_read_b64_tr_b16 v[150:151], v243 offset:23040
    ds_read_b64_tr_b16 v[152:153], v242 offset:23552
    ds_read_b64_tr_b16 v[154:155], v243 offset:24064
    s_waitcnt lgkmcnt(6)
    v_mfma_f32_32x32x16_bf16 v[132:147], v[160:163], v[88:91], v[132:147]
    v_exp_f32 v68, v68
    v_exp_f32 v69, v69
    v_exp_f32 v70, v70
    v_exp_f32 v71, v71
    v_exp_f32 v72, v72
    v_exp_f32 v73, v73
    v_exp_f32 v74, v74
    v_exp_f32 v75, v75
    s_waitcnt lgkmcnt(5)
    v_mfma_f32_32x32x16_bf16 v[84:99], v[108:111], v[52:55], 0
    v_cvt_pk_bf16_f32 v68, v68, v69
    v_cvt_pk_bf16_f32 v69, v70, v71
    v_cvt_pk_bf16_f32 v70, v72, v73
    v_cvt_pk_bf16_f32 v71, v74, v75
    v_exp_f32 v76, v76
    v_exp_f32 v77, v77
    s_waitcnt lgkmcnt(4)
    v_mfma_f32_32x32x16_bf16 v[84:99], v[112:115], v[44:47], v[84:99]
    ds_read_b128 v[100:103], v236 offset:9216
    ds_read_b64 v[104:105], v237 offset:2304
    v_exp_f32 v78, v78
    v_exp_f32 v79, v79
    v_exp_f32 v80, v80
    v_exp_f32 v81, v81
    s_waitcnt lgkmcnt(4)
    v_mfma_f32_32x32x16_bf16 v[116:131], v[148:151], v[68:71], v[116:131]
    v_exp_f32 v82, v82
    v_exp_f32 v83, v83
    v_cvt_pk_bf16_f32 v72, v76, v77
    v_cvt_pk_bf16_f32 v73, v78, v79
    v_cvt_pk_bf16_f32 v74, v80, v81
    v_cvt_pk_bf16_f32 v75, v82, v83
    ds_read_b64_tr_b16 v[156:157], v242 offset:20480
    ds_read_b64_tr_b16 v[158:159], v243 offset:20992
    ds_read_b64_tr_b16 v[160:161], v242 offset:21504
    ds_read_b64_tr_b16 v[162:163], v243 offset:22016
    s_waitcnt lgkmcnt(6)
    v_mfma_f32_32x32x16_bf16 v[116:131], v[152:155], v[72:75], v[116:131]
    s_waitcnt vmcnt(0)
    s_mov_b64 exec, 1
    buffer_store_dword v216, v217, s[4:7], s47 offen offset:64 sc1
    s_mov_b64 exec, -1
    v_exp_f32 v84, v84
    v_exp_f32 v85, v85
    v_exp_f32 v86, v86
    v_exp_f32 v87, v87
    v_exp_f32 v88, v88
    v_exp_f32 v89, v89
    v_exp_f32 v90, v90
    v_exp_f32 v91, v91
    s_waitcnt lgkmcnt(5)
    v_mfma_f32_32x32x16_bf16 v[68:83], v[100:103], v[52:55], 0
    v_cvt_pk_bf16_f32 v84, v84, v85
    v_cvt_pk_bf16_f32 v85, v86, v87
    v_cvt_pk_bf16_f32 v86, v88, v89
    v_cvt_pk_bf16_f32 v87, v90, v91
    v_exp_f32 v92, v92
    v_exp_f32 v93, v93
    s_waitcnt lgkmcnt(4)
    v_mfma_f32_32x32x16_bf16 v[68:83], v[104:107], v[44:47], v[68:83]
    ds_read_b128 v[108:111], v236 offset:8192
    ds_read_b64 v[112:113], v237 offset:2048
    v_exp_f32 v94, v94
    v_exp_f32 v95, v95
    v_exp_f32 v96, v96
    v_exp_f32 v97, v97
    s_waitcnt lgkmcnt(4)
    v_mfma_f32_32x32x16_bf16 v[116:131], v[156:159], v[84:87], v[116:131]
    v_exp_f32 v98, v98
    v_exp_f32 v99, v99
    v_cvt_pk_bf16_f32 v88, v92, v93
    v_cvt_pk_bf16_f32 v89, v94, v95
    v_cvt_pk_bf16_f32 v90, v96, v97
    v_cvt_pk_bf16_f32 v91, v98, v99
    ds_read_b64_tr_b16 v[148:149], v242 offset:18432
    ds_read_b64_tr_b16 v[150:151], v243 offset:18944
    ds_read_b64_tr_b16 v[152:153], v242 offset:19456
    ds_read_b64_tr_b16 v[154:155], v243 offset:19968
    s_waitcnt lgkmcnt(6)
    v_mfma_f32_32x32x16_bf16 v[116:131], v[160:163], v[88:91], v[116:131]
    v_exp_f32 v68, v68
    v_exp_f32 v69, v69
    v_exp_f32 v70, v70
    v_exp_f32 v71, v71
    v_exp_f32 v72, v72
    v_exp_f32 v73, v73
    v_exp_f32 v74, v74
    v_exp_f32 v75, v75
    s_waitcnt lgkmcnt(5)
    v_mfma_f32_32x32x16_bf16 v[84:99], v[108:111], v[52:55], 0
    v_cvt_pk_bf16_f32 v68, v68, v69
    v_cvt_pk_bf16_f32 v69, v70, v71
    v_cvt_pk_bf16_f32 v70, v72, v73
    v_cvt_pk_bf16_f32 v71, v74, v75
    v_exp_f32 v76, v76
    v_exp_f32 v77, v77
    s_waitcnt lgkmcnt(4)
    v_mfma_f32_32x32x16_bf16 v[84:99], v[112:115], v[44:47], v[84:99]
    ds_read_b128 v[100:103], v236 offset:10240
    ds_read_b64 v[104:105], v237 offset:2560
    v_exp_f32 v78, v78
    v_exp_f32 v79, v79
    v_exp_f32 v80, v80
    v_exp_f32 v81, v81
    s_waitcnt lgkmcnt(4)
    v_mfma_f32_32x32x16_bf16 v[116:131], v[148:151], v[68:71], v[116:131]
    v_exp_f32 v82, v82
    v_exp_f32 v83, v83
    v_cvt_pk_bf16_f32 v72, v76, v77
    v_cvt_pk_bf16_f32 v73, v78, v79
    v_cvt_pk_bf16_f32 v74, v80, v81
    v_cvt_pk_bf16_f32 v75, v82, v83
    ds_read_b64_tr_b16 v[156:157], v242 offset:16384
    ds_read_b64_tr_b16 v[158:159], v243 offset:16896
    ds_read_b64_tr_b16 v[160:161], v242 offset:17408
    ds_read_b64_tr_b16 v[162:163], v243 offset:17920
    s_waitcnt lgkmcnt(6)
    v_mfma_f32_32x32x16_bf16 v[116:131], v[152:155], v[72:75], v[116:131]
    v_exp_f32 v84, v84
    v_exp_f32 v85, v85
    v_exp_f32 v86, v86
    v_exp_f32 v87, v87
    v_exp_f32 v88, v88
    v_exp_f32 v89, v89
    v_exp_f32 v90, v90
    v_exp_f32 v91, v91
    s_waitcnt lgkmcnt(5)
    v_mfma_f32_32x32x16_bf16 v[68:83], v[100:103], v[28:31], 0
    v_cvt_pk_bf16_f32 v84, v84, v85
    v_cvt_pk_bf16_f32 v85, v86, v87
    v_cvt_pk_bf16_f32 v86, v88, v89
    v_cvt_pk_bf16_f32 v87, v90, v91
    v_exp_f32 v92, v92
    v_exp_f32 v93, v93
    s_waitcnt lgkmcnt(4)
    v_mfma_f32_32x32x16_bf16 v[68:83], v[104:107], v[48:51], v[68:83]
    ds_read_b128 v[108:111], v236 offset:9216
    ds_read_b64 v[112:113], v237 offset:2304
    v_exp_f32 v94, v94
    v_exp_f32 v95, v95
    v_exp_f32 v96, v96
    v_exp_f32 v97, v97
    s_waitcnt lgkmcnt(4)
    v_mfma_f32_32x32x16_bf16 v[116:131], v[156:159], v[84:87], v[116:131]
    v_exp_f32 v98, v98
    v_exp_f32 v99, v99
    v_cvt_pk_bf16_f32 v88, v92, v93
    v_cvt_pk_bf16_f32 v89, v94, v95
    v_cvt_pk_bf16_f32 v90, v96, v97
    v_cvt_pk_bf16_f32 v91, v98, v99
    ds_read_b64_tr_b16 v[148:149], v242 offset:20480
    ds_read_b64_tr_b16 v[150:151], v243 offset:20992
    ds_read_b64_tr_b16 v[152:153], v242 offset:21504
    ds_read_b64_tr_b16 v[154:155], v243 offset:22016
    s_waitcnt lgkmcnt(6)
    v_mfma_f32_32x32x16_bf16 v[116:131], v[160:163], v[88:91], v[116:131]
    v_exp_f32 v68, v68
    v_exp_f32 v69, v69
    v_exp_f32 v70, v70
    v_exp_f32 v71, v71
    v_exp_f32 v72, v72
    v_exp_f32 v73, v73
    v_exp_f32 v74, v74
    v_exp_f32 v75, v75
    s_waitcnt lgkmcnt(5)
    v_mfma_f32_32x32x16_bf16 v[84:99], v[108:111], v[28:31], 0
    v_cvt_pk_bf16_f32 v68, v68, v69
    v_cvt_pk_bf16_f32 v69, v70, v71
    v_cvt_pk_bf16_f32 v70, v72, v73
    v_cvt_pk_bf16_f32 v71, v74, v75
    v_exp_f32 v76, v76
    v_exp_f32 v77, v77
    s_waitcnt lgkmcnt(4)
    v_mfma_f32_32x32x16_bf16 v[84:99], v[112:115], v[48:51], v[84:99]
    ds_read_b128 v[100:103], v236 offset:8192
    ds_read_b64 v[104:105], v237 offset:2048
    v_exp_f32 v78, v78
    v_exp_f32 v79, v79
    v_exp_f32 v80, v80
    v_exp_f32 v81, v81
    s_waitcnt lgkmcnt(4)
    v_mfma_f32_32x32x16_bf16 v[132:147], v[148:151], v[68:71], v[132:147]
    v_exp_f32 v82, v82
    v_exp_f32 v83, v83
    v_cvt_pk_bf16_f32 v72, v76, v77
    v_cvt_pk_bf16_f32 v73, v78, v79
    v_cvt_pk_bf16_f32 v74, v80, v81
    v_cvt_pk_bf16_f32 v75, v82, v83
    ds_read_b64_tr_b16 v[156:157], v242 offset:18432
    ds_read_b64_tr_b16 v[158:159], v243 offset:18944
    ds_read_b64_tr_b16 v[160:161], v242 offset:19456
    ds_read_b64_tr_b16 v[162:163], v243 offset:19968
    s_waitcnt lgkmcnt(6)
    v_mfma_f32_32x32x16_bf16 v[132:147], v[152:155], v[72:75], v[132:147]
    ds_read_b32 v223, v222 offset:0
    v_exp_f32 v84, v84
    v_exp_f32 v85, v85
    v_exp_f32 v86, v86
    v_exp_f32 v87, v87
    v_exp_f32 v88, v88
    v_exp_f32 v89, v89
    v_exp_f32 v90, v90
    v_exp_f32 v91, v91
    s_waitcnt lgkmcnt(6)
    v_mfma_f32_32x32x16_bf16 v[68:83], v[100:103], v[28:31], 0
    v_cvt_pk_bf16_f32 v84, v84, v85
    v_cvt_pk_bf16_f32 v85, v86, v87
    v_cvt_pk_bf16_f32 v86, v88, v89
    v_cvt_pk_bf16_f32 v87, v90, v91
    v_exp_f32 v92, v92
    v_exp_f32 v93, v93
    s_waitcnt lgkmcnt(5)
    v_mfma_f32_32x32x16_bf16 v[68:83], v[104:107], v[48:51], v[68:83]
    v_exp_f32 v94, v94
    v_exp_f32 v95, v95
    v_exp_f32 v96, v96
    v_exp_f32 v97, v97
    s_waitcnt lgkmcnt(3)
    v_mfma_f32_32x32x16_bf16 v[132:147], v[156:159], v[84:87], v[132:147]
    v_exp_f32 v98, v98
    v_exp_f32 v99, v99
    v_cvt_pk_bf16_f32 v88, v92, v93
    v_cvt_pk_bf16_f32 v89, v94, v95
    v_cvt_pk_bf16_f32 v90, v96, v97
    v_cvt_pk_bf16_f32 v91, v98, v99
    ds_read_b64_tr_b16 v[148:149], v242 offset:16384
    ds_read_b64_tr_b16 v[150:151], v243 offset:16896
    ds_read_b64_tr_b16 v[152:153], v242 offset:17408
    ds_read_b64_tr_b16 v[154:155], v243 offset:17920
    s_waitcnt lgkmcnt(5)
    v_mfma_f32_32x32x16_bf16 v[132:147], v[160:163], v[88:91], v[132:147]
    s_mov_b64 exec, 0xffffffff
    s_mov_b32 s61, 0
xt_58:
    s_nop 9
    v_subrev_u32 v219, s100, v218
    v_subrev_u32 v219, 1, v219
    v_cmp_le_u32 vcc, 16, v219
    s_nop 4
    s_cbranch_vccz xtd_59
    buffer_load_dword v218, v3, s[4:7], s63 offen sc1
    s_waitcnt vmcnt(0)
    s_add_u32 s61, s61, 1
    s_cmp_lt_u32 s61, s23
    s_cbranch_scc1 xt_58
xtd_59:
    s_add_u32 s40, s62, s100
    v_cmp_ne_u32 vcc, s40, v218
    s_nop 1
    s_cmp_eq_u64 vcc, 0
    s_cselect_b32 s22, 1, 0
    s_mov_b64 exec, -1
    s_lshr_b32 s53, s17, 1
    s_mul_i32 s53, s53, 2560
    s_add_u32 s53, s53, 11091968
    s_and_b32 s52, s17, 1
    s_lshl_b32 s54, s52, 10
    s_lshl_b32 s55, s52, 3
    s_add_u32 s54, s54, s53
    s_add_u32 s55, s55, s53
    s_mul_i32 s52, s18, 40960
    s_add_u32 s48, s54, s52
    s_add_u32 s49, s55, s52
    s_mul_i32 s52, s19, 40960
    s_add_u32 s50, s54, s52
    s_add_u32 s51, s55, s52
    v_mov_b32 v172, 0x7fff0000
    v_cndmask_b32 v172, v172, v1, s[32:33]
    s_mov_b32 s56, 0x21800000
    s_mov_b32 s57, 0x71800000
    s_lshl_b32 s40, s18, 7
    s_lshl_b32 s41, s19, 7
    v_mov_b32 v217, s40
    v_writelane_b32 v217, s41, 1
    s_lshl_b32 s42, s17, 2
    s_add_u32 s42, s42, s21
    s_add_u32 s42, s42, 262144
    s_cmp_lg_u32 s39, 0
    s_cbranch_scc1 res_60
    buffer_load_dwordx2 v[246:247], v244, s[4:7], s34 offen sc1
    buffer_load_dwordx2 v[248:249], v244, s[4:7], s35 offen sc1
    buffer_load_dwordx2 v[250:251], v244, s[4:7], s36 offen sc1
    buffer_load_dwordx2 v[252:253], v244, s[4:7], s37 offen sc1
    buffer_load_dwordx2 v[254:255], v244, s[4:7], s38 offen sc1
    s_load_dwordx2 s[44:45], s[0:1], 40
    s_mov_b32 s46, 0xc00
    s_mov_b32 s47, 0x20000
    v_and_b32 v4, 31, v0
    v_lshlrev_b32 v24, 1, v4
    v_lshrrev_b32 v5, 5, v0
    v_mul_u32_u24 v5, 640, v5
    v_lshl_add_u32 v4, v4, 2, v5
    s_mul_i32 s40, s30, 3840
    s_add_u32 s40, s40, 5242880
    buffer_load_dword v6, v4, s[4:7], s40 offen offset:0 sc1
    buffer_load_dword v7, v4, s[4:7], s40 offen offset:128 sc1
    buffer_load_dword v8, v4, s[4:7], s40 offen offset:256 sc1
    buffer_load_dword v9, v4, s[4:7], s40 offen offset:384 sc1
    buffer_load_dword v10, v4, s[4:7], s40 offen offset:512 sc1
    buffer_load_dword v11, v4, s[4:7], s40 offen offset:1280 sc1
    buffer_load_dword v12, v4, s[4:7], s40 offen offset:1408 sc1
    buffer_load_dword v13, v4, s[4:7], s40 offen offset:1536 sc1
    buffer_load_dword v14, v4, s[4:7], s40 offen offset:1664 sc1
    buffer_load_dword v15, v4, s[4:7], s40 offen offset:1792 sc1
    buffer_load_dword v16, v4, s[4:7], s40 offen offset:2560 sc1
    buffer_load_dword v17, v4, s[4:7], s40 offen offset:2688 sc1
    buffer_load_dword v18, v4, s[4:7], s40 offen offset:2816 sc1
    buffer_load_dword v19, v4, s[4:7], s40 offen offset:2944 sc1
    buffer_load_dword v20, v4, s[4:7], s40 offen offset:3072 sc1
    s_mul_i32 s41, s30, 192
    s_waitcnt lgkmcnt(0)
    buffer_load_ushort v21, v24, s[44:47], s41 offen offset:0
    buffer_load_ushort v22, v24, s[44:47], s41 offen offset:64
    buffer_load_ushort v23, v24, s[44:47], s41 offen offset:128
res_60:
    s_cmp_eq_u32 s16, 0
    s_cbranch_scc1 att3_g0
    s_waitcnt lgkmcnt(4)
    v_cmp_ne_u32 vcc, s100, v223
    s_nop 4
    s_cbranch_vccnz hc_61
hcr_62:
    ds_read_b128 v[108:111], v236 offset:7168
    ds_read_b64 v[112:113], v237 offset:1792
    v_exp_f32 v68, v68
    v_exp_f32 v69, v69
    v_exp_f32 v70, v70
    v_exp_f32 v71, v71
    v_exp_f32 v72, v72
    v_exp_f32 v73, v73
    v_exp_f32 v74, v74
    v_exp_f32 v75, v75
    s_waitcnt lgkmcnt(1)
    v_mfma_f32_32x32x16_bf16 v[84:99], v[108:111], v[52:55], 0
    v_cvt_pk_bf16_f32 v68, v68, v69
    v_cvt_pk_bf16_f32 v69, v70, v71
    v_cvt_pk_bf16_f32 v70, v72, v73
    v_cvt_pk_bf16_f32 v71, v74, v75
    v_exp_f32 v76, v76
    v_exp_f32 v77, v77
    s_waitcnt lgkmcnt(0)
    v_mfma_f32_32x32x16_bf16 v[84:99], v[112:115], v[44:47], v[84:99]
    ds_read_b128 v[100:103], v236 offset:6144
    ds_read_b64 v[104:105], v237 offset:1536
    v_exp_f32 v78, v78
    v_exp_f32 v79, v79
    v_exp_f32 v80, v80
    v_exp_f32 v81, v81
    v_mfma_f32_32x32x16_bf16 v[132:147], v[148:151], v[68:71], v[132:147]
    v_exp_f32 v82, v82
    v_exp_f32 v83, v83
    v_cvt_pk_bf16_f32 v72, v76, v77
    v_cvt_pk_bf16_f32 v73, v78, v79
    v_cvt_pk_bf16_f32 v74, v80, v81
    v_cvt_pk_bf16_f32 v75, v82, v83
    ds_read_b64_tr_b16 v[156:157], v242 offset:14336
    ds_read_b64_tr_b16 v[158:159], v243 offset:14848
    ds_read_b64_tr_b16 v[160:161], v242 offset:15360
    ds_read_b64_tr_b16 v[162:163], v243 offset:15872
    v_mfma_f32_32x32x16_bf16 v[132:147], v[152:155], v[72:75], v[132:147]
    v_exp_f32 v84, v84
    v_exp_f32 v85, v85
    v_exp_f32 v86, v86
    v_exp_f32 v87, v87
    v_exp_f32 v88, v88
    v_exp_f32 v89, v89
    v_exp_f32 v90, v90
    v_exp_f32 v91, v91
    s_waitcnt lgkmcnt(5)
    v_mfma_f32_32x32x16_bf16 v[68:83], v[100:103], v[52:55], 0
    v_cvt_pk_bf16_f32 v84, v84, v85
    v_cvt_pk_bf16_f32 v85, v86, v87
    v_cvt_pk_bf16_f32 v86, v88, v89
    v_cvt_pk_bf16_f32 v87, v90, v91
    v_exp_f32 v92, v92
    v_exp_f32 v93, v93
    s_waitcnt lgkmcnt(4)
    v_mfma_f32_32x32x16_bf16 v[68:83], v[104:107], v[44:47], v[68:83]
    ds_read_b128 v[108:111], v236 offset:5120
    ds_read_b64 v[112:113], v237 offset:1280
    v_exp_f32 v94, v94
    v_exp_f32 v95, v95
    v_exp_f32 v96, v96
    v_exp_f32 v97, v97
    s_waitcnt lgkmcnt(4)
    v_mfma_f32_32x32x16_bf16 v[116:131], v[156:159], v[84:87], v[116:131]
    v_exp_f32 v98, v98
    v_exp_f32 v99, v99
    v_cvt_pk_bf16_f32 v88, v92, v93
    v_cvt_pk_bf16_f32 v89, v94, v95
    v_cvt_pk_bf16_f32 v90, v96, v97
    v_cvt_pk_bf16_f32 v91, v98, v99
    ds_read_b64_tr_b16 v[148:149], v242 offset:12288
    ds_read_b64_tr_b16 v[150:151], v243 offset:12800
    ds_read_b64_tr_b16 v[152:153], v242 offset:13312
    ds_read_b64_tr_b16 v[154:155], v243 offset:13824
    s_waitcnt lgkmcnt(6)
    v_mfma_f32_32x32x16_bf16 v[116:131], v[160:163], v[88:91], v[116:131]
    v_exp_f32 v68, v68
    v_exp_f32 v69, v69
    v_exp_f32 v70, v70
    v_exp_f32 v71, v71
    v_exp_f32 v72, v72
    v_exp_f32 v73, v73
    v_exp_f32 v74, v74
    v_exp_f32 v75, v75
    s_waitcnt lgkmcnt(5)
    v_mfma_f32_32x32x16_bf16 v[84:99], v[108:111], v[52:55], 0
    v_cvt_pk_bf16_f32 v68, v68, v69
    v_cvt_pk_bf16_f32 v69, v70, v71
    v_cvt_pk_bf16_f32 v70, v72, v73
    v_cvt_pk_bf16_f32 v71, v74, v75
    v_exp_f32 v76, v76
    v_exp_f32 v77, v77
    s_waitcnt lgkmcnt(4)
    v_mfma_f32_32x32x16_bf16 v[84:99], v[112:115], v[44:47], v[84:99]
    ds_read_b128 v[100:103], v236 offset:4096
    ds_read_b64 v[104:105], v237 offset:1024
    v_exp_f32 v78, v78
    v_exp_f32 v79, v79
    v_exp_f32 v80, v80
    v_exp_f32 v81, v81
    s_waitcnt lgkmcnt(4)
    v_mfma_f32_32x32x16_bf16 v[116:131], v[148:151], v[68:71], v[116:131]
    v_exp_f32 v82, v82
    v_exp_f32 v83, v83
    v_cvt_pk_bf16_f32 v72, v76, v77
    v_cvt_pk_bf16_f32 v73, v78, v79
    v_cvt_pk_bf16_f32 v74, v80, v81
    v_cvt_pk_bf16_f32 v75, v82, v83
    ds_read_b64_tr_b16 v[156:157], v242 offset:10240
    ds_read_b64_tr_b16 v[158:159], v243 offset:10752
    ds_read_b64_tr_b16 v[160:161], v242 offset:11264
    ds_read_b64_tr_b16 v[162:163], v243 offset:11776
    s_waitcnt lgkmcnt(6)
    v_mfma_f32_32x32x16_bf16 v[116:131], v[152:155], v[72:75], v[116:131]
    v_exp_f32 v84, v84
    v_exp_f32 v85, v85
    v_exp_f32 v86, v86
    v_exp_f32 v87, v87
    v_exp_f32 v88, v88
    v_exp_f32 v89, v89
    v_exp_f32 v90, v90
    v_exp_f32 v91, v91
    s_waitcnt lgkmcnt(5)
    v_mfma_f32_32x32x16_bf16 v[68:83], v[100:103], v[52:55], v[196:211]
    v_cvt_pk_bf16_f32 v84, v84, v85
    v_cvt_pk_bf16_f32 v85, v86, v87
    v_cvt_pk_bf16_f32 v86, v88, v89
    v_cvt_pk_bf16_f32 v87, v90, v91
    v_exp_f32 v92, v92
    v_exp_f32 v93, v93
    s_waitcnt lgkmcnt(4)
    v_mfma_f32_32x32x16_bf16 v[68:83], v[104:107], v[44:47], v[68:83]
    ds_read_b128 v[108:111], v236 offset:7168
    ds_read_b64 v[112:113], v237 offset:1792
    v_exp_f32 v94, v94
    v_exp_f32 v95, v95
    v_exp_f32 v96, v96
    v_exp_f32 v97, v97
    s_waitcnt lgkmcnt(4)
    v_mfma_f32_32x32x16_bf16 v[116:131], v[156:159], v[84:87], v[116:131]
    v_exp_f32 v98, v98
    v_exp_f32 v99, v99
    v_cvt_pk_bf16_f32 v88, v92, v93
    v_cvt_pk_bf16_f32 v89, v94, v95
    v_cvt_pk_bf16_f32 v90, v96, v97
    v_cvt_pk_bf16_f32 v91, v98, v99
    ds_read_b64_tr_b16 v[148:149], v242 offset:8192
    ds_read_b64_tr_b16 v[150:151], v243 offset:8704
    ds_read_b64_tr_b16 v[152:153], v242 offset:9216
    ds_read_b64_tr_b16 v[154:155], v243 offset:9728
    s_waitcnt lgkmcnt(6)
    v_mfma_f32_32x32x16_bf16 v[116:131], v[160:163], v[88:91], v[116:131]
    ds_read_b32 v223, v222 offset:16
    v_exp_f32 v68, v68
    v_exp_f32 v69, v69
    v_exp_f32 v70, v70
    v_exp_f32 v71, v71
    v_exp_f32 v72, v72
    v_exp_f32 v73, v73
    v_exp_f32 v74, v74
    v_exp_f32 v75, v75
    s_waitcnt lgkmcnt(6)
    v_mfma_f32_32x32x16_bf16 v[84:99], v[108:111], v[28:31], 0
    v_cvt_pk_bf16_f32 v68, v68, v69
    v_cvt_pk_bf16_f32 v69, v70, v71
    v_cvt_pk_bf16_f32 v70, v72, v73
    v_cvt_pk_bf16_f32 v71, v74, v75
    v_exp_f32 v76, v76
    v_exp_f32 v77, v77
    s_waitcnt lgkmcnt(5)
    v_mfma_f32_32x32x16_bf16 v[84:99], v[112:115], v[48:51], v[84:99]
    v_exp_f32 v78, v78
    v_exp_f32 v79, v79
    v_exp_f32 v80, v80
    v_exp_f32 v81, v81
    s_waitcnt lgkmcnt(3)
    v_mfma_f32_32x32x16_bf16 v[116:131], v[148:151], v[68:71], v[116:131]
    v_exp_f32 v82, v82
    v_exp_f32 v83, v83
    v_cvt_pk_bf16_f32 v72, v76, v77
    v_cvt_pk_bf16_f32 v73, v78, v79
    v_cvt_pk_bf16_f32 v74, v80, v81
    v_cvt_pk_bf16_f32 v75, v82, v83
    ds_read_b64_tr_b16 v[156:157], v242 offset:14336
    ds_read_b64_tr_b16 v[158:159], v243 offset:14848
    ds_read_b64_tr_b16 v[160:161], v242 offset:15360
    ds_read_b64_tr_b16 v[162:163], v243 offset:15872
    s_waitcnt lgkmcnt(5)
    v_mfma_f32_32x32x16_bf16 v[116:131], v[152:155], v[72:75], v[116:131]
    s_waitcnt lgkmcnt(4)
    v_cmp_ne_u32 vcc, s100, v223
    s_nop 4
    s_cbranch_vccnz hc_63
hcr_64:
    ds_read_b128 v[100:103], v236 offset:6144
    ds_read_b64 v[104:105], v237 offset:1536
    v_exp_f32 v84, v84
    v_exp_f32 v85, v85
    v_exp_f32 v86, v86
    v_exp_f32 v87, v87
    v_exp_f32 v88, v88
    v_exp_f32 v89, v89
    v_exp_f32 v90, v90
    v_exp_f32 v91, v91
    s_waitcnt lgkmcnt(1)
    v_mfma_f32_32x32x16_bf16 v[68:83], v[100:103], v[28:31], 0
    v_cvt_pk_bf16_f32 v84, v84, v85
    v_cvt_pk_bf16_f32 v85, v86, v87
    v_cvt_pk_bf16_f32 v86, v88, v89
    v_cvt_pk_bf16_f32 v87, v90, v91
    v_exp_f32 v92, v92
    v_exp_f32 v93, v93
    s_waitcnt lgkmcnt(0)
    v_mfma_f32_32x32x16_bf16 v[68:83], v[104:107], v[48:51], v[68:83]
    ds_read_b128 v[108:111], v236 offset:5120
    ds_read_b64 v[112:113], v237 offset:1280
    v_exp_f32 v94, v94
    v_exp_f32 v95, v95
    v_exp_f32 v96, v96
    v_exp_f32 v97, v97
    v_mfma_f32_32x32x16_bf16 v[132:147], v[156:159], v[84:87], v[132:147]
    v_exp_f32 v98, v98
    v_exp_f32 v99, v99
    v_cvt_pk_bf16_f32 v88, v92, v93
    v_cvt_pk_bf16_f32 v89, v94, v95
    v_cvt_pk_bf16_f32 v90, v96, v97
    v_cvt_pk_bf16_f32 v91, v98, v99
    ds_read_b64_tr_b16 v[148:149], v242 offset:12288
    ds_read_b64_tr_b16 v[150:151], v243 offset:12800
    ds_read_b64_tr_b16 v[152:153], v242 offset:13312
    ds_read_b64_tr_b16 v[154:155], v243 offset:13824
    v_mfma_f32_32x32x16_bf16 v[132:147], v[160:163], v[88:91], v[132:147]
    v_exp_f32 v68, v68
    v_exp_f32 v69, v69
    v_exp_f32 v70, v70
    v_exp_f32 v71, v71
    v_exp_f32 v72, v72
    v_exp_f32 v73, v73
    v_exp_f32 v74, v74
    v_exp_f32 v75, v75
    s_waitcnt lgkmcnt(5)
    v_mfma_f32_32x32x16_bf16 v[84:99], v[108:111], v[28:31], 0
    v_cvt_pk_bf16_f32 v68, v68, v69
    v_cvt_pk_bf16_f32 v69, v70, v71
    v_cvt_pk_bf16_f32 v70, v72, v73
    v_cvt_pk_bf16_f32 v71, v74, v75
    v_exp_f32 v76, v76
    v_exp_f32 v77, v77
    s_waitcnt lgkmcnt(4)
    v_mfma_f32_32x32x16_bf16 v[84:99], v[112:115], v[48:51], v[84:99]
    ds_read_b128 v[100:103], v236 offset:4096
    ds_read_b64 v[104:105], v237 offset:1024
    v_exp_f32 v78, v78
    v_exp_f32 v79, v79
    v_exp_f32 v80, v80
    v_exp_f32 v81, v81
    s_waitcnt lgkmcnt(4)
    v_mfma_f32_32x32x16_bf16 v[132:147], v[148:151], v[68:71], v[132:147]
    v_exp_f32 v82, v82
    v_exp_f32 v83, v83
    v_cvt_pk_bf16_f32 v72, v76, v77
    v_cvt_pk_bf16_f32 v73, v78, v79
    v_cvt_pk_bf16_f32 v74, v80, v81
    v_cvt_pk_bf16_f32 v75, v82, v83
    ds_read_b64_tr_b16 v[156:157], v242 offset:10240
    ds_read_b64_tr_b16 v[158:159], v243 offset:10752
    ds_read_b64_tr_b16 v[160:161], v242 offset:11264
    ds_read_b64_tr_b16 v[162:163], v243 offset:11776
    s_waitcnt lgkmcnt(6)
    v_mfma_f32_32x32x16_bf16 v[132:147], v[152:155], v[72:75], v[132:147]
    v_exp_f32 v84, v84
    v_exp_f32 v85, v85
    v_exp_f32 v86, v86
    v_exp_f32 v87, v87
    v_exp_f32 v88, v88
    v_exp_f32 v89, v89
    v_exp_f32 v90, v90
    v_exp_f32 v91, v91
    s_waitcnt lgkmcnt(5)
    v_mfma_f32_32x32x16_bf16 v[68:83], v[100:103], v[28:31], 0
    v_cvt_pk_bf16_f32 v84, v84, v85
    v_cvt_pk_bf16_f32 v85, v86, v87
    v_cvt_pk_bf16_f32 v86, v88, v89
    v_cvt_pk_bf16_f32 v87, v90, v91
    v_exp_f32 v92, v92
    v_exp_f32 v93, v93
    s_waitcnt lgkmcnt(4)
    v_mfma_f32_32x32x16_bf16 v[68:83], v[104:107], v[48:51], v[68:83]
    ds_read_b128 v[108:111], v236 offset:3072
    ds_read_b64 v[112:113], v237 offset:768
    v_exp_f32 v94, v94
    v_exp_f32 v95, v95
    v_exp_f32 v96, v96
    v_exp_f32 v97, v97
    s_waitcnt lgkmcnt(4)
    v_mfma_f32_32x32x16_bf16 v[132:147], v[156:159], v[84:87], v[132:147]
    v_exp_f32 v98, v98
    v_exp_f32 v99, v99
    v_cvt_pk_bf16_f32 v88, v92, v93
    v_cvt_pk_bf16_f32 v89, v94, v95
    v_cvt_pk_bf16_f32 v90, v96, v97
    v_cvt_pk_bf16_f32 v91, v98, v99
    ds_read_b64_tr_b16 v[148:149], v242 offset:8192
    ds_read_b64_tr_b16 v[150:151], v243 offset:8704
    ds_read_b64_tr_b16 v[152:153], v242 offset:9216
    ds_read_b64_tr_b16 v[154:155], v243 offset:9728
    s_waitcnt lgkmcnt(6)
    v_mfma_f32_32x32x16_bf16 v[132:147], v[160:163], v[88:91], v[132:147]
    v_exp_f32 v68, v68
    v_exp_f32 v69, v69
    v_exp_f32 v70, v70
    v_exp_f32 v71, v71
    v_exp_f32 v72, v72
    v_exp_f32 v73, v73
    v_exp_f32 v74, v74
    v_exp_f32 v75, v75
    s_waitcnt lgkmcnt(5)
    v_mfma_f32_32x32x16_bf16 v[84:99], v[108:111], v[28:31], v[196:211]
    v_cvt_pk_bf16_f32 v68, v68, v69
    v_cvt_pk_bf16_f32 v69, v70, v71
    v_cvt_pk_bf16_f32 v70, v72, v73
    v_cvt_pk_bf16_f32 v71, v74, v75
    v_exp_f32 v76, v76
    v_exp_f32 v77, v77
    s_waitcnt lgkmcnt(4)
    v_mfma_f32_32x32x16_bf16 v[84:99], v[112:115], v[48:51], v[84:99]
    v_exp_f32 v78, v78
    v_exp_f32 v79, v79
    v_exp_f32 v80, v80
    v_exp_f32 v81, v81
    s_waitcnt lgkmcnt(2)
    v_mfma_f32_32x32x16_bf16 v[132:147], v[148:151], v[68:71], v[132:147]
    v_exp_f32 v82, v82
    v_exp_f32 v83, v83
    v_cvt_pk_bf16_f32 v72, v76, v77
    v_cvt_pk_bf16_f32 v73, v78, v79
    v_cvt_pk_bf16_f32 v74, v80, v81
    v_cvt_pk_bf16_f32 v75, v82, v83
    ds_read_b64_tr_b16 v[156:157], v242 offset:6144
    ds_read_b64_tr_b16 v[158:159], v243 offset:6656
    ds_read_b64_tr_b16 v[160:161], v242 offset:7168
    ds_read_b64_tr_b16 v[162:163], v243 offset:7680
    s_waitcnt lgkmcnt(4)
    v_mfma_f32_32x32x16_bf16 v[132:147], v[152:155], v[72:75], v[132:147]
    v_exp_f32 v84, v84
    v_exp_f32 v85, v85
    v_exp_f32 v86, v86
    v_exp_f32 v87, v87
    v_exp_f32 v88, v88
    v_exp_f32 v89, v89
    v_exp_f32 v90, v90
    v_exp_f32 v91, v91
    v_cvt_pk_bf16_f32 v84, v84, v85
    v_cvt_pk_bf16_f32 v85, v86, v87
    v_cvt_pk_bf16_f32 v86, v88, v89
    v_cvt_pk_bf16_f32 v87, v90, v91
    v_exp_f32 v92, v92
    v_exp_f32 v93, v93
    v_exp_f32 v94, v94
    v_exp_f32 v95, v95
    v_exp_f32 v96, v96
    v_exp_f32 v97, v97
    s_waitcnt lgkmcnt(2)
    v_mfma_f32_32x32x16_bf16 v[132:147], v[156:159], v[84:87], v[132:147]
    v_exp_f32 v98, v98
    v_exp_f32 v99, v99
    v_cvt_pk_bf16_f32 v88, v92, v93
    v_cvt_pk_bf16_f32 v89, v94, v95
    v_cvt_pk_bf16_f32 v90, v96, v97
    v_cvt_pk_bf16_f32 v91, v98, v99
    s_waitcnt lgkmcnt(0)
    s_nop 0
    v_mfma_f32_32x32x16_bf16 v[132:147], v[160:163], v[88:91], v[132:147]
att_done:
    s_nop 11
    s_nop 7
    v_mov_b32 v164, v124
    v_mov_b32 v165, v124
    s_nop 1
    v_permlane32_swap_b32 v164, v165
    v_cmp_lt_f32 s[58:59], s56, v165
    v_cmp_gt_f32 vcc, s57, v165
    s_nop 1
    s_and_b64 s[58:59], s[58:59], vcc
    s_cmp_eq_u64 s[58:59], -1
    s_cbranch_scc0 slowA
normA:
    v_rcp_f32 v164, v165
    s_nop 0
    v_mov_b32 v165, v164
    v_pk_mul_f32 v[116:117], v[116:117], v[164:165]
    v_pk_mul_f32 v[118:119], v[118:119], v[164:165]
    v_pk_mul_f32 v[120:121], v[120:121], v[164:165]
    v_pk_mul_f32 v[122:123], v[122:123], v[164:165]
    v_pk_mul_f32 v[124:125], v[124:125], v[164:165]
    v_pk_mul_f32 v[126:127], v[126:127], v[164:165]
    v_cvt_pk_bf16_f32 v116, v116, v117
    v_cvt_pk_bf16_f32 v117, v118, v119
    v_cvt_pk_bf16_f32 v118, v120, v121
    v_cvt_pk_bf16_f32 v119, v122, v123
    v_cvt_pk_bf16_f32 v120, v124, v125
    v_cvt_pk_bf16_f32 v121, v126, v127
    s_cmp_eq_u32 s22, 0
    s_cbranch_scc1 du_65
    buffer_store_dwordx4 v[116:119], v1, s[4:7], s48 offen
    buffer_store_dwordx2 v[120:121], v172, s[4:7], s49 offen offset:2048
dur_66:
    v_mov_b32 v166, v140
    v_mov_b32 v167, v140
    s_nop 1
    v_permlane32_swap_b32 v166, v167
    v_cmp_lt_f32 s[58:59], s56, v167
    v_cmp_gt_f32 vcc, s57, v167
    s_nop 1
    s_and_b64 s[58:59], s[58:59], vcc
    s_cmp_eq_u64 s[58:59], -1
    s_cbranch_scc0 slowB
normB:
    v_rcp_f32 v166, v167
    s_nop 0
    v_mov_b32 v167, v166
    v_pk_mul_f32 v[132:133], v[132:133], v[166:167]
    v_pk_mul_f32 v[134:135], v[134:135], v[166:167]
    v_pk_mul_f32 v[136:137], v[136:137], v[166:167]
    v_pk_mul_f32 v[138:139], v[138:139], v[166:167]
    v_pk_mul_f32 v[140:141], v[140:141], v[166:167]
    v_pk_mul_f32 v[142:143], v[142:143], v[166:167]
    v_cvt_pk_bf16_f32 v132, v132, v133
    v_cvt_pk_bf16_f32 v133, v134, v135
    v_cvt_pk_bf16_f32 v134, v136, v137
    v_cvt_pk_bf16_f32 v135, v138, v139
    v_cvt_pk_bf16_f32 v136, v140, v141
    v_cvt_pk_bf16_f32 v137, v142, v143
    s_cmp_eq_u32 s22, 0
    s_cbranch_scc1 du_67
    buffer_store_dwordx4 v[132:135], v1, s[4:7], s50 offen
    buffer_store_dwordx2 v[136:137], v172, s[4:7], s51 offen offset:2048
dur_68:
    s_waitcnt vmcnt(0)
    s_cmp_eq_u32 s22, 0
    s_cbranch_scc1 du_69
    s_mov_b64 exec, 3
    buffer_store_dword v216, v217, s[4:7], s42 offen
    s_mov_b64 exec, -1
dur_70:
    s_cmp_lg_u32 s39, 0
    s_cbranch_scc1 a1_71
    v_add_f32 v6, v6, v7
    v_add_f32 v6, v6, v8
    v_add_f32 v6, v6, v9
    v_add_f32 v6, v6, v10
    v_mov_b32 v7, v6
    s_nop 1
    v_permlane32_swap_b32 v6, v7
    v_add_f32 v6, v6, v7
    v_sub_f32 v6, 0, v6
    v_cvt_pk_bf16_f32 v8, v6, v6
    v_and_b32 v8, 0xffff0000, v8
    v_sub_f32 v6, v6, v8
    v_cvt_pk_bf16_f32 v9, v6, v6
    v_and_b32 v9, 0xffff0000, v9
    v_sub_f32 v6, v6, v9
    v_cvt_pk_bf16_f32 v6, v6, v6
    v_and_b32 v6, 0xffff, v6
    v_lshrrev_b32 v8, 16, v8
    v_or_b32 v8, v8, v9
    v_lshl_or_b32 v6, v21, 16, v6
    v_cndmask_b32 v229, 0, v8, s[32:33]
    v_cndmask_b32 v230, 0, v6, s[32:33]
    v_add_f32 v11, v11, v12
    v_add_f32 v11, v11, v13
    v_add_f32 v11, v11, v14
    v_add_f32 v11, v11, v15
    v_mov_b32 v12, v11
    s_nop 1
    v_permlane32_swap_b32 v11, v12
    v_add_f32 v11, v11, v12
    v_sub_f32 v11, 0, v11
    v_cvt_pk_bf16_f32 v13, v11, v11
    v_and_b32 v13, 0xffff0000, v13
    v_sub_f32 v11, v11, v13
    v_cvt_pk_bf16_f32 v14, v11, v11
    v_and_b32 v14, 0xffff0000, v14
    v_sub_f32 v11, v11, v14
    v_cvt_pk_bf16_f32 v11, v11, v11
    v_and_b32 v11, 0xffff, v11
    v_lshrrev_b32 v13, 16, v13
    v_or_b32 v13, v13, v14
    v_lshl_or_b32 v11, v22, 16, v11
    v_cndmask_b32 v231, 0, v13, s[32:33]
    v_cndmask_b32 v232, 0, v11, s[32:33]
    v_add_f32 v16, v16, v17
    v_add_f32 v16, v16, v18
    v_add_f32 v16, v16, v19
    v_add_f32 v16, v16, v20
    v_mov_b32 v17, v16
    s_nop 1
    v_permlane32_swap_b32 v16, v17
    v_add_f32 v16, v16, v17
    v_sub_f32 v16, 0, v16
    v_cvt_pk_bf16_f32 v18, v16, v16
    v_and_b32 v18, 0xffff0000, v18
    v_sub_f32 v16, v16, v18
    v_cvt_pk_bf16_f32 v19, v16, v16
    v_and_b32 v19, 0xffff0000, v19
    v_sub_f32 v16, v16, v19
    v_cvt_pk_bf16_f32 v16, v16, v16
    v_and_b32 v16, 0xffff, v16
    v_lshrrev_b32 v18, 16, v18
    v_or_b32 v18, v18, v19
    v_lshl_or_b32 v16, v23, 16, v16
    v_cndmask_b32 v233, 0, v18, s[32:33]
    v_cndmask_b32 v234, 0, v16, s[32:33]
a1_71:
    s_nop 2
    v_add_u32 v5, 61440, v1
    v_add_u32 v6, 122880, v1
    s_mul_i32 s44, s28, 40960
    s_lshl_b32 s45, s29, 8
    s_add_u32 s44, s44, s45
    s_add_u32 s44, s44, 11091968
    v_lshlrev_b32 v16, 16, v246
    v_and_b32 v17, 0xffff0000, v246
    v_lshlrev_b32 v18, 16, v247
    v_and_b32 v19, 0xffff0000, v247
    v_lshlrev_b32 v20, 16, v248
    v_and_b32 v21, 0xffff0000, v248
    v_lshlrev_b32 v22, 16, v249
    v_and_b32 v23, 0xffff0000, v249
    v_lshlrev_b32 v24, 16, v250
    v_and_b32 v25, 0xffff0000, v250
    v_lshlrev_b32 v26, 16, v251
    v_and_b32 v27, 0xffff0000, v251
    v_lshlrev_b32 v28, 16, v252
    v_and_b32 v29, 0xffff0000, v252
    v_lshlrev_b32 v30, 16, v253
    v_and_b32 v31, 0xffff0000, v253
    v_lshlrev_b32 v32, 16, v254
    v_and_b32 v33, 0xffff0000, v254
    v_lshlrev_b32 v34, 16, v255
    v_and_b32 v35, 0xffff0000, v255
    s_barrier
    ds_read_b128 v[40:43], v1 offset:0
    ds_read_b128 v[44:47], v1 offset:1024
    ds_read_b128 v[48:51], v1 offset:2048
    ds_read_b128 v[52:55], v1 offset:3072
    ds_read_b128 v[56:59], v1 offset:4096
    ds_read_b128 v[60:63], v1 offset:5120
    ds_read_b128 v[64:67], v1 offset:6144
    ds_read_b128 v[68:71], v1 offset:7168
    ds_read_b128 v[72:75], v1 offset:8192
    ds_read_b128 v[76:79], v1 offset:9216
    s_lshl_b32 s40, s28, 7
    s_add_u32 s40, s40, s21
    s_add_u32 s40, s40, 262144
    s_mov_b64 exec, 0xffffffff
    s_mov_b32 s61, 0
pl_72:
    buffer_load_dword v7, v3, s[4:7], s40 offen sc1
    s_waitcnt vmcnt(0)
    v_cmp_ne_u32 vcc, s100, v7
    s_add_u32 s61, s61, 1
    s_nop 3
    s_cbranch_vccz pd_73
    s_cmp_ge_u32 s61, s23
    s_cbranch_scc1 to_74
    s_branch pl_72
pd_73:
    s_mov_b64 exec, -1
    s_cmp_eq_u32 s22, 0
    s_cbranch_scc1 inv_75
invr_76:
    buffer_load_dwordx4 v[100:103], v244, s[4:7], s44 offen offset:0 sc1
    buffer_load_dwordx4 v[104:107], v244, s[4:7], s44 offen offset:2048 sc1
    s_add_u32 s44, s44, 4096
    buffer_load_dwordx4 v[108:111], v244, s[4:7], s44 offen offset:0 sc1
    buffer_load_dwordx4 v[112:115], v244, s[4:7], s44 offen offset:2048 sc1
    s_add_u32 s44, s44, 4096
    s_waitcnt vmcnt(3) lgkmcnt(9)
    v_mfma_f32_16x16x32_bf16 v[16:19], v[40:43], v[100:103], v[16:19]
    ds_read_b128 v[80:83], v1 offset:10240
    s_waitcnt lgkmcnt(9)
    v_mfma_f32_16x16x32_bf16 v[20:23], v[44:47], v[100:103], v[20:23]
    ds_read_b128 v[84:87], v1 offset:11264
    buffer_load_dwordx4 v[116:119], v244, s[4:7], s44 offen offset:0 sc1
    s_waitcnt lgkmcnt(9)
    v_mfma_f32_16x16x32_bf16 v[24:27], v[48:51], v[100:103], v[24:27]
    ds_read_b128 v[88:91], v1 offset:12288
    s_waitcnt lgkmcnt(9)
    v_mfma_f32_16x16x32_bf16 v[28:31], v[52:55], v[100:103], v[28:31]
    ds_read_b128 v[92:95], v1 offset:13312
    buffer_load_dwordx4 v[120:123], v244, s[4:7], s44 offen offset:2048 sc1
    s_add_u32 s44, s44, 4096
    s_waitcnt lgkmcnt(9)
    v_mfma_f32_16x16x32_bf16 v[32:35], v[56:59], v[100:103], v[32:35]
    ds_read_b128 v[96:99], v1 offset:14336
    s_waitcnt vmcnt(4) lgkmcnt(9)
    v_mfma_f32_16x16x32_bf16 v[16:19], v[60:63], v[104:107], v[16:19]
    ds_read_b128 v[40:43], v1 offset:15360
    s_waitcnt lgkmcnt(9)
    v_mfma_f32_16x16x32_bf16 v[20:23], v[64:67], v[104:107], v[20:23]
    ds_read_b128 v[44:47], v1 offset:16384
    buffer_load_dwordx4 v[124:127], v244, s[4:7], s44 offen offset:0 sc1
    s_waitcnt lgkmcnt(9)
    v_mfma_f32_16x16x32_bf16 v[24:27], v[68:71], v[104:107], v[24:27]
    ds_read_b128 v[48:51], v1 offset:17408
    s_waitcnt lgkmcnt(9)
    v_mfma_f32_16x16x32_bf16 v[28:31], v[72:75], v[104:107], v[28:31]
    ds_read_b128 v[52:55], v1 offset:18432
    buffer_load_dwordx4 v[128:131], v244, s[4:7], s44 offen offset:2048 sc1
    s_add_u32 s44, s44, 4096
    s_waitcnt lgkmcnt(9)
    v_mfma_f32_16x16x32_bf16 v[32:35], v[76:79], v[104:107], v[32:35]
    ds_read_b128 v[56:59], v1 offset:19456
    s_waitcnt vmcnt(5) lgkmcnt(9)
    v_mfma_f32_16x16x32_bf16 v[16:19], v[80:83], v[108:111], v[16:19]
    ds_read_b128 v[60:63], v1 offset:20480
    s_waitcnt lgkmcnt(9)
    v_mfma_f32_16x16x32_bf16 v[20:23], v[84:87], v[108:111], v[20:23]
    ds_read_b128 v[64:67], v1 offset:21504
    buffer_load_dwordx4 v[132:135], v244, s[4:7], s44 offen offset:0 sc1
    s_waitcnt lgkmcnt(9)
    v_mfma_f32_16x16x32_bf16 v[24:27], v[88:91], v[108:111], v[24:27]
    ds_read_b128 v[68:71], v1 offset:22528
    s_waitcnt lgkmcnt(9)
    v_mfma_f32_16x16x32_bf16 v[28:31], v[92:95], v[108:111], v[28:31]
    ds_read_b128 v[72:75], v1 offset:23552
    buffer_load_dwordx4 v[136:139], v244, s[4:7], s44 offen offset:2048 sc1
    s_add_u32 s44, s44, 4096
    s_waitcnt lgkmcnt(9)
    v_mfma_f32_16x16x32_bf16 v[32:35], v[96:99], v[108:111], v[32:35]
    ds_read_b128 v[76:79], v1 offset:24576
    s_waitcnt vmcnt(6) lgkmcnt(9)
    v_mfma_f32_16x16x32_bf16 v[16:19], v[40:43], v[112:115], v[16:19]
    ds_read_b128 v[80:83], v1 offset:25600
    s_waitcnt lgkmcnt(9)
    v_mfma_f32_16x16x32_bf16 v[20:23], v[44:47], v[112:115], v[20:23]
    ds_read_b128 v[84:87], v1 offset:26624
    buffer_load_dwordx4 v[140:143], v244, s[4:7], s44 offen offset:0 sc1
    s_waitcnt lgkmcnt(9)
    v_mfma_f32_16x16x32_bf16 v[24:27], v[48:51], v[112:115], v[24:27]
    ds_read_b128 v[88:91], v1 offset:27648
    s_waitcnt lgkmcnt(9)
    v_mfma_f32_16x16x32_bf16 v[28:31], v[52:55], v[112:115], v[28:31]
    ds_read_b128 v[92:95], v1 offset:28672
    buffer_load_dwordx4 v[144:147], v244, s[4:7], s44 offen offset:2048 sc1
    s_add_u32 s44, s44, 4096
    s_waitcnt lgkmcnt(9)
    v_mfma_f32_16x16x32_bf16 v[32:35], v[56:59], v[112:115], v[32:35]
    ds_read_b128 v[96:99], v1 offset:29696
    s_waitcnt vmcnt(7) lgkmcnt(9)
    v_mfma_f32_16x16x32_bf16 v[16:19], v[60:63], v[116:119], v[16:19]
    ds_read_b128 v[40:43], v1 offset:30720
    s_waitcnt lgkmcnt(9)
    v_mfma_f32_16x16x32_bf16 v[20:23], v[64:67], v[116:119], v[20:23]
    ds_read_b128 v[44:47], v1 offset:31744
    buffer_load_dwordx4 v[148:151], v244, s[4:7], s44 offen offset:0 sc1
    s_waitcnt lgkmcnt(9)
    v_mfma_f32_16x16x32_bf16 v[24:27], v[68:71], v[116:119], v[24:27]
    ds_read_b128 v[48:51], v1 offset:32768
    s_waitcnt lgkmcnt(9)
    v_mfma_f32_16x16x32_bf16 v[28:31], v[72:75], v[116:119], v[28:31]
    ds_read_b128 v[52:55], v1 offset:33792
    buffer_load_dwordx4 v[152:155], v244, s[4:7], s44 offen offset:2048 sc1
    s_add_u32 s44, s44, 4096
    s_waitcnt lgkmcnt(9)
    v_mfma_f32_16x16x32_bf16 v[32:35], v[76:79], v[116:119], v[32:35]
    ds_read_b128 v[56:59], v1 offset:34816
    s_waitcnt vmcnt(8) lgkmcnt(9)
    v_mfma_f32_16x16x32_bf16 v[16:19], v[80:83], v[120:123], v[16:19]
    ds_read_b128 v[60:63], v1 offset:35840
    s_waitcnt lgkmcnt(9)
    v_mfma_f32_16x16x32_bf16 v[20:23], v[84:87], v[120:123], v[20:23]
    ds_read_b128 v[64:67], v1 offset:36864
    buffer_load_dwordx4 v[156:159], v244, s[4:7], s44 offen offset:0 sc1
    s_waitcnt lgkmcnt(9)
    v_mfma_f32_16x16x32_bf16 v[24:27], v[88:91], v[120:123], v[24:27]
    ds_read_b128 v[68:71], v1 offset:37888
    s_waitcnt lgkmcnt(9)
    v_mfma_f32_16x16x32_bf16 v[28:31], v[92:95], v[120:123], v[28:31]
    ds_read_b128 v[72:75], v1 offset:38912
    buffer_load_dwordx4 v[160:163], v244, s[4:7], s44 offen offset:2048 sc1
    s_add_u32 s44, s44, 4096
    s_waitcnt lgkmcnt(9)
    v_mfma_f32_16x16x32_bf16 v[32:35], v[96:99], v[120:123], v[32:35]
    ds_read_b128 v[76:79], v1 offset:39936
    s_waitcnt vmcnt(9) lgkmcnt(9)
    v_mfma_f32_16x16x32_bf16 v[16:19], v[40:43], v[124:127], v[16:19]
    ds_read_b128 v[80:83], v1 offset:40960
    s_waitcnt lgkmcnt(9)
    v_mfma_f32_16x16x32_bf16 v[20:23], v[44:47], v[124:127], v[20:23]
    ds_read_b128 v[84:87], v1 offset:41984
    buffer_load_dwordx4 v[164:167], v244, s[4:7], s44 offen offset:0 sc1
    s_waitcnt lgkmcnt(9)
    v_mfma_f32_16x16x32_bf16 v[24:27], v[48:51], v[124:127], v[24:27]
    ds_read_b128 v[88:91], v1 offset:43008
    s_waitcnt lgkmcnt(9)
    v_mfma_f32_16x16x32_bf16 v[28:31], v[52:55], v[124:127], v[28:31]
    ds_read_b128 v[92:95], v1 offset:44032
    buffer_load_dwordx4 v[168:171], v244, s[4:7], s44 offen offset:2048 sc1
    s_add_u32 s44, s44, 4096
    s_waitcnt lgkmcnt(9)
    v_mfma_f32_16x16x32_bf16 v[32:35], v[56:59], v[124:127], v[32:35]
    ds_read_b128 v[96:99], v1 offset:45056
    s_waitcnt vmcnt(10) lgkmcnt(9)
    v_mfma_f32_16x16x32_bf16 v[16:19], v[60:63], v[128:131], v[16:19]
    ds_read_b128 v[40:43], v1 offset:46080
    s_waitcnt lgkmcnt(9)
    v_mfma_f32_16x16x32_bf16 v[20:23], v[64:67], v[128:131], v[20:23]
    ds_read_b128 v[44:47], v1 offset:47104
    buffer_load_dwordx4 v[172:175], v244, s[4:7], s44 offen offset:0 sc1
    s_waitcnt lgkmcnt(9)
    v_mfma_f32_16x16x32_bf16 v[24:27], v[68:71], v[128:131], v[24:27]
    ds_read_b128 v[48:51], v1 offset:48128
    s_waitcnt lgkmcnt(9)
    v_mfma_f32_16x16x32_bf16 v[28:31], v[72:75], v[128:131], v[28:31]
    ds_read_b128 v[52:55], v1 offset:49152
    buffer_load_dwordx4 v[176:179], v244, s[4:7], s44 offen offset:2048 sc1
    s_add_u32 s44, s44, 4096
    s_waitcnt lgkmcnt(9)
    v_mfma_f32_16x16x32_bf16 v[32:35], v[76:79], v[128:131], v[32:35]
    ds_read_b128 v[56:59], v1 offset:50176
    s_waitcnt vmcnt(11) lgkmcnt(9)
    v_mfma_f32_16x16x32_bf16 v[16:19], v[80:83], v[132:135], v[16:19]
    ds_read_b128 v[60:63], v1 offset:51200
    s_waitcnt lgkmcnt(9)
    v_mfma_f32_16x16x32_bf16 v[20:23], v[84:87], v[132:135], v[20:23]
    ds_read_b128 v[64:67], v1 offset:52224
    s_waitcnt lgkmcnt(9)
    v_mfma_f32_16x16x32_bf16 v[24:27], v[88:91], v[132:135], v[24:27]
    ds_read_b128 v[68:71], v1 offset:53248
    s_waitcnt lgkmcnt(9)
    v_mfma_f32_16x16x32_bf16 v[28:31], v[92:95], v[132:135], v[28:31]
    ds_read_b128 v[72:75], v1 offset:54272
    s_waitcnt lgkmcnt(9)
    v_mfma_f32_16x16x32_bf16 v[32:35], v[96:99], v[132:135], v[32:35]
    ds_read_b128 v[76:79], v1 offset:55296
    s_waitcnt vmcnt(10) lgkmcnt(9)
    v_mfma_f32_16x16x32_bf16 v[16:19], v[40:43], v[136:139], v[16:19]
    ds_read_b128 v[80:83], v1 offset:56320
    s_waitcnt lgkmcnt(9)
    v_mfma_f32_16x16x32_bf16 v[20:23], v[44:47], v[136:139], v[20:23]
    ds_read_b128 v[84:87], v1 offset:57344
    s_waitcnt lgkmcnt(9)
    v_mfma_f32_16x16x32_bf16 v[24:27], v[48:51], v[136:139], v[24:27]
    ds_read_b128 v[88:91], v1 offset:58368
    s_waitcnt lgkmcnt(9)
    v_mfma_f32_16x16x32_bf16 v[28:31], v[52:55], v[136:139], v[28:31]
    ds_read_b128 v[92:95], v1 offset:59392
    s_waitcnt lgkmcnt(9)
    v_mfma_f32_16x16x32_bf16 v[32:35], v[56:59], v[136:139], v[32:35]
    ds_read_b128 v[96:99], v1 offset:60416
    s_waitcnt vmcnt(9) lgkmcnt(9)
    v_mfma_f32_16x16x32_bf16 v[16:19], v[60:63], v[140:143], v[16:19]
    ds_read_b128 v[40:43], v5 offset:0
    s_waitcnt lgkmcnt(9)
    v_mfma_f32_16x16x32_bf16 v[20:23], v[64:67], v[140:143], v[20:23]
    ds_read_b128 v[44:47], v5 offset:1024
    s_waitcnt lgkmcnt(9)
    v_mfma_f32_16x16x32_bf16 v[24:27], v[68:71], v[140:143], v[24:27]
    ds_read_b128 v[48:51], v5 offset:2048
    s_waitcnt lgkmcnt(9)
    v_mfma_f32_16x16x32_bf16 v[28:31], v[72:75], v[140:143], v[28:31]
    ds_read_b128 v[52:55], v5 offset:3072
    s_waitcnt lgkmcnt(9)
    v_mfma_f32_16x16x32_bf16 v[32:35], v[76:79], v[140:143], v[32:35]
    ds_read_b128 v[56:59], v5 offset:4096
    s_waitcnt vmcnt(8) lgkmcnt(9)
    v_mfma_f32_16x16x32_bf16 v[16:19], v[80:83], v[144:147], v[16:19]
    ds_read_b128 v[60:63], v5 offset:5120
    s_waitcnt lgkmcnt(9)
    v_mfma_f32_16x16x32_bf16 v[20:23], v[84:87], v[144:147], v[20:23]
    ds_read_b128 v[64:67], v5 offset:6144
    s_waitcnt lgkmcnt(9)
    v_mfma_f32_16x16x32_bf16 v[24:27], v[88:91], v[144:147], v[24:27]
    ds_read_b128 v[68:71], v5 offset:7168
    s_waitcnt lgkmcnt(9)
    v_mfma_f32_16x16x32_bf16 v[28:31], v[92:95], v[144:147], v[28:31]
    ds_read_b128 v[72:75], v5 offset:8192
    s_waitcnt lgkmcnt(9)
    v_mfma_f32_16x16x32_bf16 v[32:35], v[96:99], v[144:147], v[32:35]
    ds_read_b128 v[76:79], v5 offset:9216
    s_waitcnt vmcnt(7) lgkmcnt(9)
    v_mfma_f32_16x16x32_bf16 v[16:19], v[40:43], v[148:151], v[16:19]
    ds_read_b128 v[80:83], v5 offset:10240
    s_waitcnt lgkmcnt(9)
    v_mfma_f32_16x16x32_bf16 v[20:23], v[44:47], v[148:151], v[20:23]
    ds_read_b128 v[84:87], v5 offset:11264
    s_waitcnt lgkmcnt(9)
    v_mfma_f32_16x16x32_bf16 v[24:27], v[48:51], v[148:151], v[24:27]
    ds_read_b128 v[88:91], v5 offset:12288
    s_waitcnt lgkmcnt(9)
    v_mfma_f32_16x16x32_bf16 v[28:31], v[52:55], v[148:151], v[28:31]
    ds_read_b128 v[92:95], v5 offset:13312
    s_waitcnt lgkmcnt(9)
    v_mfma_f32_16x16x32_bf16 v[32:35], v[56:59], v[148:151], v[32:35]
    ds_read_b128 v[96:99], v5 offset:14336
    s_waitcnt vmcnt(6) lgkmcnt(9)
    v_mfma_f32_16x16x32_bf16 v[16:19], v[60:63], v[152:155], v[16:19]
    ds_read_b128 v[40:43], v5 offset:15360
    s_waitcnt lgkmcnt(9)
    v_mfma_f32_16x16x32_bf16 v[20:23], v[64:67], v[152:155], v[20:23]
    ds_read_b128 v[44:47], v5 offset:16384
    s_waitcnt lgkmcnt(9)
    v_mfma_f32_16x16x32_bf16 v[24:27], v[68:71], v[152:155], v[24:27]
    ds_read_b128 v[48:51], v5 offset:17408
    s_waitcnt lgkmcnt(9)
    v_mfma_f32_16x16x32_bf16 v[28:31], v[72:75], v[152:155], v[28:31]
    ds_read_b128 v[52:55], v5 offset:18432
    s_waitcnt lgkmcnt(9)
    v_mfma_f32_16x16x32_bf16 v[32:35], v[76:79], v[152:155], v[32:35]
    ds_read_b128 v[56:59], v5 offset:19456
    s_waitcnt vmcnt(5) lgkmcnt(9)
    v_mfma_f32_16x16x32_bf16 v[16:19], v[80:83], v[156:159], v[16:19]
    ds_read_b128 v[60:63], v5 offset:20480
    s_waitcnt lgkmcnt(9)
    v_mfma_f32_16x16x32_bf16 v[20:23], v[84:87], v[156:159], v[20:23]
    ds_read_b128 v[64:67], v5 offset:21504
    s_waitcnt lgkmcnt(9)
    v_mfma_f32_16x16x32_bf16 v[24:27], v[88:91], v[156:159], v[24:27]
    ds_read_b128 v[68:71], v5 offset:22528
    s_waitcnt lgkmcnt(9)
    v_mfma_f32_16x16x32_bf16 v[28:31], v[92:95], v[156:159], v[28:31]
    ds_read_b128 v[72:75], v5 offset:23552
    s_waitcnt lgkmcnt(9)
    v_mfma_f32_16x16x32_bf16 v[32:35], v[96:99], v[156:159], v[32:35]
    ds_read_b128 v[76:79], v5 offset:24576
    s_waitcnt vmcnt(4) lgkmcnt(9)
    v_mfma_f32_16x16x32_bf16 v[16:19], v[40:43], v[160:163], v[16:19]
    ds_read_b128 v[80:83], v5 offset:25600
    s_waitcnt lgkmcnt(9)
    v_mfma_f32_16x16x32_bf16 v[20:23], v[44:47], v[160:163], v[20:23]
    ds_read_b128 v[84:87], v5 offset:26624
    s_waitcnt lgkmcnt(9)
    v_mfma_f32_16x16x32_bf16 v[24:27], v[48:51], v[160:163], v[24:27]
    ds_read_b128 v[88:91], v5 offset:27648
    s_waitcnt lgkmcnt(9)
    v_mfma_f32_16x16x32_bf16 v[28:31], v[52:55], v[160:163], v[28:31]
    ds_read_b128 v[92:95], v5 offset:28672
    s_waitcnt lgkmcnt(9)
    v_mfma_f32_16x16x32_bf16 v[32:35], v[56:59], v[160:163], v[32:35]
    ds_read_b128 v[96:99], v5 offset:29696
    s_waitcnt vmcnt(3) lgkmcnt(9)
    v_mfma_f32_16x16x32_bf16 v[16:19], v[60:63], v[164:167], v[16:19]
    ds_read_b128 v[40:43], v5 offset:30720
    s_waitcnt lgkmcnt(9)
    v_mfma_f32_16x16x32_bf16 v[20:23], v[64:67], v[164:167], v[20:23]
    ds_read_b128 v[44:47], v5 offset:31744
    s_waitcnt lgkmcnt(9)
    v_mfma_f32_16x16x32_bf16 v[24:27], v[68:71], v[164:167], v[24:27]
    ds_read_b128 v[48:51], v5 offset:32768
    s_waitcnt lgkmcnt(9)
    v_mfma_f32_16x16x32_bf16 v[28:31], v[72:75], v[164:167], v[28:31]
    ds_read_b128 v[52:55], v5 offset:33792
    s_waitcnt lgkmcnt(9)
    v_mfma_f32_16x16x32_bf16 v[32:35], v[76:79], v[164:167], v[32:35]
    ds_read_b128 v[56:59], v5 offset:34816
    s_waitcnt vmcnt(2) lgkmcnt(9)
    v_mfma_f32_16x16x32_bf16 v[16:19], v[80:83], v[168:171], v[16:19]
    ds_read_b128 v[60:63], v5 offset:35840
    s_waitcnt lgkmcnt(9)
    v_mfma_f32_16x16x32_bf16 v[20:23], v[84:87], v[168:171], v[20:23]
    ds_read_b128 v[64:67], v5 offset:36864
    s_waitcnt lgkmcnt(9)
    v_mfma_f32_16x16x32_bf16 v[24:27], v[88:91], v[168:171], v[24:27]
    ds_read_b128 v[68:71], v5 offset:37888
    s_waitcnt lgkmcnt(9)
    v_mfma_f32_16x16x32_bf16 v[28:31], v[92:95], v[168:171], v[28:31]
    ds_read_b128 v[72:75], v5 offset:38912
    s_waitcnt lgkmcnt(9)
    v_mfma_f32_16x16x32_bf16 v[32:35], v[96:99], v[168:171], v[32:35]
    ds_read_b128 v[76:79], v5 offset:39936
    s_waitcnt vmcnt(1) lgkmcnt(9)
    v_mfma_f32_16x16x32_bf16 v[16:19], v[40:43], v[172:175], v[16:19]
    s_waitcnt lgkmcnt(8)
    v_mfma_f32_16x16x32_bf16 v[20:23], v[44:47], v[172:175], v[20:23]
    s_waitcnt lgkmcnt(7)
    v_mfma_f32_16x16x32_bf16 v[24:27], v[48:51], v[172:175], v[24:27]
    s_waitcnt lgkmcnt(6)
    v_mfma_f32_16x16x32_bf16 v[28:31], v[52:55], v[172:175], v[28:31]
    s_waitcnt lgkmcnt(5)
    v_mfma_f32_16x16x32_bf16 v[32:35], v[56:59], v[172:175], v[32:35]
    s_waitcnt vmcnt(0) lgkmcnt(4)
    v_mfma_f32_16x16x32_bf16 v[16:19], v[60:63], v[176:179], v[16:19]
    s_waitcnt lgkmcnt(3)
    v_mfma_f32_16x16x32_bf16 v[20:23], v[64:67], v[176:179], v[20:23]
    s_waitcnt lgkmcnt(2)
    v_mfma_f32_16x16x32_bf16 v[24:27], v[68:71], v[176:179], v[24:27]
    s_waitcnt lgkmcnt(1)
    v_mfma_f32_16x16x32_bf16 v[28:31], v[72:75], v[176:179], v[28:31]
    s_waitcnt lgkmcnt(0)
    v_mfma_f32_16x16x32_bf16 v[32:35], v[76:79], v[176:179], v[32:35]
    v_cvt_pk_bf16_f32 v246, v16, v17
    v_cvt_pk_bf16_f32 v247, v18, v19
    v_cvt_pk_bf16_f32 v248, v20, v21
    v_cvt_pk_bf16_f32 v249, v22, v23
    v_cvt_pk_bf16_f32 v250, v24, v25
    v_cvt_pk_bf16_f32 v251, v26, v27
    v_cvt_pk_bf16_f32 v252, v28, v29
    v_cvt_pk_bf16_f32 v253, v30, v31
    v_cvt_pk_bf16_f32 v254, v32, v33
    v_cvt_pk_bf16_f32 v255, v34, v35
    s_cmp_eq_u32 s22, 0
    s_cbranch_scc1 du_77
    s_bitcmp1_b32 s25, 0
    s_cbranch_scc1 xo_79
    buffer_store_dwordx4 v[246:249], v244, s[4:7], s34 offen
    buffer_store_dwordx4 v[250:253], v244, s[4:7], s36 offen
    buffer_store_dwordx2 v[254:255], v244, s[4:7], s38 offen
    s_branch xj_80
xo_79:
    buffer_store_dwordx4 v[248:251], v244, s[4:7], s35 offen
    buffer_store_dwordx4 v[252:255], v244, s[4:7], s37 offen
    buffer_store_dwordx2 v[246:247], v244, s[4:7], s34 offen
xj_80:
dur_78:
    s_barrier
    v_pk_mul_f32 v[42:43], v[16:17], v[16:17]
    v_pk_add_f32 v[40:41], v[16:17], v[18:19]
    v_pk_fma_f32 v[42:43], v[18:19], v[18:19], v[42:43]
    v_pk_add_f32 v[40:41], v[40:41], v[20:21]
    v_pk_fma_f32 v[42:43], v[20:21], v[20:21], v[42:43]
    v_pk_add_f32 v[40:41], v[40:41], v[22:23]
    v_pk_fma_f32 v[42:43], v[22:23], v[22:23], v[42:43]
    v_pk_add_f32 v[40:41], v[40:41], v[24:25]
    v_pk_fma_f32 v[42:43], v[24:25], v[24:25], v[42:43]
    v_pk_add_f32 v[40:41], v[40:41], v[26:27]
    v_pk_fma_f32 v[42:43], v[26:27], v[26:27], v[42:43]
    v_pk_add_f32 v[40:41], v[40:41], v[28:29]
    v_pk_fma_f32 v[42:43], v[28:29], v[28:29], v[42:43]
    v_pk_add_f32 v[40:41], v[40:41], v[30:31]
    v_pk_fma_f32 v[42:43], v[30:31], v[30:31], v[42:43]
    v_pk_add_f32 v[40:41], v[40:41], v[32:33]
    v_pk_fma_f32 v[42:43], v[32:33], v[32:33], v[42:43]
    v_pk_add_f32 v[40:41], v[40:41], v[34:35]
    v_pk_fma_f32 v[42:43], v[34:35], v[34:35], v[42:43]
    v_add_f32 v40, v40, v41
    v_add_f32 v41, v42, v43
    v_mov_b32 v42, v40
    v_mov_b32 v43, v41
    s_nop 0
    v_permlane16_swap_b32 v40, v42
    v_permlane16_swap_b32 v41, v43
    v_pk_add_f32 v[40:41], v[40:41], v[42:43]
    v_mov_b32 v42, v40
    v_mov_b32 v43, v41
    s_nop 0
    v_permlane32_swap_b32 v40, v42
    v_permlane32_swap_b32 v41, v43
    v_pk_add_f32 v[40:41], v[40:41], v[42:43]
    v_or_b32 v41, 0x80000000, v41
    s_lshl_b32 s40, s28, 3
    s_add_u32 s40, s40, s25
    s_lshl_b32 s40, s40, 8
    s_lshl_b32 s41, s29, 7
    s_add_u32 s40, s40, s41
    s_add_u32 s40, s40, s21
    s_add_u32 s40, s40, 131072
    s_waitcnt vmcnt(0)
    s_cmp_eq_u32 s22, 0
    s_cbranch_scc1 du_81
    s_mov_b64 exec, 0xffff
    buffer_store_dwordx2 v[40:41], v2, s[4:7], s40 offen
    s_mov_b64 exec, -1
dur_82:
    s_lshl_b32 s42, s31, 11
    s_add_u32 s42, s42, s21
    s_add_u32 s42, s42, 131072
    s_mul_i32 s43, s31, 40960
    s_add_u32 s43, s43, 2621440
    v_add_u32 v18, 102400, v1
    ds_read_b128 v[20:23], v18 offset:0
    ds_read_b128 v[24:27], v18 offset:1024
    ds_read_b128 v[28:31], v18 offset:2048
    ds_read_b128 v[32:35], v18 offset:3072
    ds_read_b128 v[36:39], v18 offset:4096
    ds_read_b128 v[40:43], v18 offset:5120
    s_mov_b32 s61, 0
pl_83:
    buffer_load_dwordx2 v[8:9], v2, s[4:7], s42 offen offset:0 sc1
    buffer_load_dwordx2 v[10:11], v2, s[4:7], s42 offen offset:512 sc1
    buffer_load_dwordx2 v[12:13], v2, s[4:7], s42 offen offset:1024 sc1
    buffer_load_dwordx2 v[14:15], v2, s[4:7], s42 offen offset:1536 sc1
    s_waitcnt vmcnt(0)
    v_and_b32 v19, v9, v11
    v_and_b32 v19, v19, v13
    v_and_b32 v19, v19, v15
    v_cmp_le_i32 vcc, 0, v19
    s_add_u32 s61, s61, 1
    s_nop 3
    s_cbranch_vccz pd_84
    s_cmp_ge_u32 s61, s23
    s_cbranch_scc1 to_85
    s_branch pl_83
pd_84:
    s_cmp_eq_u32 s22, 0
    s_cbranch_scc1 inv_86
invr_87:
    buffer_load_dwordx4 v[104:107], v1, s[4:7], s43 offen offset:0 sc1
    buffer_load_dwordx4 v[108:111], v1, s[4:7], s43 offen offset:1024 sc1
    buffer_load_dwordx4 v[112:115], v1, s[4:7], s43 offen offset:2048 sc1
    buffer_load_dwordx4 v[116:119], v1, s[4:7], s43 offen offset:3072 sc1
    s_add_u32 s43, s43, 4096
    s_mul_i32 s44, s31, 98304
    s_mul_i32 s45, s30, 6144
    s_add_u32 s44, s44, s45
    s_add_u32 s44, s44, s101
    s_add_u32 s45, s44, 4096
    s_waitcnt vmcnt(3) lgkmcnt(5)
    v_mfma_f32_32x32x16_bf16 v[56:71], v[20:23], v[104:107], 0
    ds_read_b128 v[44:47], v18 offset:6144
    buffer_load_dwordx4 v[120:123], v1, s[4:7], s43 offen offset:0 sc1
    s_waitcnt lgkmcnt(5)
    v_mfma_f32_32x32x16_bf16 v[72:87], v[24:27], v[104:107], 0
    ds_read_b128 v[48:51], v18 offset:7168
    s_waitcnt lgkmcnt(5)
    v_mfma_f32_32x32x16_bf16 v[88:103], v[28:31], v[104:107], 0
    ds_read_b128 v[52:55], v18 offset:8192
    buffer_load_dwordx4 v[124:127], v1, s[4:7], s43 offen offset:1024 sc1
    s_waitcnt vmcnt(4) lgkmcnt(5)
    v_mfma_f32_32x32x16_bf16 v[56:71], v[32:35], v[108:111], v[56:71]
    ds_read_b128 v[20:23], v18 offset:9216
    buffer_load_dwordx4 v[128:131], v1, s[4:7], s43 offen offset:2048 sc1
    s_waitcnt lgkmcnt(5)
    v_mfma_f32_32x32x16_bf16 v[72:87], v[36:39], v[108:111], v[72:87]
    ds_read_b128 v[24:27], v18 offset:10240
    s_waitcnt lgkmcnt(5)
    v_mfma_f32_32x32x16_bf16 v[88:103], v[40:43], v[108:111], v[88:103]
    ds_read_b128 v[28:31], v18 offset:11264
    buffer_load_dwordx4 v[132:135], v1, s[4:7], s43 offen offset:3072 sc1
    s_add_u32 s43, s43, 4096
    s_waitcnt vmcnt(5) lgkmcnt(5)
    v_mfma_f32_32x32x16_bf16 v[56:71], v[44:47], v[112:115], v[56:71]
    ds_read_b128 v[32:35], v18 offset:12288
    buffer_load_dwordx4 v[136:139], v1, s[4:7], s43 offen offset:0 sc1
    s_waitcnt lgkmcnt(5)
    v_mfma_f32_32x32x16_bf16 v[72:87], v[48:51], v[112:115], v[72:87]
    ds_read_b128 v[36:39], v18 offset:13312
    v_pk_add_f32 v[8:9], v[8:9], v[10:11]
    s_waitcnt lgkmcnt(5)
    v_mfma_f32_32x32x16_bf16 v[88:103], v[52:55], v[112:115], v[88:103]
    ds_read_b128 v[40:43], v18 offset:14336
    buffer_load_dwordx4 v[140:143], v1, s[4:7], s43 offen offset:1024 sc1
    s_waitcnt vmcnt(6) lgkmcnt(5)
    v_mfma_f32_32x32x16_bf16 v[56:71], v[20:23], v[116:119], v[56:71]
    ds_read_b128 v[44:47], v18 offset:15360
    buffer_load_dwordx4 v[144:147], v1, s[4:7], s43 offen offset:2048 sc1
    s_waitcnt lgkmcnt(5)
    v_mfma_f32_32x32x16_bf16 v[72:87], v[24:27], v[116:119], v[72:87]
    ds_read_b128 v[48:51], v18 offset:16384
    v_pk_add_f32 v[12:13], v[12:13], v[14:15]
    s_waitcnt lgkmcnt(5)
    v_mfma_f32_32x32x16_bf16 v[88:103], v[28:31], v[116:119], v[88:103]
    ds_read_b128 v[52:55], v18 offset:17408
    buffer_load_dwordx4 v[148:151], v1, s[4:7], s43 offen offset:3072 sc1
    s_add_u32 s43, s43, 4096
    s_waitcnt vmcnt(7) lgkmcnt(5)
    v_mfma_f32_32x32x16_bf16 v[56:71], v[32:35], v[120:123], v[56:71]
    ds_read_b128 v[20:23], v18 offset:18432
    buffer_load_dwordx4 v[152:155], v1, s[4:7], s43 offen offset:0 sc1
    s_waitcnt lgkmcnt(5)
    v_mfma_f32_32x32x16_bf16 v[72:87], v[36:39], v[120:123], v[72:87]
    ds_read_b128 v[24:27], v18 offset:19456
    v_pk_add_f32 v[8:9], v[8:9], v[12:13]
    s_waitcnt lgkmcnt(5)
    v_mfma_f32_32x32x16_bf16 v[88:103], v[40:43], v[120:123], v[88:103]
    ds_read_b128 v[28:31], v18 offset:20480
    buffer_load_dwordx4 v[156:159], v1, s[4:7], s43 offen offset:1024 sc1
    s_waitcnt vmcnt(8) lgkmcnt(5)
    v_mfma_f32_32x32x16_bf16 v[56:71], v[44:47], v[124:127], v[56:71]
    ds_read_b128 v[32:35], v18 offset:21504
    buffer_load_dwordx4 v[160:163], v1, s[4:7], s43 offen offset:2048 sc1
    s_waitcnt lgkmcnt(5)
    v_mfma_f32_32x32x16_bf16 v[72:87], v[48:51], v[124:127], v[72:87]
    ds_read_b128 v[36:39], v18 offset:22528
    v_mov_b32 v10, v8
    s_waitcnt lgkmcnt(5)
    v_mfma_f32_32x32x16_bf16 v[88:103], v[52:55], v[124:127], v[88:103]
    ds_read_b128 v[40:43], v18 offset:23552
    buffer_load_dwordx4 v[164:167], v1, s[4:7], s43 offen offset:3072 sc1
    s_add_u32 s43, s43, 4096
    s_waitcnt vmcnt(9) lgkmcnt(5)
    v_mfma_f32_32x32x16_bf16 v[56:71], v[20:23], v[128:131], v[56:71]
    ds_read_b128 v[44:47], v18 offset:24576
    buffer_load_dwordx4 v[168:171], v1, s[4:7], s43 offen offset:0 sc1
    s_waitcnt lgkmcnt(5)
    v_mfma_f32_32x32x16_bf16 v[72:87], v[24:27], v[128:131], v[72:87]
    ds_read_b128 v[48:51], v18 offset:25600
    v_mov_b32 v11, v9
    s_waitcnt lgkmcnt(5)
    v_mfma_f32_32x32x16_bf16 v[88:103], v[28:31], v[128:131], v[88:103]
    ds_read_b128 v[52:55], v18 offset:26624
    buffer_load_dwordx4 v[172:175], v1, s[4:7], s43 offen offset:1024 sc1
    s_waitcnt vmcnt(10) lgkmcnt(5)
    v_mfma_f32_32x32x16_bf16 v[56:71], v[32:35], v[132:135], v[56:71]
    ds_read_b128 v[20:23], v18 offset:27648
    buffer_load_dwordx4 v[176:179], v1, s[4:7], s43 offen offset:2048 sc1
    s_waitcnt lgkmcnt(5)
    v_mfma_f32_32x32x16_bf16 v[72:87], v[36:39], v[132:135], v[72:87]
    ds_read_b128 v[24:27], v18 offset:28672
    v_permlane32_swap_b32 v8, v10
    s_waitcnt lgkmcnt(5)
    v_mfma_f32_32x32x16_bf16 v[88:103], v[40:43], v[132:135], v[88:103]
    ds_read_b128 v[28:31], v18 offset:29696
    buffer_load_dwordx4 v[180:183], v1, s[4:7], s43 offen offset:3072 sc1
    s_add_u32 s43, s43, 4096
    s_waitcnt vmcnt(11) lgkmcnt(5)
    v_mfma_f32_32x32x16_bf16 v[56:71], v[44:47], v[136:139], v[56:71]
    ds_read_b128 v[32:35], v18 offset:30720
    buffer_load_dwordx4 v[184:187], v1, s[4:7], s43 offen offset:0 sc1
    s_waitcnt lgkmcnt(5)
    v_mfma_f32_32x32x16_bf16 v[72:87], v[48:51], v[136:139], v[72:87]
    ds_read_b128 v[36:39], v18 offset:31744
    v_permlane32_swap_b32 v9, v11
    s_waitcnt lgkmcnt(5)
    v_mfma_f32_32x32x16_bf16 v[88:103], v[52:55], v[136:139], v[88:103]
    ds_read_b128 v[40:43], v18 offset:32768
    buffer_load_dwordx4 v[188:191], v1, s[4:7], s43 offen offset:1024 sc1
    s_waitcnt vmcnt(12) lgkmcnt(5)
    v_mfma_f32_32x32x16_bf16 v[56:71], v[20:23], v[140:143], v[56:71]
    ds_read_b128 v[44:47], v18 offset:33792
    buffer_load_dwordx4 v[192:195], v1, s[4:7], s43 offen offset:2048 sc1
    s_waitcnt lgkmcnt(5)
    v_mfma_f32_32x32x16_bf16 v[72:87], v[24:27], v[140:143], v[72:87]
    ds_read_b128 v[48:51], v18 offset:34816
    v_pk_add_f32 v[8:9], v[8:9], v[10:11]
    s_waitcnt lgkmcnt(5)
    v_mfma_f32_32x32x16_bf16 v[88:103], v[28:31], v[140:143], v[88:103]
    ds_read_b128 v[52:55], v18 offset:35840
    buffer_load_dwordx4 v[196:199], v1, s[4:7], s43 offen offset:3072 sc1
    s_add_u32 s43, s43, 4096
    s_waitcnt vmcnt(13) lgkmcnt(5)
    v_mfma_f32_32x32x16_bf16 v[56:71], v[32:35], v[144:147], v[56:71]
    ds_read_b128 v[20:23], v18 offset:36864
    buffer_load_dwordx4 v[104:107], v1, s[4:7], s43 offen offset:0 sc1
    s_waitcnt lgkmcnt(5)
    v_mfma_f32_32x32x16_bf16 v[72:87], v[36:39], v[144:147], v[72:87]
    ds_read_b128 v[24:27], v18 offset:37888
    v_mul_f32 v8, 0x3acccccd, v8
    s_waitcnt lgkmcnt(5)
    v_mfma_f32_32x32x16_bf16 v[88:103], v[40:43], v[144:147], v[88:103]
    ds_read_b128 v[28:31], v18 offset:38912
    buffer_load_dwordx4 v[108:111], v1, s[4:7], s43 offen offset:1024 sc1
    s_waitcnt vmcnt(14) lgkmcnt(5)
    v_mfma_f32_32x32x16_bf16 v[56:71], v[44:47], v[148:151], v[56:71]
    ds_read_b128 v[32:35], v18 offset:39936
    buffer_load_dwordx4 v[112:115], v1, s[4:7], s43 offen offset:2048 sc1
    s_waitcnt lgkmcnt(5)
    v_mfma_f32_32x32x16_bf16 v[72:87], v[48:51], v[148:151], v[72:87]
    ds_read_b128 v[36:39], v18 offset:40960
    v_mul_f32 v9, 0xbacccccd, v9
    s_waitcnt lgkmcnt(5)
    v_mfma_f32_32x32x16_bf16 v[88:103], v[52:55], v[148:151], v[88:103]
    ds_read_b128 v[40:43], v18 offset:41984
    buffer_load_dwordx4 v[116:119], v1, s[4:7], s43 offen offset:3072 sc1
    s_add_u32 s43, s43, 4096
    s_waitcnt vmcnt(15) lgkmcnt(5)
    v_mfma_f32_32x32x16_bf16 v[56:71], v[20:23], v[152:155], v[56:71]
    ds_read_b128 v[44:47], v18 offset:43008
    buffer_load_dwordx4 v[120:123], v1, s[4:7], s43 offen offset:0 sc1
    s_waitcnt lgkmcnt(5)
    v_mfma_f32_32x32x16_bf16 v[72:87], v[24:27], v[152:155], v[72:87]
    ds_read_b128 v[48:51], v18 offset:44032
    v_fma_f32 v9, -v8, v8, v9
    s_waitcnt lgkmcnt(5)
    v_mfma_f32_32x32x16_bf16 v[88:103], v[28:31], v[152:155], v[88:103]
    ds_read_b128 v[52:55], v18 offset:45056
    buffer_load_dwordx4 v[124:127], v1, s[4:7], s43 offen offset:1024 sc1
    s_waitcnt vmcnt(16) lgkmcnt(5)
    v_mfma_f32_32x32x16_bf16 v[56:71], v[32:35], v[156:159], v[56:71]
    ds_read_b128 v[20:23], v18 offset:46080
    buffer_load_dwordx4 v[128:131], v1, s[4:7], s43 offen offset:2048 sc1
    s_waitcnt lgkmcnt(5)
    v_mfma_f32_32x32x16_bf16 v[72:87], v[36:39], v[156:159], v[72:87]
    ds_read_b128 v[24:27], v18 offset:47104
    v_max_f32 v9, 0, v9
    s_waitcnt lgkmcnt(5)
    v_mfma_f32_32x32x16_bf16 v[88:103], v[40:43], v[156:159], v[88:103]
    ds_read_b128 v[28:31], v18 offset:48128
    buffer_load_dwordx4 v[132:135], v1, s[4:7], s43 offen offset:3072 sc1
    s_add_u32 s43, s43, 4096
    s_waitcnt vmcnt(17) lgkmcnt(5)
    v_mfma_f32_32x32x16_bf16 v[56:71], v[44:47], v[160:163], v[56:71]
    ds_read_b128 v[32:35], v18 offset:49152
    buffer_load_dwordx4 v[136:139], v1, s[4:7], s43 offen offset:0 sc1
    s_waitcnt lgkmcnt(5)
    v_mfma_f32_32x32x16_bf16 v[72:87], v[48:51], v[160:163], v[72:87]
    ds_read_b128 v[36:39], v18 offset:50176
    v_cvt_pk_bf16_f32 v9, v9, v9
    s_waitcnt lgkmcnt(5)
    v_mfma_f32_32x32x16_bf16 v[88:103], v[52:55], v[160:163], v[88:103]
    ds_read_b128 v[40:43], v18 offset:51200
    buffer_load_dwordx4 v[140:143], v1, s[4:7], s43 offen offset:1024 sc1
    s_waitcnt vmcnt(18) lgkmcnt(5)
    v_mfma_f32_32x32x16_bf16 v[56:71], v[20:23], v[164:167], v[56:71]
    ds_read_b128 v[44:47], v18 offset:52224
    buffer_load_dwordx4 v[144:147], v1, s[4:7], s43 offen offset:2048 sc1
    s_waitcnt lgkmcnt(5)
    v_mfma_f32_32x32x16_bf16 v[72:87], v[24:27], v[164:167], v[72:87]
    ds_read_b128 v[48:51], v18 offset:53248
    v_and_b32 v9, 0xffff0000, v9
    s_waitcnt lgkmcnt(5)
    v_mfma_f32_32x32x16_bf16 v[88:103], v[28:31], v[164:167], v[88:103]
    ds_read_b128 v[52:55], v18 offset:54272
    buffer_load_dwordx4 v[148:151], v1, s[4:7], s43 offen offset:3072 sc1
    s_add_u32 s43, s43, 4096
    s_waitcnt vmcnt(19) lgkmcnt(5)
    v_mfma_f32_32x32x16_bf16 v[56:71], v[32:35], v[168:171], v[56:71]
    ds_read_b128 v[20:23], v18 offset:55296
    buffer_load_dwordx4 v[152:155], v1, s[4:7], s43 offen offset:0 sc1
    s_waitcnt lgkmcnt(5)
    v_mfma_f32_32x32x16_bf16 v[72:87], v[36:39], v[168:171], v[72:87]
    ds_read_b128 v[24:27], v18 offset:56320
    v_add_f32 v9, 0x3727c5ac, v9
    s_waitcnt lgkmcnt(5)
    v_mfma_f32_32x32x16_bf16 v[88:103], v[40:43], v[168:171], v[88:103]
    ds_read_b128 v[28:31], v18 offset:57344
    buffer_load_dwordx4 v[156:159], v1, s[4:7], s43 offen offset:1024 sc1
    s_waitcnt vmcnt(20) lgkmcnt(5)
    v_mfma_f32_32x32x16_bf16 v[56:71], v[44:47], v[172:175], v[56:71]
    ds_read_b128 v[32:35], v18 offset:58368
    buffer_load_dwordx4 v[160:163], v1, s[4:7], s43 offen offset:2048 sc1
    s_waitcnt lgkmcnt(5)
    v_mfma_f32_32x32x16_bf16 v[72:87], v[48:51], v[172:175], v[72:87]
    ds_read_b128 v[36:39], v18 offset:59392
    v_cvt_pk_bf16_f32 v9, v9, v9
    s_waitcnt lgkmcnt(5)
    v_mfma_f32_32x32x16_bf16 v[88:103], v[52:55], v[172:175], v[88:103]
    ds_read_b128 v[40:43], v18 offset:60416
    v_and_b32 v9, 0xffff0000, v9
    s_waitcnt vmcnt(20) lgkmcnt(5)
    v_mfma_f32_32x32x16_bf16 v[56:71], v[20:23], v[176:179], v[56:71]
    s_waitcnt lgkmcnt(0)
    s_barrier
    ds_read_b128 v[44:47], v1 offset:0
    buffer_load_dwordx4 v[164:167], v1, s[4:7], s43 offen offset:3072 sc1
    s_add_u32 s43, s43, 4096
    v_mfma_f32_32x32x16_bf16 v[72:87], v[24:27], v[176:179], v[72:87]
    ds_read_b128 v[48:51], v1 offset:1024
    v_sqrt_f32 v9, v9
    v_mfma_f32_32x32x16_bf16 v[88:103], v[28:31], v[176:179], v[88:103]
    ds_read_b128 v[52:55], v1 offset:2048
    v_cvt_pk_bf16_f32 v4, v8, v8
    s_waitcnt vmcnt(20)
    v_mfma_f32_32x32x16_bf16 v[56:71], v[32:35], v[180:183], v[56:71]
    ds_read_b128 v[20:23], v1 offset:3072
    v_mfma_f32_32x32x16_bf16 v[72:87], v[36:39], v[180:183], v[72:87]
    ds_read_b128 v[24:27], v1 offset:4096
    v_cvt_pk_bf16_f32 v5, v8, v9
    v_mfma_f32_32x32x16_bf16 v[88:103], v[40:43], v[180:183], v[88:103]
    ds_read_b128 v[28:31], v1 offset:5120
    s_waitcnt vmcnt(19) lgkmcnt(5)
    v_mfma_f32_32x32x16_bf16 v[56:71], v[44:47], v[184:187], v[56:71]
    ds_read_b128 v[32:35], v1 offset:6144
    s_waitcnt lgkmcnt(5)
    v_mfma_f32_32x32x16_bf16 v[72:87], v[48:51], v[184:187], v[72:87]
    ds_read_b128 v[36:39], v1 offset:7168
    v_mov_b32 v6, 0
    s_waitcnt lgkmcnt(5)
    v_mfma_f32_32x32x16_bf16 v[88:103], v[52:55], v[184:187], v[88:103]
    ds_read_b128 v[40:43], v1 offset:8192
    s_waitcnt vmcnt(18) lgkmcnt(5)
    v_mfma_f32_32x32x16_bf16 v[56:71], v[20:23], v[188:191], v[56:71]
    ds_read_b128 v[44:47], v1 offset:9216
    s_waitcnt lgkmcnt(5)
    v_mfma_f32_32x32x16_bf16 v[72:87], v[24:27], v[188:191], v[72:87]
    ds_read_b128 v[48:51], v1 offset:10240
    v_mov_b32 v7, 0
    s_waitcnt lgkmcnt(5)
    v_mfma_f32_32x32x16_bf16 v[88:103], v[28:31], v[188:191], v[88:103]
    ds_read_b128 v[52:55], v1 offset:11264
    s_waitcnt vmcnt(17) lgkmcnt(5)
    v_mfma_f32_32x32x16_bf16 v[56:71], v[32:35], v[192:195], v[56:71]
    ds_read_b128 v[20:23], v1 offset:12288
    s_waitcnt lgkmcnt(5)
    v_mfma_f32_32x32x16_bf16 v[72:87], v[36:39], v[192:195], v[72:87]
    ds_read_b128 v[24:27], v1 offset:13312
    v_and_b32 v9, 0xffff0000, v5
    s_waitcnt lgkmcnt(5)
    v_mfma_f32_32x32x16_bf16 v[88:103], v[40:43], v[192:195], v[88:103]
    ds_read_b128 v[28:31], v1 offset:14336
    s_waitcnt vmcnt(16) lgkmcnt(5)
    v_mfma_f32_32x32x16_bf16 v[56:71], v[44:47], v[196:199], v[56:71]
    ds_read_b128 v[32:35], v1 offset:15360
    s_waitcnt lgkmcnt(5)
    v_mfma_f32_32x32x16_bf16 v[72:87], v[48:51], v[196:199], v[72:87]
    ds_read_b128 v[36:39], v1 offset:16384
    v_rcp_f32 v16, v9
    s_waitcnt lgkmcnt(5)
    v_mfma_f32_32x32x16_bf16 v[88:103], v[52:55], v[196:199], v[88:103]
    ds_read_b128 v[40:43], v1 offset:17408
    s_waitcnt vmcnt(15) lgkmcnt(5)
    v_mfma_f32_32x32x16_bf16 v[56:71], v[20:23], v[104:107], v[56:71]
    ds_read_b128 v[44:47], v1 offset:18432
    s_waitcnt lgkmcnt(5)
    v_mfma_f32_32x32x16_bf16 v[72:87], v[24:27], v[104:107], v[72:87]
    ds_read_b128 v[48:51], v1 offset:19456
    v_mov_b32 v17, v16
    s_waitcnt lgkmcnt(5)
    v_mfma_f32_32x32x16_bf16 v[88:103], v[28:31], v[104:107], v[88:103]
    ds_read_b128 v[52:55], v1 offset:20480
    s_waitcnt vmcnt(14) lgkmcnt(5)
    v_mfma_f32_32x32x16_bf16 v[56:71], v[32:35], v[108:111], v[56:71]
    ds_read_b128 v[20:23], v1 offset:21504
    s_mul_i32 s50, s25, 160
    v_lshrrev_b32 v19, 4, v0
    v_lshlrev_b32 v19, 3, v19
    buffer_load_dwordx2 v[200:201], v19, s[8:11], s50 offen offset:0
    buffer_load_dwordx2 v[202:203], v19, s[8:11], s50 offen offset:32
    buffer_load_dwordx2 v[204:205], v19, s[8:11], s50 offen offset:64
    buffer_load_dwordx2 v[206:207], v19, s[8:11], s50 offen offset:96
    buffer_load_dwordx2 v[208:209], v19, s[8:11], s50 offen offset:128
    s_waitcnt lgkmcnt(5)
    v_mfma_f32_32x32x16_bf16 v[72:87], v[36:39], v[108:111], v[72:87]
    ds_read_b128 v[24:27], v1 offset:22528
    s_waitcnt lgkmcnt(5)
    v_mfma_f32_32x32x16_bf16 v[88:103], v[40:43], v[108:111], v[88:103]
    ds_read_b128 v[28:31], v1 offset:23552
    s_waitcnt vmcnt(18) lgkmcnt(5)
    v_mfma_f32_32x32x16_bf16 v[56:71], v[44:47], v[112:115], v[56:71]
    ds_read_b128 v[32:35], v1 offset:24576
    s_waitcnt lgkmcnt(5)
    v_mfma_f32_32x32x16_bf16 v[72:87], v[48:51], v[112:115], v[72:87]
    ds_read_b128 v[36:39], v1 offset:25600
    s_waitcnt lgkmcnt(5)
    v_mfma_f32_32x32x16_bf16 v[88:103], v[52:55], v[112:115], v[88:103]
    ds_read_b128 v[40:43], v1 offset:26624
    s_waitcnt vmcnt(17) lgkmcnt(5)
    v_mfma_f32_32x32x16_bf16 v[56:71], v[20:23], v[116:119], v[56:71]
    ds_read_b128 v[44:47], v1 offset:27648
    s_waitcnt lgkmcnt(5)
    v_mfma_f32_32x32x16_bf16 v[72:87], v[24:27], v[116:119], v[72:87]
    ds_read_b128 v[48:51], v1 offset:28672
    s_waitcnt lgkmcnt(5)
    v_mfma_f32_32x32x16_bf16 v[88:103], v[28:31], v[116:119], v[88:103]
    ds_read_b128 v[52:55], v1 offset:29696
    s_waitcnt vmcnt(16) lgkmcnt(5)
    v_mfma_f32_32x32x16_bf16 v[56:71], v[32:35], v[120:123], v[56:71]
    s_waitcnt lgkmcnt(0)
    s_barrier
    ds_read_b128 v[20:23], v1 offset:30720
    v_mfma_f32_32x32x16_bf16 v[72:87], v[36:39], v[120:123], v[72:87]
    ds_read_b128 v[24:27], v1 offset:31744
    v_mfma_f32_32x32x16_bf16 v[88:103], v[40:43], v[120:123], v[88:103]
    ds_read_b128 v[28:31], v1 offset:32768
    s_waitcnt vmcnt(15)
    v_mfma_f32_32x32x16_bf16 v[56:71], v[44:47], v[124:127], v[56:71]
    ds_read_b128 v[32:35], v1 offset:33792
    v_mfma_f32_32x32x16_bf16 v[72:87], v[48:51], v[124:127], v[72:87]
    ds_read_b128 v[36:39], v1 offset:34816
    v_mfma_f32_32x32x16_bf16 v[88:103], v[52:55], v[124:127], v[88:103]
    ds_read_b128 v[40:43], v1 offset:35840
    s_waitcnt vmcnt(14) lgkmcnt(5)
    v_mfma_f32_32x32x16_bf16 v[56:71], v[20:23], v[128:131], v[56:71]
    ds_read_b128 v[44:47], v1 offset:36864
    s_waitcnt lgkmcnt(5)
    v_mfma_f32_32x32x16_bf16 v[72:87], v[24:27], v[128:131], v[72:87]
    ds_read_b128 v[48:51], v1 offset:37888
    s_waitcnt lgkmcnt(5)
    v_mfma_f32_32x32x16_bf16 v[88:103], v[28:31], v[128:131], v[88:103]
    ds_read_b128 v[52:55], v1 offset:38912
    s_waitcnt vmcnt(13) lgkmcnt(5)
    v_mfma_f32_32x32x16_bf16 v[56:71], v[32:35], v[132:135], v[56:71]
    ds_read_b128 v[20:23], v1 offset:39936
    s_waitcnt lgkmcnt(5)
    v_mfma_f32_32x32x16_bf16 v[72:87], v[36:39], v[132:135], v[72:87]
    ds_read_b128 v[24:27], v1 offset:40960
    s_waitcnt lgkmcnt(5)
    v_mfma_f32_32x32x16_bf16 v[88:103], v[40:43], v[132:135], v[88:103]
    ds_read_b128 v[28:31], v1 offset:41984
    s_waitcnt vmcnt(12) lgkmcnt(5)
    v_mfma_f32_32x32x16_bf16 v[56:71], v[44:47], v[136:139], v[56:71]
    ds_read_b128 v[32:35], v1 offset:43008
    s_waitcnt lgkmcnt(5)
    v_mfma_f32_32x32x16_bf16 v[72:87], v[48:51], v[136:139], v[72:87]
    ds_read_b128 v[36:39], v1 offset:44032
    s_waitcnt lgkmcnt(5)
    v_mfma_f32_32x32x16_bf16 v[88:103], v[52:55], v[136:139], v[88:103]
    ds_read_b128 v[40:43], v1 offset:45056
    s_waitcnt vmcnt(11) lgkmcnt(5)
    v_mfma_f32_32x32x16_bf16 v[56:71], v[20:23], v[140:143], v[56:71]
    ds_read_b128 v[44:47], v1 offset:46080
    s_waitcnt lgkmcnt(5)
    v_mfma_f32_32x32x16_bf16 v[72:87], v[24:27], v[140:143], v[72:87]
    ds_read_b128 v[48:51], v1 offset:49152
    s_waitcnt lgkmcnt(5)
    v_mfma_f32_32x32x16_bf16 v[88:103], v[28:31], v[140:143], v[88:103]
    ds_read_b128 v[52:55], v1 offset:52224
    s_waitcnt vmcnt(10) lgkmcnt(5)
    v_mfma_f32_32x32x16_bf16 v[56:71], v[32:35], v[144:147], v[56:71]
    ds_read_b128 v[20:23], v1 offset:55296
    s_waitcnt lgkmcnt(5)
    v_mfma_f32_32x32x16_bf16 v[72:87], v[36:39], v[144:147], v[72:87]
    ds_read_b128 v[24:27], v1 offset:58368
    s_waitcnt lgkmcnt(5)
    v_mfma_f32_32x32x16_bf16 v[88:103], v[40:43], v[144:147], v[88:103]
    v_mov_b32 v28, v229
    v_mov_b32 v29, v230
    v_mov_b32 v30, 0
    v_mov_b32 v31, 0
    s_waitcnt vmcnt(9) lgkmcnt(4)
    v_mfma_f32_32x32x16_bf16 v[56:71], v[44:47], v[148:151], v[56:71]
    ds_read_b128 v[32:35], v1 offset:47104
    s_waitcnt vmcnt(8) lgkmcnt(4)
    v_mfma_f32_32x32x16_bf16 v[56:71], v[48:51], v[152:155], v[56:71]
    ds_read_b128 v[36:39], v1 offset:50176
    s_waitcnt vmcnt(7) lgkmcnt(4)
    v_mfma_f32_32x32x16_bf16 v[56:71], v[52:55], v[156:159], v[56:71]
    ds_read_b128 v[40:43], v1 offset:53248
    s_waitcnt vmcnt(6) lgkmcnt(4)
    v_mfma_f32_32x32x16_bf16 v[56:71], v[20:23], v[160:163], v[56:71]
    ds_read_b128 v[44:47], v1 offset:56320
    s_waitcnt vmcnt(5) lgkmcnt(4)
    v_mfma_f32_32x32x16_bf16 v[56:71], v[24:27], v[164:167], v[56:71]
    ds_read_b128 v[48:51], v1 offset:59392
    v_mfma_f32_32x32x16_bf16 v[56:71], v[28:31], v[4:7], v[56:71]
    v_mov_b32 v52, v231
    v_mov_b32 v53, v232
    v_mov_b32 v54, 0
    v_mov_b32 v55, 0
    s_waitcnt lgkmcnt(4)
    v_mfma_f32_32x32x16_bf16 v[72:87], v[32:35], v[148:151], v[72:87]
    ds_read_b128 v[20:23], v1 offset:48128
    s_waitcnt lgkmcnt(4)
    v_mfma_f32_32x32x16_bf16 v[72:87], v[36:39], v[152:155], v[72:87]
    ds_read_b128 v[24:27], v1 offset:51200
    s_nop 1
    v_pk_mul_f32 v[56:57], v[56:57], v[16:17]
    v_pk_mul_f32 v[58:59], v[58:59], v[16:17]
    v_pk_mul_f32 v[60:61], v[60:61], v[16:17]
    v_pk_mul_f32 v[62:63], v[62:63], v[16:17]
    v_max_f32 v210, 0, v56
    v_max_f32 v211, 0, v57
    v_max_f32 v212, 0, v58
    v_max_f32 v213, 0, v59
    s_waitcnt lgkmcnt(4)
    v_mfma_f32_32x32x16_bf16 v[72:87], v[40:43], v[156:159], v[72:87]
    ds_read_b128 v[28:31], v1 offset:54272
    v_max_f32 v214, 0, v60
    v_max_f32 v215, 0, v61
    v_max_f32 v216, 0, v62
    v_max_f32 v217, 0, v63
    v_pk_mul_f32 v[210:211], v[210:211], v[210:211]
    v_pk_mul_f32 v[212:213], v[212:213], v[212:213]
    v_pk_mul_f32 v[214:215], v[214:215], v[214:215]
    v_pk_mul_f32 v[216:217], v[216:217], v[216:217]
    s_waitcnt lgkmcnt(4)
    v_mfma_f32_32x32x16_bf16 v[72:87], v[44:47], v[160:163], v[72:87]
    ds_read_b128 v[32:35], v1 offset:57344
    v_cvt_pk_bf16_f32 v56, v210, v211
    v_cvt_pk_bf16_f32 v57, v212, v213
    v_cvt_pk_bf16_f32 v58, v214, v215
    v_cvt_pk_bf16_f32 v59, v216, v217
    v_pk_mul_f32 v[64:65], v[64:65], v[16:17]
    v_pk_mul_f32 v[66:67], v[66:67], v[16:17]
    v_pk_mul_f32 v[68:69], v[68:69], v[16:17]
    v_pk_mul_f32 v[70:71], v[70:71], v[16:17]
    s_waitcnt lgkmcnt(4)
    v_mfma_f32_32x32x16_bf16 v[72:87], v[48:51], v[164:167], v[72:87]
    ds_read_b128 v[36:39], v1 offset:60416
    v_max_f32 v210, 0, v64
    v_max_f32 v211, 0, v65
    v_max_f32 v212, 0, v66
    v_max_f32 v213, 0, v67
    v_max_f32 v214, 0, v68
    v_max_f32 v215, 0, v69
    v_max_f32 v216, 0, v70
    v_max_f32 v217, 0, v71
    v_mfma_f32_32x32x16_bf16 v[72:87], v[52:55], v[4:7], v[72:87]
    v_mov_b32 v40, v233
    v_mov_b32 v41, v234
    v_mov_b32 v42, 0
    v_mov_b32 v43, 0
    v_pk_mul_f32 v[210:211], v[210:211], v[210:211]
    v_pk_mul_f32 v[212:213], v[212:213], v[212:213]
    v_pk_mul_f32 v[214:215], v[214:215], v[214:215]
    v_pk_mul_f32 v[216:217], v[216:217], v[216:217]
    v_cvt_pk_bf16_f32 v64, v210, v211
    v_cvt_pk_bf16_f32 v65, v212, v213
    v_cvt_pk_bf16_f32 v66, v214, v215
    v_cvt_pk_bf16_f32 v67, v216, v217
    s_cmp_eq_u32 s22, 0
    s_cbranch_scc1 du_88
    buffer_store_dwordx4 v[56:59], v1, s[4:7], s44 offen offset:0
    buffer_store_dwordx4 v[64:67], v1, s[4:7], s44 offen offset:1024
dur_89:
    s_waitcnt lgkmcnt(4)
    v_mfma_f32_32x32x16_bf16 v[88:103], v[20:23], v[148:151], v[88:103]
    s_waitcnt lgkmcnt(3)
    v_mfma_f32_32x32x16_bf16 v[88:103], v[24:27], v[152:155], v[88:103]
    v_pk_mul_f32 v[72:73], v[72:73], v[16:17]
    v_pk_mul_f32 v[74:75], v[74:75], v[16:17]
    v_pk_mul_f32 v[76:77], v[76:77], v[16:17]
    v_pk_mul_f32 v[78:79], v[78:79], v[16:17]
    v_max_f32 v210, 0, v72
    v_max_f32 v211, 0, v73
    v_max_f32 v212, 0, v74
    v_max_f32 v213, 0, v75
    s_waitcnt lgkmcnt(2)
    v_mfma_f32_32x32x16_bf16 v[88:103], v[28:31], v[156:159], v[88:103]
    v_max_f32 v214, 0, v76
    v_max_f32 v215, 0, v77
    v_max_f32 v216, 0, v78
    v_max_f32 v217, 0, v79
    v_pk_mul_f32 v[210:211], v[210:211], v[210:211]
    v_pk_mul_f32 v[212:213], v[212:213], v[212:213]
    v_pk_mul_f32 v[214:215], v[214:215], v[214:215]
    v_pk_mul_f32 v[216:217], v[216:217], v[216:217]
    s_waitcnt lgkmcnt(1)
    v_mfma_f32_32x32x16_bf16 v[88:103], v[32:35], v[160:163], v[88:103]
    v_cvt_pk_bf16_f32 v72, v210, v211
    v_cvt_pk_bf16_f32 v73, v212, v213
    v_cvt_pk_bf16_f32 v74, v214, v215
    v_cvt_pk_bf16_f32 v75, v216, v217
    v_pk_mul_f32 v[80:81], v[80:81], v[16:17]
    v_pk_mul_f32 v[82:83], v[82:83], v[16:17]
    v_pk_mul_f32 v[84:85], v[84:85], v[16:17]
    v_pk_mul_f32 v[86:87], v[86:87], v[16:17]
    s_waitcnt lgkmcnt(0)
    v_mfma_f32_32x32x16_bf16 v[88:103], v[36:39], v[164:167], v[88:103]
    v_max_f32 v210, 0, v80
    v_max_f32 v211, 0, v81
    v_max_f32 v212, 0, v82
    v_max_f32 v213, 0, v83
    v_max_f32 v214, 0, v84
    v_max_f32 v215, 0, v85
    v_max_f32 v216, 0, v86
    v_max_f32 v217, 0, v87
    v_mfma_f32_32x32x16_bf16 v[88:103], v[40:43], v[4:7], v[88:103]
    v_pk_mul_f32 v[210:211], v[210:211], v[210:211]
    v_pk_mul_f32 v[212:213], v[212:213], v[212:213]
    v_pk_mul_f32 v[214:215], v[214:215], v[214:215]
    v_pk_mul_f32 v[216:217], v[216:217], v[216:217]
    v_cvt_pk_bf16_f32 v80, v210, v211
    v_cvt_pk_bf16_f32 v81, v212, v213
    v_cvt_pk_bf16_f32 v82, v214, v215
    v_cvt_pk_bf16_f32 v83, v216, v217
    s_cmp_eq_u32 s22, 0
    s_cbranch_scc1 du_90
    buffer_store_dwordx4 v[72:75], v1, s[4:7], s44 offen offset:2048
    buffer_store_dwordx4 v[80:83], v1, s[4:7], s44 offen offset:3072
dur_91:
    v_pk_mul_f32 v[88:89], v[88:89], v[16:17]
    v_pk_mul_f32 v[90:91], v[90:91], v[16:17]
    v_pk_mul_f32 v[92:93], v[92:93], v[16:17]
    v_pk_mul_f32 v[94:95], v[94:95], v[16:17]
    v_max_f32 v210, 0, v88
    v_max_f32 v211, 0, v89
    v_max_f32 v212, 0, v90
    v_max_f32 v213, 0, v91
    v_max_f32 v214, 0, v92
    v_max_f32 v215, 0, v93
    v_max_f32 v216, 0, v94
    v_max_f32 v217, 0, v95
    v_pk_mul_f32 v[210:211], v[210:211], v[210:211]
    v_pk_mul_f32 v[212:213], v[212:213], v[212:213]
    v_pk_mul_f32 v[214:215], v[214:215], v[214:215]
    v_pk_mul_f32 v[216:217], v[216:217], v[216:217]
    v_cvt_pk_bf16_f32 v88, v210, v211
    v_cvt_pk_bf16_f32 v89, v212, v213
    v_cvt_pk_bf16_f32 v90, v214, v215
    v_cvt_pk_bf16_f32 v91, v216, v217
    v_pk_mul_f32 v[96:97], v[96:97], v[16:17]
    v_pk_mul_f32 v[98:99], v[98:99], v[16:17]
    v_pk_mul_f32 v[100:101], v[100:101], v[16:17]
    v_pk_mul_f32 v[102:103], v[102:103], v[16:17]
    v_max_f32 v210, 0, v96
    v_max_f32 v211, 0, v97
    v_max_f32 v212, 0, v98
    v_max_f32 v213, 0, v99
    v_max_f32 v214, 0, v100
    v_max_f32 v215, 0, v101
    v_max_f32 v216, 0, v102
    v_max_f32 v217, 0, v103
    v_pk_mul_f32 v[210:211], v[210:211], v[210:211]
    v_pk_mul_f32 v[212:213], v[212:213], v[212:213]
    v_pk_mul_f32 v[214:215], v[214:215], v[214:215]
    v_pk_mul_f32 v[216:217], v[216:217], v[216:217]
    v_cvt_pk_bf16_f32 v96, v210, v211
    v_cvt_pk_bf16_f32 v97, v212, v213
    v_cvt_pk_bf16_f32 v98, v214, v215
    v_cvt_pk_bf16_f32 v99, v216, v217
    s_cmp_eq_u32 s22, 0
    s_cbranch_scc1 du_92
    buffer_store_dwordx4 v[88:91], v1, s[4:7], s45 offen offset:0
    buffer_store_dwordx4 v[96:99], v1, s[4:7], s45 offen offset:1024
dur_93:
    s_lshl_b32 s40, s31, 7
    s_lshl_b32 s41, s30, 2
    s_add_u32 s40, s40, s41
    s_add_u32 s40, s40, s21
    s_add_u32 s40, s40, 270336
    v_mov_b32 v8, s100
    v_mov_b32 v9, 0
    s_waitcnt vmcnt(0)
    s_cmp_eq_u32 s22, 0
    s_cbranch_scc1 du_94
    s_mov_b64 exec, 1
    buffer_store_dword v8, v9, s[4:7], s40 offen
    s_mov_b64 exec, -1
dur_95:
    v_add_u32 v5, 61440, v1
    v_add_u32 v6, 122880, v1
    s_mul_i32 s44, s28, 98304
    s_lshl_b32 s45, s29, 8
    s_add_u32 s44, s44, s45
    s_add_u32 s44, s44, s101
    v_lshlrev_b32 v16, 16, v246
    v_and_b32 v17, 0xffff0000, v246
    v_lshlrev_b32 v18, 16, v247
    v_and_b32 v19, 0xffff0000, v247
    v_lshlrev_b32 v20, 16, v248
    v_and_b32 v21, 0xffff0000, v248
    v_lshlrev_b32 v22, 16, v249
    v_and_b32 v23, 0xffff0000, v249
    v_lshlrev_b32 v24, 16, v250
    v_and_b32 v25, 0xffff0000, v250
    v_lshlrev_b32 v26, 16, v251
    v_and_b32 v27, 0xffff0000, v251
    v_lshlrev_b32 v28, 16, v252
    v_and_b32 v29, 0xffff0000, v252
    v_lshlrev_b32 v30, 16, v253
    v_and_b32 v31, 0xffff0000, v253
    v_lshlrev_b32 v32, 16, v254
    v_and_b32 v33, 0xffff0000, v254
    v_lshlrev_b32 v34, 16, v255
    v_and_b32 v35, 0xffff0000, v255
    v_lshlrev_b32 v40, 16, v200
    v_and_b32 v41, 0xffff0000, v200
    v_lshlrev_b32 v42, 16, v201
    v_and_b32 v43, 0xffff0000, v201
    v_lshlrev_b32 v44, 16, v202
    v_and_b32 v45, 0xffff0000, v202
    v_lshlrev_b32 v46, 16, v203
    v_and_b32 v47, 0xffff0000, v203
    v_lshlrev_b32 v48, 16, v204
    v_and_b32 v49, 0xffff0000, v204
    v_lshlrev_b32 v50, 16, v205
    v_and_b32 v51, 0xffff0000, v205
    v_lshlrev_b32 v52, 16, v206
    v_and_b32 v53, 0xffff0000, v206
    v_lshlrev_b32 v54, 16, v207
    v_and_b32 v55, 0xffff0000, v207
    v_lshlrev_b32 v56, 16, v208
    v_and_b32 v57, 0xffff0000, v208
    v_lshlrev_b32 v58, 16, v209
    v_and_b32 v59, 0xffff0000, v209
    v_pk_add_f32 v[16:17], v[16:17], v[40:41]
    v_pk_add_f32 v[18:19], v[18:19], v[42:43]
    v_pk_add_f32 v[20:21], v[20:21], v[44:45]
    v_pk_add_f32 v[22:23], v[22:23], v[46:47]
    v_pk_add_f32 v[24:25], v[24:25], v[48:49]
    v_pk_add_f32 v[26:27], v[26:27], v[50:51]
    v_pk_add_f32 v[28:29], v[28:29], v[52:53]
    v_pk_add_f32 v[30:31], v[30:31], v[54:55]
    v_pk_add_f32 v[32:33], v[32:33], v[56:57]
    v_pk_add_f32 v[34:35], v[34:35], v[58:59]
    s_barrier
    ds_read_b128 v[40:43], v5 offset:5120
    ds_read_b128 v[44:47], v5 offset:6144
    ds_read_b128 v[48:51], v5 offset:7168
    ds_read_b128 v[52:55], v5 offset:8192
    ds_read_b128 v[56:59], v5 offset:9216
    ds_read_b128 v[60:63], v5 offset:10240
    ds_read_b128 v[64:67], v5 offset:11264
    ds_read_b128 v[68:71], v5 offset:12288
    ds_read_b128 v[72:75], v5 offset:13312
    ds_read_b128 v[76:79], v5 offset:14336
    s_lshl_b32 s40, s28, 7
    s_add_u32 s40, s40, s21
    s_add_u32 s40, s40, 270336
    s_mov_b64 exec, 0xffff
    s_mov_b32 s61, 0
pl_96:
    buffer_load_dword v7, v3, s[4:7], s40 offen sc1
    s_waitcnt vmcnt(0)
    v_cmp_ne_u32 vcc, s100, v7
    s_add_u32 s61, s61, 1
    s_nop 3
    s_cbranch_vccz pd_97
    s_cmp_ge_u32 s61, s23
    s_cbranch_scc1 to_98
    s_branch pl_96
pd_97:
    s_mov_b64 exec, -1
    s_cmp_eq_u32 s22, 0
    s_cbranch_scc1 inv_99
invr_100:
    buffer_load_dwordx4 v[100:103], v244, s[4:7], s44 offen offset:0 sc1
    buffer_load_dwordx4 v[104:107], v244, s[4:7], s44 offen offset:2048 sc1
    s_add_u32 s44, s44, 4096
    buffer_load_dwordx4 v[108:111], v244, s[4:7], s44 offen offset:0 sc1
    buffer_load_dwordx4 v[112:115], v244, s[4:7], s44 offen offset:2048 sc1
    s_add_u32 s44, s44, 4096
    s_waitcnt vmcnt(3) lgkmcnt(9)
    v_mfma_f32_16x16x32_bf16 v[16:19], v[40:43], v[100:103], v[16:19]
    ds_read_b128 v[80:83], v5 offset:15360
    s_waitcnt lgkmcnt(9)
    v_mfma_f32_16x16x32_bf16 v[20:23], v[44:47], v[100:103], v[20:23]
    ds_read_b128 v[84:87], v5 offset:16384
    buffer_load_dwordx4 v[116:119], v244, s[4:7], s44 offen offset:0 sc1
    s_waitcnt lgkmcnt(9)
    v_mfma_f32_16x16x32_bf16 v[24:27], v[48:51], v[100:103], v[24:27]
    ds_read_b128 v[88:91], v5 offset:17408
    s_waitcnt lgkmcnt(9)
    v_mfma_f32_16x16x32_bf16 v[28:31], v[52:55], v[100:103], v[28:31]
    ds_read_b128 v[92:95], v5 offset:18432
    buffer_load_dwordx4 v[120:123], v244, s[4:7], s44 offen offset:2048 sc1
    s_add_u32 s44, s44, 4096
    s_waitcnt lgkmcnt(9)
    v_mfma_f32_16x16x32_bf16 v[32:35], v[56:59], v[100:103], v[32:35]
    ds_read_b128 v[96:99], v5 offset:19456
    s_waitcnt vmcnt(4) lgkmcnt(9)
    v_mfma_f32_16x16x32_bf16 v[16:19], v[60:63], v[104:107], v[16:19]
    ds_read_b128 v[40:43], v5 offset:20480
    s_waitcnt lgkmcnt(9)
    v_mfma_f32_16x16x32_bf16 v[20:23], v[64:67], v[104:107], v[20:23]
    ds_read_b128 v[44:47], v5 offset:21504
    buffer_load_dwordx4 v[124:127], v244, s[4:7], s44 offen offset:0 sc1
    s_waitcnt lgkmcnt(9)
    v_mfma_f32_16x16x32_bf16 v[24:27], v[68:71], v[104:107], v[24:27]
    ds_read_b128 v[48:51], v5 offset:22528
    s_waitcnt lgkmcnt(9)
    v_mfma_f32_16x16x32_bf16 v[28:31], v[72:75], v[104:107], v[28:31]
    ds_read_b128 v[52:55], v5 offset:23552
    buffer_load_dwordx4 v[128:131], v244, s[4:7], s44 offen offset:2048 sc1
    s_add_u32 s44, s44, 4096
    s_waitcnt lgkmcnt(9)
    v_mfma_f32_16x16x32_bf16 v[32:35], v[76:79], v[104:107], v[32:35]
    ds_read_b128 v[56:59], v5 offset:24576
    s_waitcnt vmcnt(5) lgkmcnt(9)
    v_mfma_f32_16x16x32_bf16 v[16:19], v[80:83], v[108:111], v[16:19]
    ds_read_b128 v[60:63], v5 offset:25600
    s_waitcnt lgkmcnt(9)
    v_mfma_f32_16x16x32_bf16 v[20:23], v[84:87], v[108:111], v[20:23]
    ds_read_b128 v[64:67], v5 offset:26624
    buffer_load_dwordx4 v[132:135], v244, s[4:7], s44 offen offset:0 sc1
    s_waitcnt lgkmcnt(9)
    v_mfma_f32_16x16x32_bf16 v[24:27], v[88:91], v[108:111], v[24:27]
    ds_read_b128 v[68:71], v5 offset:27648
    s_waitcnt lgkmcnt(9)
    v_mfma_f32_16x16x32_bf16 v[28:31], v[92:95], v[108:111], v[28:31]
    ds_read_b128 v[72:75], v5 offset:28672
    buffer_load_dwordx4 v[136:139], v244, s[4:7], s44 offen offset:2048 sc1
    s_add_u32 s44, s44, 4096
    s_waitcnt lgkmcnt(9)
    v_mfma_f32_16x16x32_bf16 v[32:35], v[96:99], v[108:111], v[32:35]
    ds_read_b128 v[76:79], v5 offset:29696
    s_waitcnt vmcnt(6) lgkmcnt(9)
    v_mfma_f32_16x16x32_bf16 v[16:19], v[40:43], v[112:115], v[16:19]
    ds_read_b128 v[80:83], v5 offset:30720
    s_waitcnt lgkmcnt(9)
    v_mfma_f32_16x16x32_bf16 v[20:23], v[44:47], v[112:115], v[20:23]
    ds_read_b128 v[84:87], v5 offset:31744
    buffer_load_dwordx4 v[140:143], v244, s[4:7], s44 offen offset:0 sc1
    s_waitcnt lgkmcnt(9)
    v_mfma_f32_16x16x32_bf16 v[24:27], v[48:51], v[112:115], v[24:27]
    ds_read_b128 v[88:91], v5 offset:32768
    s_waitcnt lgkmcnt(9)
    v_mfma_f32_16x16x32_bf16 v[28:31], v[52:55], v[112:115], v[28:31]
    ds_read_b128 v[92:95], v5 offset:33792
    buffer_load_dwordx4 v[144:147], v244, s[4:7], s44 offen offset:2048 sc1
    s_add_u32 s44, s44, 4096
    s_waitcnt lgkmcnt(9)
    v_mfma_f32_16x16x32_bf16 v[32:35], v[56:59], v[112:115], v[32:35]
    ds_read_b128 v[96:99], v5 offset:34816
    s_waitcnt vmcnt(7) lgkmcnt(9)
    v_mfma_f32_16x16x32_bf16 v[16:19], v[60:63], v[116:119], v[16:19]
    ds_read_b128 v[40:43], v5 offset:35840
    s_waitcnt lgkmcnt(9)
    v_mfma_f32_16x16x32_bf16 v[20:23], v[64:67], v[116:119], v[20:23]
    ds_read_b128 v[44:47], v5 offset:36864
    buffer_load_dwordx4 v[148:151], v244, s[4:7], s44 offen offset:0 sc1
    s_waitcnt lgkmcnt(9)
    v_mfma_f32_16x16x32_bf16 v[24:27], v[68:71], v[116:119], v[24:27]
    ds_read_b128 v[48:51], v5 offset:37888
    s_waitcnt lgkmcnt(9)
    v_mfma_f32_16x16x32_bf16 v[28:31], v[72:75], v[116:119], v[28:31]
    ds_read_b128 v[52:55], v5 offset:38912
    buffer_load_dwordx4 v[152:155], v244, s[4:7], s44 offen offset:2048 sc1
    s_add_u32 s44, s44, 4096
    s_waitcnt lgkmcnt(9)
    v_mfma_f32_16x16x32_bf16 v[32:35], v[76:79], v[116:119], v[32:35]
    ds_read_b128 v[56:59], v5 offset:39936
    s_waitcnt vmcnt(8) lgkmcnt(9)
    v_mfma_f32_16x16x32_bf16 v[16:19], v[80:83], v[120:123], v[16:19]
    ds_read_b128 v[60:63], v5 offset:40960
    s_waitcnt lgkmcnt(9)
    v_mfma_f32_16x16x32_bf16 v[20:23], v[84:87], v[120:123], v[20:23]
    ds_read_b128 v[64:67], v5 offset:41984
    buffer_load_dwordx4 v[156:159], v244, s[4:7], s44 offen offset:0 sc1
    s_waitcnt lgkmcnt(9)
    v_mfma_f32_16x16x32_bf16 v[24:27], v[88:91], v[120:123], v[24:27]
    ds_read_b128 v[68:71], v5 offset:43008
    s_waitcnt lgkmcnt(9)
    v_mfma_f32_16x16x32_bf16 v[28:31], v[92:95], v[120:123], v[28:31]
    ds_read_b128 v[72:75], v5 offset:44032
    buffer_load_dwordx4 v[160:163], v244, s[4:7], s44 offen offset:2048 sc1
    s_add_u32 s44, s44, 4096
    s_waitcnt lgkmcnt(9)
    v_mfma_f32_16x16x32_bf16 v[32:35], v[96:99], v[120:123], v[32:35]
    ds_read_b128 v[76:79], v5 offset:45056
    s_waitcnt vmcnt(9) lgkmcnt(9)
    v_mfma_f32_16x16x32_bf16 v[16:19], v[40:43], v[124:127], v[16:19]
    s_waitcnt lgkmcnt(0)
    s_barrier
    ds_read_b128 v[80:83], v5 offset:46080
    v_mfma_f32_16x16x32_bf16 v[20:23], v[44:47], v[124:127], v[20:23]
    ds_read_b128 v[84:87], v5 offset:47104
    buffer_load_dwordx4 v[164:167], v244, s[4:7], s44 offen offset:0 sc1
    v_mfma_f32_16x16x32_bf16 v[24:27], v[48:51], v[124:127], v[24:27]
    ds_read_b128 v[88:91], v5 offset:48128
    v_mfma_f32_16x16x32_bf16 v[28:31], v[52:55], v[124:127], v[28:31]
    ds_read_b128 v[92:95], v5 offset:49152
    buffer_load_dwordx4 v[168:171], v244, s[4:7], s44 offen offset:2048 sc1
    s_add_u32 s44, s44, 4096
    v_mfma_f32_16x16x32_bf16 v[32:35], v[56:59], v[124:127], v[32:35]
    ds_read_b128 v[96:99], v5 offset:50176
    s_waitcnt vmcnt(10)
    v_mfma_f32_16x16x32_bf16 v[16:19], v[60:63], v[128:131], v[16:19]
    ds_read_b128 v[40:43], v5 offset:51200
    v_mfma_f32_16x16x32_bf16 v[20:23], v[64:67], v[128:131], v[20:23]
    ds_read_b128 v[44:47], v5 offset:52224
    buffer_load_dwordx4 v[172:175], v244, s[4:7], s44 offen offset:0 sc1
    v_mfma_f32_16x16x32_bf16 v[24:27], v[68:71], v[128:131], v[24:27]
    ds_read_b128 v[48:51], v5 offset:53248
    v_mfma_f32_16x16x32_bf16 v[28:31], v[72:75], v[128:131], v[28:31]
    ds_read_b128 v[52:55], v5 offset:54272
    buffer_load_dwordx4 v[176:179], v244, s[4:7], s44 offen offset:2048 sc1
    s_add_u32 s44, s44, 4096
    v_mfma_f32_16x16x32_bf16 v[32:35], v[76:79], v[128:131], v[32:35]
    ds_read_b128 v[56:59], v5 offset:55296
    s_waitcnt vmcnt(11) lgkmcnt(9)
    v_mfma_f32_16x16x32_bf16 v[16:19], v[80:83], v[132:135], v[16:19]
    ds_read_b128 v[60:63], v5 offset:56320
    s_waitcnt lgkmcnt(9)
    v_mfma_f32_16x16x32_bf16 v[20:23], v[84:87], v[132:135], v[20:23]
    ds_read_b128 v[64:67], v5 offset:57344
    buffer_load_dwordx4 v[180:183], v244, s[4:7], s44 offen offset:0 sc1
    s_waitcnt lgkmcnt(9)
    v_mfma_f32_16x16x32_bf16 v[24:27], v[88:91], v[132:135], v[24:27]
    ds_read_b128 v[68:71], v5 offset:58368
    s_waitcnt lgkmcnt(9)
    v_mfma_f32_16x16x32_bf16 v[28:31], v[92:95], v[132:135], v[28:31]
    ds_read_b128 v[72:75], v5 offset:59392
    buffer_load_dwordx4 v[184:187], v244, s[4:7], s44 offen offset:2048 sc1
    s_add_u32 s44, s44, 4096
    s_waitcnt lgkmcnt(9)
    v_mfma_f32_16x16x32_bf16 v[32:35], v[96:99], v[132:135], v[32:35]
    ds_read_b128 v[76:79], v5 offset:60416
    s_waitcnt vmcnt(12) lgkmcnt(9)
    v_mfma_f32_16x16x32_bf16 v[16:19], v[40:43], v[136:139], v[16:19]
    ds_read_b128 v[80:83], v6 offset:0
    s_waitcnt lgkmcnt(9)
    v_mfma_f32_16x16x32_bf16 v[20:23], v[44:47], v[136:139], v[20:23]
    ds_read_b128 v[84:87], v6 offset:1024
    buffer_load_dwordx4 v[188:191], v244, s[4:7], s44 offen offset:0 sc1
    s_waitcnt lgkmcnt(9)
    v_mfma_f32_16x16x32_bf16 v[24:27], v[48:51], v[136:139], v[24:27]
    ds_read_b128 v[88:91], v6 offset:2048
    s_waitcnt lgkmcnt(9)
    v_mfma_f32_16x16x32_bf16 v[28:31], v[52:55], v[136:139], v[28:31]
    ds_read_b128 v[92:95], v6 offset:3072
    buffer_load_dwordx4 v[192:195], v244, s[4:7], s44 offen offset:2048 sc1
    s_add_u32 s44, s44, 4096
    s_waitcnt lgkmcnt(9)
    v_mfma_f32_16x16x32_bf16 v[32:35], v[56:59], v[136:139], v[32:35]
    ds_read_b128 v[96:99], v6 offset:4096
    s_waitcnt vmcnt(13) lgkmcnt(9)
    v_mfma_f32_16x16x32_bf16 v[16:19], v[60:63], v[140:143], v[16:19]
    ds_read_b128 v[40:43], v6 offset:5120
    s_waitcnt lgkmcnt(9)
    v_mfma_f32_16x16x32_bf16 v[20:23], v[64:67], v[140:143], v[20:23]
    ds_read_b128 v[44:47], v6 offset:6144
    buffer_load_dwordx4 v[100:103], v244, s[4:7], s44 offen offset:0 sc1
    s_waitcnt lgkmcnt(9)
    v_mfma_f32_16x16x32_bf16 v[24:27], v[68:71], v[140:143], v[24:27]
    ds_read_b128 v[48:51], v6 offset:7168
    s_waitcnt lgkmcnt(9)
    v_mfma_f32_16x16x32_bf16 v[28:31], v[72:75], v[140:143], v[28:31]
    ds_read_b128 v[52:55], v6 offset:8192
    buffer_load_dwordx4 v[104:107], v244, s[4:7], s44 offen offset:2048 sc1
    s_add_u32 s44, s44, 4096
    s_waitcnt lgkmcnt(9)
    v_mfma_f32_16x16x32_bf16 v[32:35], v[76:79], v[140:143], v[32:35]
    ds_read_b128 v[56:59], v6 offset:9216
    s_waitcnt vmcnt(14) lgkmcnt(9)
    v_mfma_f32_16x16x32_bf16 v[16:19], v[80:83], v[144:147], v[16:19]
    ds_read_b128 v[60:63], v6 offset:10240
    s_waitcnt lgkmcnt(9)
    v_mfma_f32_16x16x32_bf16 v[20:23], v[84:87], v[144:147], v[20:23]
    ds_read_b128 v[64:67], v6 offset:11264
    buffer_load_dwordx4 v[108:111], v244, s[4:7], s44 offen offset:0 sc1
    s_waitcnt lgkmcnt(9)
    v_mfma_f32_16x16x32_bf16 v[24:27], v[88:91], v[144:147], v[24:27]
    ds_read_b128 v[68:71], v6 offset:12288
    s_waitcnt lgkmcnt(9)
    v_mfma_f32_16x16x32_bf16 v[28:31], v[92:95], v[144:147], v[28:31]
    ds_read_b128 v[72:75], v6 offset:13312
    s_waitcnt lgkmcnt(9)
    v_mfma_f32_16x16x32_bf16 v[32:35], v[96:99], v[144:147], v[32:35]
    ds_read_b128 v[76:79], v6 offset:14336
    s_waitcnt vmcnt(14) lgkmcnt(9)
    v_mfma_f32_16x16x32_bf16 v[16:19], v[40:43], v[148:151], v[16:19]
    ds_read_b128 v[80:83], v6 offset:15360
    s_waitcnt lgkmcnt(9)
    v_mfma_f32_16x16x32_bf16 v[20:23], v[44:47], v[148:151], v[20:23]
    ds_read_b128 v[84:87], v6 offset:16384
    buffer_load_dwordx4 v[112:115], v244, s[4:7], s44 offen offset:2048 sc1
    s_add_u32 s44, s44, 4096
    s_waitcnt lgkmcnt(9)
    v_mfma_f32_16x16x32_bf16 v[24:27], v[48:51], v[148:151], v[24:27]
    ds_read_b128 v[88:91], v6 offset:17408
    s_waitcnt lgkmcnt(9)
    v_mfma_f32_16x16x32_bf16 v[28:31], v[52:55], v[148:151], v[28:31]
    ds_read_b128 v[92:95], v6 offset:18432
    s_waitcnt lgkmcnt(9)
    v_mfma_f32_16x16x32_bf16 v[32:35], v[56:59], v[148:151], v[32:35]
    ds_read_b128 v[96:99], v6 offset:19456
    s_waitcnt vmcnt(14) lgkmcnt(9)
    v_mfma_f32_16x16x32_bf16 v[16:19], v[60:63], v[152:155], v[16:19]
    ds_read_b128 v[40:43], v6 offset:20480
    s_waitcnt lgkmcnt(9)
    v_mfma_f32_16x16x32_bf16 v[20:23], v[64:67], v[152:155], v[20:23]
    ds_read_b128 v[44:47], v6 offset:21504
    buffer_load_dwordx4 v[116:119], v244, s[4:7], s44 offen offset:0 sc1
    s_waitcnt lgkmcnt(9)
    v_mfma_f32_16x16x32_bf16 v[24:27], v[68:71], v[152:155], v[24:27]
    ds_read_b128 v[48:51], v6 offset:22528
    s_waitcnt lgkmcnt(9)
    v_mfma_f32_16x16x32_bf16 v[28:31], v[72:75], v[152:155], v[28:31]
    ds_read_b128 v[52:55], v6 offset:23552
    s_waitcnt lgkmcnt(9)
    v_mfma_f32_16x16x32_bf16 v[32:35], v[76:79], v[152:155], v[32:35]
    ds_read_b128 v[56:59], v6 offset:24576
    s_waitcnt vmcnt(14) lgkmcnt(9)
    v_mfma_f32_16x16x32_bf16 v[16:19], v[80:83], v[156:159], v[16:19]
    s_waitcnt lgkmcnt(0)
    s_barrier
    ds_read_b128 v[60:63], v6 offset:25600
    v_mfma_f32_16x16x32_bf16 v[20:23], v[84:87], v[156:159], v[20:23]
    ds_read_b128 v[64:67], v6 offset:26624
    buffer_load_dwordx4 v[120:123], v244, s[4:7], s44 offen offset:2048 sc1
    s_add_u32 s44, s44, 4096
    v_mfma_f32_16x16x32_bf16 v[24:27], v[88:91], v[156:159], v[24:27]
    ds_read_b128 v[68:71], v6 offset:27648
    v_mfma_f32_16x16x32_bf16 v[28:31], v[92:95], v[156:159], v[28:31]
    ds_read_b128 v[72:75], v6 offset:28672
    v_mfma_f32_16x16x32_bf16 v[32:35], v[96:99], v[156:159], v[32:35]
    ds_read_b128 v[76:79], v6 offset:29696
    s_waitcnt vmcnt(14)
    v_mfma_f32_16x16x32_bf16 v[16:19], v[40:43], v[160:163], v[16:19]
    ds_read_b128 v[80:83], v6 offset:30720
    v_mfma_f32_16x16x32_bf16 v[20:23], v[44:47], v[160:163], v[20:23]
    ds_read_b128 v[84:87], v6 offset:31744
    buffer_load_dwordx4 v[124:127], v244, s[4:7], s44 offen offset:0 sc1
    v_mfma_f32_16x16x32_bf16 v[24:27], v[48:51], v[160:163], v[24:27]
    ds_read_b128 v[88:91], v6 offset:32768
    v_mfma_f32_16x16x32_bf16 v[28:31], v[52:55], v[160:163], v[28:31]
    ds_read_b128 v[92:95], v6 offset:33792
    v_mfma_f32_16x16x32_bf16 v[32:35], v[56:59], v[160:163], v[32:35]
    ds_read_b128 v[96:99], v6 offset:34816
    s_waitcnt vmcnt(14) lgkmcnt(9)
    v_mfma_f32_16x16x32_bf16 v[16:19], v[60:63], v[164:167], v[16:19]
    ds_read_b128 v[40:43], v6 offset:35840
    s_waitcnt lgkmcnt(9)
    v_mfma_f32_16x16x32_bf16 v[20:23], v[64:67], v[164:167], v[20:23]
    ds_read_b128 v[44:47], v6 offset:36864
    buffer_load_dwordx4 v[128:131], v244, s[4:7], s44 offen offset:2048 sc1
    s_add_u32 s44, s44, 4096
    s_waitcnt lgkmcnt(9)
    v_mfma_f32_16x16x32_bf16 v[24:27], v[68:71], v[164:167], v[24:27]
    ds_read_b128 v[48:51], v6 offset:37888
    s_waitcnt lgkmcnt(9)
    v_mfma_f32_16x16x32_bf16 v[28:31], v[72:75], v[164:167], v[28:31]
    ds_read_b128 v[52:55], v6 offset:38912
    s_waitcnt lgkmcnt(9)
    v_mfma_f32_16x16x32_bf16 v[32:35], v[76:79], v[164:167], v[32:35]
    ds_read_b128 v[56:59], v6 offset:39936
    s_waitcnt vmcnt(14) lgkmcnt(9)
    v_mfma_f32_16x16x32_bf16 v[16:19], v[80:83], v[168:171], v[16:19]
    ds_read_b128 v[60:63], v1 offset:0
    s_waitcnt lgkmcnt(9)
    v_mfma_f32_16x16x32_bf16 v[20:23], v[84:87], v[168:171], v[20:23]
    ds_read_b128 v[64:67], v1 offset:1024
    buffer_load_dwordx4 v[132:135], v244, s[4:7], s44 offen offset:0 sc1
    s_waitcnt lgkmcnt(9)
    v_mfma_f32_16x16x32_bf16 v[24:27], v[88:91], v[168:171], v[24:27]
    ds_read_b128 v[68:71], v1 offset:2048
    s_waitcnt lgkmcnt(9)
    v_mfma_f32_16x16x32_bf16 v[28:31], v[92:95], v[168:171], v[28:31]
    ds_read_b128 v[72:75], v1 offset:3072
    s_waitcnt lgkmcnt(9)
    v_mfma_f32_16x16x32_bf16 v[32:35], v[96:99], v[168:171], v[32:35]
    ds_read_b128 v[76:79], v1 offset:4096
    s_waitcnt vmcnt(14) lgkmcnt(9)
    v_mfma_f32_16x16x32_bf16 v[16:19], v[40:43], v[172:175], v[16:19]
    ds_read_b128 v[80:83], v1 offset:5120
    s_waitcnt lgkmcnt(9)
    v_mfma_f32_16x16x32_bf16 v[20:23], v[44:47], v[172:175], v[20:23]
    ds_read_b128 v[84:87], v1 offset:6144
    buffer_load_dwordx4 v[136:139], v244, s[4:7], s44 offen offset:2048 sc1
    s_add_u32 s44, s44, 4096
    s_waitcnt lgkmcnt(9)
    v_mfma_f32_16x16x32_bf16 v[24:27], v[48:51], v[172:175], v[24:27]
    ds_read_b128 v[88:91], v1 offset:7168
    s_waitcnt lgkmcnt(9)
    v_mfma_f32_16x16x32_bf16 v[28:31], v[52:55], v[172:175], v[28:31]
    ds_read_b128 v[92:95], v1 offset:8192
    s_waitcnt lgkmcnt(9)
    v_mfma_f32_16x16x32_bf16 v[32:35], v[56:59], v[172:175], v[32:35]
    ds_read_b128 v[96:99], v1 offset:9216
    s_waitcnt vmcnt(14) lgkmcnt(9)
    v_mfma_f32_16x16x32_bf16 v[16:19], v[60:63], v[176:179], v[16:19]
    ds_read_b128 v[40:43], v1 offset:10240
    s_waitcnt lgkmcnt(9)
    v_mfma_f32_16x16x32_bf16 v[20:23], v[64:67], v[176:179], v[20:23]
    ds_read_b128 v[44:47], v1 offset:11264
    buffer_load_dwordx4 v[140:143], v244, s[4:7], s44 offen offset:0 sc1
    s_waitcnt lgkmcnt(9)
    v_mfma_f32_16x16x32_bf16 v[24:27], v[68:71], v[176:179], v[24:27]
    ds_read_b128 v[48:51], v1 offset:12288
    s_waitcnt lgkmcnt(9)
    v_mfma_f32_16x16x32_bf16 v[28:31], v[72:75], v[176:179], v[28:31]
    ds_read_b128 v[52:55], v1 offset:13312
    s_waitcnt lgkmcnt(9)
    v_mfma_f32_16x16x32_bf16 v[32:35], v[76:79], v[176:179], v[32:35]
    ds_read_b128 v[56:59], v1 offset:14336
    s_waitcnt vmcnt(14) lgkmcnt(9)
    v_mfma_f32_16x16x32_bf16 v[16:19], v[80:83], v[180:183], v[16:19]
    ds_read_b128 v[60:63], v1 offset:15360
    s_waitcnt lgkmcnt(9)
    v_mfma_f32_16x16x32_bf16 v[20:23], v[84:87], v[180:183], v[20:23]
    ds_read_b128 v[64:67], v1 offset:16384
    buffer_load_dwordx4 v[144:147], v244, s[4:7], s44 offen offset:2048 sc1
    s_add_u32 s44, s44, 4096
    s_waitcnt lgkmcnt(9)
    v_mfma_f32_16x16x32_bf16 v[24:27], v[88:91], v[180:183], v[24:27]
    ds_read_b128 v[68:71], v1 offset:17408
    s_waitcnt lgkmcnt(9)
    v_mfma_f32_16x16x32_bf16 v[28:31], v[92:95], v[180:183], v[28:31]
    ds_read_b128 v[72:75], v1 offset:18432
    s_waitcnt lgkmcnt(9)
    v_mfma_f32_16x16x32_bf16 v[32:35], v[96:99], v[180:183], v[32:35]
    ds_read_b128 v[76:79], v1 offset:19456
    s_waitcnt vmcnt(14) lgkmcnt(9)
    v_mfma_f32_16x16x32_bf16 v[16:19], v[40:43], v[184:187], v[16:19]
    ds_read_b128 v[80:83], v1 offset:20480
    s_waitcnt lgkmcnt(9)
    v_mfma_f32_16x16x32_bf16 v[20:23], v[44:47], v[184:187], v[20:23]
    ds_read_b128 v[84:87], v1 offset:21504
    buffer_load_dwordx4 v[148:151], v244, s[4:7], s44 offen offset:0 sc1
    s_waitcnt lgkmcnt(9)
    v_mfma_f32_16x16x32_bf16 v[24:27], v[48:51], v[184:187], v[24:27]
    ds_read_b128 v[88:91], v1 offset:22528
    s_waitcnt lgkmcnt(9)
    v_mfma_f32_16x16x32_bf16 v[28:31], v[52:55], v[184:187], v[28:31]
    ds_read_b128 v[92:95], v1 offset:23552
    s_waitcnt lgkmcnt(9)
    v_mfma_f32_16x16x32_bf16 v[32:35], v[56:59], v[184:187], v[32:35]
    ds_read_b128 v[96:99], v1 offset:24576
    s_waitcnt vmcnt(14) lgkmcnt(9)
    v_mfma_f32_16x16x32_bf16 v[16:19], v[60:63], v[188:191], v[16:19]
    ds_read_b128 v[40:43], v1 offset:25600
    s_waitcnt lgkmcnt(9)
    v_mfma_f32_16x16x32_bf16 v[20:23], v[64:67], v[188:191], v[20:23]
    ds_read_b128 v[44:47], v1 offset:26624
    buffer_load_dwordx4 v[152:155], v244, s[4:7], s44 offen offset:2048 sc1
    s_add_u32 s44, s44, 4096
    s_waitcnt lgkmcnt(9)
    v_mfma_f32_16x16x32_bf16 v[24:27], v[68:71], v[188:191], v[24:27]
    ds_read_b128 v[48:51], v1 offset:27648
    s_waitcnt lgkmcnt(9)
    v_mfma_f32_16x16x32_bf16 v[28:31], v[72:75], v[188:191], v[28:31]
    ds_read_b128 v[52:55], v1 offset:28672
    s_waitcnt lgkmcnt(9)
    v_mfma_f32_16x16x32_bf16 v[32:35], v[76:79], v[188:191], v[32:35]
    ds_read_b128 v[56:59], v1 offset:29696
    s_waitcnt vmcnt(14) lgkmcnt(9)
    v_mfma_f32_16x16x32_bf16 v[16:19], v[80:83], v[192:195], v[16:19]
    ds_read_b128 v[60:63], v1 offset:30720
    s_waitcnt lgkmcnt(9)
    v_mfma_f32_16x16x32_bf16 v[20:23], v[84:87], v[192:195], v[20:23]
    ds_read_b128 v[64:67], v1 offset:31744
    buffer_load_dwordx4 v[156:159], v244, s[4:7], s44 offen offset:0 sc1
    s_waitcnt lgkmcnt(9)
    v_mfma_f32_16x16x32_bf16 v[24:27], v[88:91], v[192:195], v[24:27]
    ds_read_b128 v[68:71], v1 offset:32768
    s_waitcnt lgkmcnt(9)
    v_mfma_f32_16x16x32_bf16 v[28:31], v[92:95], v[192:195], v[28:31]
    ds_read_b128 v[72:75], v1 offset:33792
    s_waitcnt lgkmcnt(9)
    v_mfma_f32_16x16x32_bf16 v[32:35], v[96:99], v[192:195], v[32:35]
    ds_read_b128 v[76:79], v1 offset:34816
    s_waitcnt vmcnt(14) lgkmcnt(9)
    v_mfma_f32_16x16x32_bf16 v[16:19], v[40:43], v[100:103], v[16:19]
    ds_read_b128 v[80:83], v1 offset:35840
    s_waitcnt lgkmcnt(9)
    v_mfma_f32_16x16x32_bf16 v[20:23], v[44:47], v[100:103], v[20:23]
    ds_read_b128 v[84:87], v1 offset:36864
    buffer_load_dwordx4 v[160:163], v244, s[4:7], s44 offen offset:2048 sc1
    s_add_u32 s44, s44, 4096
    s_waitcnt lgkmcnt(9)
    v_mfma_f32_16x16x32_bf16 v[24:27], v[48:51], v[100:103], v[24:27]
    ds_read_b128 v[88:91], v1 offset:37888
    s_waitcnt lgkmcnt(9)
    v_mfma_f32_16x16x32_bf16 v[28:31], v[52:55], v[100:103], v[28:31]
    ds_read_b128 v[92:95], v1 offset:38912
    s_waitcnt lgkmcnt(9)
    v_mfma_f32_16x16x32_bf16 v[32:35], v[56:59], v[100:103], v[32:35]
    ds_read_b128 v[96:99], v1 offset:39936
    s_waitcnt vmcnt(14) lgkmcnt(9)
    v_mfma_f32_16x16x32_bf16 v[16:19], v[60:63], v[104:107], v[16:19]
    ds_read_b128 v[40:43], v1 offset:40960
    s_waitcnt lgkmcnt(9)
    v_mfma_f32_16x16x32_bf16 v[20:23], v[64:67], v[104:107], v[20:23]
    ds_read_b128 v[44:47], v1 offset:41984
    buffer_load_dwordx4 v[164:167], v244, s[4:7], s44 offen offset:0 sc1
    s_waitcnt lgkmcnt(9)
    v_mfma_f32_16x16x32_bf16 v[24:27], v[68:71], v[104:107], v[24:27]
    ds_read_b128 v[48:51], v1 offset:43008
    s_waitcnt lgkmcnt(9)
    v_mfma_f32_16x16x32_bf16 v[28:31], v[72:75], v[104:107], v[28:31]
    ds_read_b128 v[52:55], v1 offset:44032
    s_waitcnt lgkmcnt(9)
    v_mfma_f32_16x16x32_bf16 v[32:35], v[76:79], v[104:107], v[32:35]
    ds_read_b128 v[56:59], v1 offset:45056
    s_waitcnt vmcnt(14) lgkmcnt(9)
    v_mfma_f32_16x16x32_bf16 v[16:19], v[80:83], v[108:111], v[16:19]
    ds_read_b128 v[60:63], v1 offset:46080
    s_waitcnt lgkmcnt(9)
    v_mfma_f32_16x16x32_bf16 v[20:23], v[84:87], v[108:111], v[20:23]
    ds_read_b128 v[64:67], v1 offset:47104
    buffer_load_dwordx4 v[168:171], v244, s[4:7], s44 offen offset:2048 sc1
    s_add_u32 s44, s44, 4096
    s_waitcnt lgkmcnt(9)
    v_mfma_f32_16x16x32_bf16 v[24:27], v[88:91], v[108:111], v[24:27]
    ds_read_b128 v[68:71], v1 offset:48128
    s_waitcnt lgkmcnt(9)
    v_mfma_f32_16x16x32_bf16 v[28:31], v[92:95], v[108:111], v[28:31]
    ds_read_b128 v[72:75], v1 offset:49152
    s_waitcnt lgkmcnt(9)
    v_mfma_f32_16x16x32_bf16 v[32:35], v[96:99], v[108:111], v[32:35]
    ds_read_b128 v[76:79], v1 offset:50176
    s_waitcnt vmcnt(14) lgkmcnt(9)
    v_mfma_f32_16x16x32_bf16 v[16:19], v[40:43], v[112:115], v[16:19]
    ds_read_b128 v[80:83], v1 offset:51200
    s_waitcnt lgkmcnt(9)
    v_mfma_f32_16x16x32_bf16 v[20:23], v[44:47], v[112:115], v[20:23]
    ds_read_b128 v[84:87], v1 offset:52224
    buffer_load_dwordx4 v[172:175], v244, s[4:7], s44 offen offset:0 sc1
    s_waitcnt lgkmcnt(9)
    v_mfma_f32_16x16x32_bf16 v[24:27], v[48:51], v[112:115], v[24:27]
    ds_read_b128 v[88:91], v1 offset:53248
    s_waitcnt lgkmcnt(9)
    v_mfma_f32_16x16x32_bf16 v[28:31], v[52:55], v[112:115], v[28:31]
    ds_read_b128 v[92:95], v1 offset:54272
    s_waitcnt lgkmcnt(9)
    v_mfma_f32_16x16x32_bf16 v[32:35], v[56:59], v[112:115], v[32:35]
    ds_read_b128 v[96:99], v1 offset:55296
    s_waitcnt vmcnt(14) lgkmcnt(9)
    v_mfma_f32_16x16x32_bf16 v[16:19], v[60:63], v[116:119], v[16:19]
    ds_read_b128 v[40:43], v1 offset:56320
    s_waitcnt lgkmcnt(9)
    v_mfma_f32_16x16x32_bf16 v[20:23], v[64:67], v[116:119], v[20:23]
    ds_read_b128 v[44:47], v1 offset:57344
    buffer_load_dwordx4 v[176:179], v244, s[4:7], s44 offen offset:2048 sc1
    s_add_u32 s44, s44, 4096
    s_waitcnt lgkmcnt(9)
    v_mfma_f32_16x16x32_bf16 v[24:27], v[68:71], v[116:119], v[24:27]
    ds_read_b128 v[48:51], v1 offset:58368
    s_waitcnt lgkmcnt(9)
    v_mfma_f32_16x16x32_bf16 v[28:31], v[72:75], v[116:119], v[28:31]
    ds_read_b128 v[52:55], v1 offset:59392
    s_waitcnt lgkmcnt(9)
    v_mfma_f32_16x16x32_bf16 v[32:35], v[76:79], v[116:119], v[32:35]
    ds_read_b128 v[56:59], v1 offset:60416
    s_waitcnt vmcnt(14) lgkmcnt(9)
    v_mfma_f32_16x16x32_bf16 v[16:19], v[80:83], v[120:123], v[16:19]
    ds_read_b128 v[60:63], v5 offset:0
    s_waitcnt lgkmcnt(9)
    v_mfma_f32_16x16x32_bf16 v[20:23], v[84:87], v[120:123], v[20:23]
    ds_read_b128 v[64:67], v5 offset:1024
    buffer_load_dwordx4 v[180:183], v244, s[4:7], s44 offen offset:0 sc1
    s_waitcnt lgkmcnt(9)
    v_mfma_f32_16x16x32_bf16 v[24:27], v[88:91], v[120:123], v[24:27]
    ds_read_b128 v[68:71], v5 offset:2048
    s_waitcnt lgkmcnt(9)
    v_mfma_f32_16x16x32_bf16 v[28:31], v[92:95], v[120:123], v[28:31]
    ds_read_b128 v[72:75], v5 offset:3072
    s_waitcnt lgkmcnt(9)
    v_mfma_f32_16x16x32_bf16 v[32:35], v[96:99], v[120:123], v[32:35]
    ds_read_b128 v[76:79], v5 offset:4096
    s_waitcnt vmcnt(14) lgkmcnt(9)
    v_mfma_f32_16x16x32_bf16 v[16:19], v[40:43], v[124:127], v[16:19]
    s_waitcnt lgkmcnt(0)
    s_barrier
    ds_read_b128 v[80:83], v5 offset:5120
    v_mfma_f32_16x16x32_bf16 v[20:23], v[44:47], v[124:127], v[20:23]
    ds_read_b128 v[84:87], v5 offset:6144
    buffer_load_dwordx4 v[184:187], v244, s[4:7], s44 offen offset:2048 sc1
    s_add_u32 s44, s44, 4096
    v_mfma_f32_16x16x32_bf16 v[24:27], v[48:51], v[124:127], v[24:27]
    ds_read_b128 v[88:91], v5 offset:7168
    v_mfma_f32_16x16x32_bf16 v[28:31], v[52:55], v[124:127], v[28:31]
    ds_read_b128 v[92:95], v5 offset:8192
    v_mfma_f32_16x16x32_bf16 v[32:35], v[56:59], v[124:127], v[32:35]
    ds_read_b128 v[96:99], v5 offset:9216
    s_waitcnt vmcnt(14)
    v_mfma_f32_16x16x32_bf16 v[16:19], v[60:63], v[128:131], v[16:19]
    ds_read_b128 v[40:43], v5 offset:10240
    v_mfma_f32_16x16x32_bf16 v[20:23], v[64:67], v[128:131], v[20:23]
    ds_read_b128 v[44:47], v5 offset:11264
    buffer_load_dwordx4 v[188:191], v244, s[4:7], s44 offen offset:0 sc1
    v_mfma_f32_16x16x32_bf16 v[24:27], v[68:71], v[128:131], v[24:27]
    ds_read_b128 v[48:51], v5 offset:12288
    v_mfma_f32_16x16x32_bf16 v[28:31], v[72:75], v[128:131], v[28:31]
    ds_read_b128 v[52:55], v5 offset:13312
    v_mfma_f32_16x16x32_bf16 v[32:35], v[76:79], v[128:131], v[32:35]
    ds_read_b128 v[56:59], v5 offset:14336
    s_waitcnt vmcnt(14) lgkmcnt(9)
    v_mfma_f32_16x16x32_bf16 v[16:19], v[80:83], v[132:135], v[16:19]
    ds_read_b128 v[60:63], v5 offset:15360
    s_waitcnt lgkmcnt(9)
    v_mfma_f32_16x16x32_bf16 v[20:23], v[84:87], v[132:135], v[20:23]
    ds_read_b128 v[64:67], v5 offset:16384
    buffer_load_dwordx4 v[192:195], v244, s[4:7], s44 offen offset:2048 sc1
    s_add_u32 s44, s44, 4096
    s_waitcnt lgkmcnt(9)
    v_mfma_f32_16x16x32_bf16 v[24:27], v[88:91], v[132:135], v[24:27]
    ds_read_b128 v[68:71], v5 offset:17408
    s_waitcnt lgkmcnt(9)
    v_mfma_f32_16x16x32_bf16 v[28:31], v[92:95], v[132:135], v[28:31]
    ds_read_b128 v[72:75], v5 offset:18432
    s_waitcnt lgkmcnt(9)
    v_mfma_f32_16x16x32_bf16 v[32:35], v[96:99], v[132:135], v[32:35]
    ds_read_b128 v[76:79], v5 offset:19456
    s_waitcnt vmcnt(14) lgkmcnt(9)
    v_mfma_f32_16x16x32_bf16 v[16:19], v[40:43], v[136:139], v[16:19]
    ds_read_b128 v[80:83], v5 offset:20480
    s_waitcnt lgkmcnt(9)
    v_mfma_f32_16x16x32_bf16 v[20:23], v[44:47], v[136:139], v[20:23]
    ds_read_b128 v[84:87], v5 offset:21504
    s_waitcnt lgkmcnt(9)
    v_mfma_f32_16x16x32_bf16 v[24:27], v[48:51], v[136:139], v[24:27]
    ds_read_b128 v[88:91], v5 offset:22528
    s_waitcnt lgkmcnt(9)
    v_mfma_f32_16x16x32_bf16 v[28:31], v[52:55], v[136:139], v[28:31]
    ds_read_b128 v[92:95], v5 offset:23552
    s_waitcnt lgkmcnt(9)
    v_mfma_f32_16x16x32_bf16 v[32:35], v[56:59], v[136:139], v[32:35]
    ds_read_b128 v[96:99], v5 offset:24576
    s_waitcnt vmcnt(13) lgkmcnt(9)
    v_mfma_f32_16x16x32_bf16 v[16:19], v[60:63], v[140:143], v[16:19]
    ds_read_b128 v[40:43], v5 offset:25600
    s_waitcnt lgkmcnt(9)
    v_mfma_f32_16x16x32_bf16 v[20:23], v[64:67], v[140:143], v[20:23]
    ds_read_b128 v[44:47], v5 offset:26624
    s_waitcnt lgkmcnt(9)
    v_mfma_f32_16x16x32_bf16 v[24:27], v[68:71], v[140:143], v[24:27]
    ds_read_b128 v[48:51], v5 offset:27648
    s_waitcnt lgkmcnt(9)
    v_mfma_f32_16x16x32_bf16 v[28:31], v[72:75], v[140:143], v[28:31]
    ds_read_b128 v[52:55], v5 offset:28672
    s_waitcnt lgkmcnt(9)
    v_mfma_f32_16x16x32_bf16 v[32:35], v[76:79], v[140:143], v[32:35]
    ds_read_b128 v[56:59], v5 offset:29696
    s_waitcnt vmcnt(12) lgkmcnt(9)
    v_mfma_f32_16x16x32_bf16 v[16:19], v[80:83], v[144:147], v[16:19]
    ds_read_b128 v[60:63], v5 offset:30720
    s_waitcnt lgkmcnt(9)
    v_mfma_f32_16x16x32_bf16 v[20:23], v[84:87], v[144:147], v[20:23]
    ds_read_b128 v[64:67], v5 offset:31744
    s_waitcnt lgkmcnt(9)
    v_mfma_f32_16x16x32_bf16 v[24:27], v[88:91], v[144:147], v[24:27]
    ds_read_b128 v[68:71], v5 offset:32768
    s_waitcnt lgkmcnt(9)
    v_mfma_f32_16x16x32_bf16 v[28:31], v[92:95], v[144:147], v[28:31]
    ds_read_b128 v[72:75], v5 offset:33792
    s_waitcnt lgkmcnt(9)
    v_mfma_f32_16x16x32_bf16 v[32:35], v[96:99], v[144:147], v[32:35]
    ds_read_b128 v[76:79], v5 offset:34816
    s_waitcnt vmcnt(11) lgkmcnt(9)
    v_mfma_f32_16x16x32_bf16 v[16:19], v[40:43], v[148:151], v[16:19]
    ds_read_b128 v[80:83], v5 offset:35840
    s_waitcnt lgkmcnt(9)
    v_mfma_f32_16x16x32_bf16 v[20:23], v[44:47], v[148:151], v[20:23]
    ds_read_b128 v[84:87], v5 offset:36864
    s_waitcnt lgkmcnt(9)
    v_mfma_f32_16x16x32_bf16 v[24:27], v[48:51], v[148:151], v[24:27]
    ds_read_b128 v[88:91], v5 offset:37888
    s_waitcnt lgkmcnt(9)
    v_mfma_f32_16x16x32_bf16 v[28:31], v[52:55], v[148:151], v[28:31]
    ds_read_b128 v[92:95], v5 offset:38912
    s_waitcnt lgkmcnt(9)
    v_mfma_f32_16x16x32_bf16 v[32:35], v[56:59], v[148:151], v[32:35]
    ds_read_b128 v[96:99], v5 offset:39936
    s_waitcnt vmcnt(10) lgkmcnt(9)
    v_mfma_f32_16x16x32_bf16 v[16:19], v[60:63], v[152:155], v[16:19]
    ds_read_b128 v[40:43], v5 offset:40960
    s_waitcnt lgkmcnt(9)
    v_mfma_f32_16x16x32_bf16 v[20:23], v[64:67], v[152:155], v[20:23]
    ds_read_b128 v[44:47], v5 offset:41984
    s_waitcnt lgkmcnt(9)
    v_mfma_f32_16x16x32_bf16 v[24:27], v[68:71], v[152:155], v[24:27]
    ds_read_b128 v[48:51], v5 offset:43008
    s_waitcnt lgkmcnt(9)
    v_mfma_f32_16x16x32_bf16 v[28:31], v[72:75], v[152:155], v[28:31]
    ds_read_b128 v[52:55], v5 offset:44032
    s_waitcnt lgkmcnt(9)
    v_mfma_f32_16x16x32_bf16 v[32:35], v[76:79], v[152:155], v[32:35]
    ds_read_b128 v[56:59], v5 offset:45056
    s_waitcnt vmcnt(9) lgkmcnt(9)
    v_mfma_f32_16x16x32_bf16 v[16:19], v[80:83], v[156:159], v[16:19]
    ds_read_b128 v[60:63], v5 offset:46080
    s_waitcnt lgkmcnt(9)
    v_mfma_f32_16x16x32_bf16 v[20:23], v[84:87], v[156:159], v[20:23]
    ds_read_b128 v[64:67], v5 offset:47104
    s_waitcnt lgkmcnt(9)
    v_mfma_f32_16x16x32_bf16 v[24:27], v[88:91], v[156:159], v[24:27]
    ds_read_b128 v[68:71], v5 offset:48128
    s_waitcnt lgkmcnt(9)
    v_mfma_f32_16x16x32_bf16 v[28:31], v[92:95], v[156:159], v[28:31]
    ds_read_b128 v[72:75], v5 offset:49152
    s_waitcnt lgkmcnt(9)
    v_mfma_f32_16x16x32_bf16 v[32:35], v[96:99], v[156:159], v[32:35]
    ds_read_b128 v[76:79], v5 offset:50176
    s_waitcnt vmcnt(8) lgkmcnt(9)
    v_mfma_f32_16x16x32_bf16 v[16:19], v[40:43], v[160:163], v[16:19]
    ds_read_b128 v[80:83], v5 offset:51200
    s_waitcnt lgkmcnt(9)
    v_mfma_f32_16x16x32_bf16 v[20:23], v[44:47], v[160:163], v[20:23]
    ds_read_b128 v[84:87], v5 offset:52224
    s_waitcnt lgkmcnt(9)
    v_mfma_f32_16x16x32_bf16 v[24:27], v[48:51], v[160:163], v[24:27]
    ds_read_b128 v[88:91], v5 offset:53248
    s_waitcnt lgkmcnt(9)
    v_mfma_f32_16x16x32_bf16 v[28:31], v[52:55], v[160:163], v[28:31]
    ds_read_b128 v[92:95], v5 offset:54272
    s_waitcnt lgkmcnt(9)
    v_mfma_f32_16x16x32_bf16 v[32:35], v[56:59], v[160:163], v[32:35]
    ds_read_b128 v[96:99], v5 offset:55296
    s_waitcnt vmcnt(7) lgkmcnt(9)
    v_mfma_f32_16x16x32_bf16 v[16:19], v[60:63], v[164:167], v[16:19]
    ds_read_b128 v[40:43], v5 offset:56320
    s_waitcnt lgkmcnt(9)
    v_mfma_f32_16x16x32_bf16 v[20:23], v[64:67], v[164:167], v[20:23]
    ds_read_b128 v[44:47], v5 offset:57344
    s_waitcnt lgkmcnt(9)
    v_mfma_f32_16x16x32_bf16 v[24:27], v[68:71], v[164:167], v[24:27]
    ds_read_b128 v[48:51], v5 offset:58368
    s_waitcnt lgkmcnt(9)
    v_mfma_f32_16x16x32_bf16 v[28:31], v[72:75], v[164:167], v[28:31]
    ds_read_b128 v[52:55], v5 offset:59392
    s_waitcnt lgkmcnt(9)
    v_mfma_f32_16x16x32_bf16 v[32:35], v[76:79], v[164:167], v[32:35]
    ds_read_b128 v[56:59], v5 offset:60416
    s_waitcnt vmcnt(6) lgkmcnt(9)
    v_mfma_f32_16x16x32_bf16 v[16:19], v[80:83], v[168:171], v[16:19]
    ds_read_b128 v[60:63], v6 offset:0
    s_waitcnt lgkmcnt(9)
    v_mfma_f32_16x16x32_bf16 v[20:23], v[84:87], v[168:171], v[20:23]
    ds_read_b128 v[64:67], v6 offset:1024
    s_waitcnt lgkmcnt(9)
    v_mfma_f32_16x16x32_bf16 v[24:27], v[88:91], v[168:171], v[24:27]
    ds_read_b128 v[68:71], v6 offset:2048
    s_waitcnt lgkmcnt(9)
    v_mfma_f32_16x16x32_bf16 v[28:31], v[92:95], v[168:171], v[28:31]
    ds_read_b128 v[72:75], v6 offset:3072
    s_waitcnt lgkmcnt(9)
    v_mfma_f32_16x16x32_bf16 v[32:35], v[96:99], v[168:171], v[32:35]
    ds_read_b128 v[76:79], v6 offset:4096
    s_waitcnt vmcnt(5) lgkmcnt(9)
    v_mfma_f32_16x16x32_bf16 v[16:19], v[40:43], v[172:175], v[16:19]
    ds_read_b128 v[80:83], v6 offset:5120
    s_waitcnt lgkmcnt(9)
    v_mfma_f32_16x16x32_bf16 v[20:23], v[44:47], v[172:175], v[20:23]
    ds_read_b128 v[84:87], v6 offset:6144
    s_waitcnt lgkmcnt(9)
    v_mfma_f32_16x16x32_bf16 v[24:27], v[48:51], v[172:175], v[24:27]
    ds_read_b128 v[88:91], v6 offset:7168
    s_waitcnt lgkmcnt(9)
    v_mfma_f32_16x16x32_bf16 v[28:31], v[52:55], v[172:175], v[28:31]
    ds_read_b128 v[92:95], v6 offset:8192
    s_waitcnt lgkmcnt(9)
    v_mfma_f32_16x16x32_bf16 v[32:35], v[56:59], v[172:175], v[32:35]
    ds_read_b128 v[96:99], v6 offset:9216
    s_waitcnt vmcnt(4) lgkmcnt(9)
    v_mfma_f32_16x16x32_bf16 v[16:19], v[60:63], v[176:179], v[16:19]
    ds_read_b128 v[40:43], v6 offset:10240
    s_waitcnt lgkmcnt(9)
    v_mfma_f32_16x16x32_bf16 v[20:23], v[64:67], v[176:179], v[20:23]
    ds_read_b128 v[44:47], v6 offset:11264
    s_waitcnt lgkmcnt(9)
    v_mfma_f32_16x16x32_bf16 v[24:27], v[68:71], v[176:179], v[24:27]
    ds_read_b128 v[48:51], v6 offset:12288
    s_waitcnt lgkmcnt(9)
    v_mfma_f32_16x16x32_bf16 v[28:31], v[72:75], v[176:179], v[28:31]
    ds_read_b128 v[52:55], v6 offset:13312
    s_waitcnt lgkmcnt(9)
    v_mfma_f32_16x16x32_bf16 v[32:35], v[76:79], v[176:179], v[32:35]
    ds_read_b128 v[56:59], v6 offset:14336
    s_waitcnt vmcnt(3) lgkmcnt(9)
    v_mfma_f32_16x16x32_bf16 v[16:19], v[80:83], v[180:183], v[16:19]
    ds_read_b128 v[60:63], v6 offset:15360
    s_waitcnt lgkmcnt(9)
    v_mfma_f32_16x16x32_bf16 v[20:23], v[84:87], v[180:183], v[20:23]
    ds_read_b128 v[64:67], v6 offset:16384
    s_waitcnt lgkmcnt(9)
    v_mfma_f32_16x16x32_bf16 v[24:27], v[88:91], v[180:183], v[24:27]
    ds_read_b128 v[68:71], v6 offset:17408
    s_waitcnt lgkmcnt(9)
    v_mfma_f32_16x16x32_bf16 v[28:31], v[92:95], v[180:183], v[28:31]
    ds_read_b128 v[72:75], v6 offset:18432
    s_waitcnt lgkmcnt(9)
    v_mfma_f32_16x16x32_bf16 v[32:35], v[96:99], v[180:183], v[32:35]
    ds_read_b128 v[76:79], v6 offset:19456
    s_waitcnt vmcnt(2) lgkmcnt(9)
    v_mfma_f32_16x16x32_bf16 v[16:19], v[40:43], v[184:187], v[16:19]
    ds_read_b128 v[80:83], v6 offset:20480
    s_waitcnt lgkmcnt(9)
    v_mfma_f32_16x16x32_bf16 v[20:23], v[44:47], v[184:187], v[20:23]
    ds_read_b128 v[84:87], v6 offset:21504
    s_waitcnt lgkmcnt(9)
    v_mfma_f32_16x16x32_bf16 v[24:27], v[48:51], v[184:187], v[24:27]
    ds_read_b128 v[88:91], v6 offset:22528
    s_waitcnt lgkmcnt(9)
    v_mfma_f32_16x16x32_bf16 v[28:31], v[52:55], v[184:187], v[28:31]
    ds_read_b128 v[92:95], v6 offset:23552
    s_waitcnt lgkmcnt(9)
    v_mfma_f32_16x16x32_bf16 v[32:35], v[56:59], v[184:187], v[32:35]
    ds_read_b128 v[96:99], v6 offset:24576
    s_waitcnt vmcnt(1) lgkmcnt(9)
    v_mfma_f32_16x16x32_bf16 v[16:19], v[60:63], v[188:191], v[16:19]
    s_waitcnt lgkmcnt(8)
    v_mfma_f32_16x16x32_bf16 v[20:23], v[64:67], v[188:191], v[20:23]
    s_waitcnt lgkmcnt(7)
    v_mfma_f32_16x16x32_bf16 v[24:27], v[68:71], v[188:191], v[24:27]
    s_waitcnt lgkmcnt(6)
    v_mfma_f32_16x16x32_bf16 v[28:31], v[72:75], v[188:191], v[28:31]
    s_waitcnt lgkmcnt(5)
    v_mfma_f32_16x16x32_bf16 v[32:35], v[76:79], v[188:191], v[32:35]
    s_waitcnt vmcnt(0) lgkmcnt(4)
    v_mfma_f32_16x16x32_bf16 v[16:19], v[80:83], v[192:195], v[16:19]
    s_waitcnt lgkmcnt(3)
    v_mfma_f32_16x16x32_bf16 v[20:23], v[84:87], v[192:195], v[20:23]
    s_waitcnt lgkmcnt(2)
    v_mfma_f32_16x16x32_bf16 v[24:27], v[88:91], v[192:195], v[24:27]
    s_waitcnt lgkmcnt(1)
    v_mfma_f32_16x16x32_bf16 v[28:31], v[92:95], v[192:195], v[28:31]
    s_waitcnt lgkmcnt(0)
    v_mfma_f32_16x16x32_bf16 v[32:35], v[96:99], v[192:195], v[32:35]
    v_cvt_pk_bf16_f32 v246, v16, v17
    v_cvt_pk_bf16_f32 v247, v18, v19
    v_cvt_pk_bf16_f32 v248, v20, v21
    v_cvt_pk_bf16_f32 v249, v22, v23
    v_cvt_pk_bf16_f32 v250, v24, v25
    v_cvt_pk_bf16_f32 v251, v26, v27
    v_cvt_pk_bf16_f32 v252, v28, v29
    v_cvt_pk_bf16_f32 v253, v30, v31
    v_cvt_pk_bf16_f32 v254, v32, v33
    v_cvt_pk_bf16_f32 v255, v34, v35
    s_cmp_lg_u32 s39, 0
    s_cbranch_scc1 p5f_101
    s_add_u32 s56, s21, 409600
    s_cmp_eq_u32 s22, 0
    s_cbranch_scc1 du_102
    s_bitcmp1_b32 s25, 0
    s_cbranch_scc1 xo_104
    buffer_store_dwordx4 v[246:249], v244, s[4:7], s34 offen
    buffer_store_dwordx4 v[250:253], v244, s[4:7], s36 offen
    buffer_store_dwordx2 v[254:255], v244, s[4:7], s38 offen
    s_branch xj_105
xo_104:
    buffer_store_dwordx4 v[248:251], v244, s[4:7], s35 offen
    buffer_store_dwordx4 v[252:255], v244, s[4:7], s37 offen
    buffer_store_dwordx2 v[246:247], v244, s[4:7], s34 offen
xj_105:
dur_103:
    s_barrier
    v_pk_mul_f32 v[42:43], v[16:17], v[16:17]
    v_pk_add_f32 v[40:41], v[16:17], v[18:19]
    v_pk_fma_f32 v[42:43], v[18:19], v[18:19], v[42:43]
    v_pk_add_f32 v[40:41], v[40:41], v[20:21]
    v_pk_fma_f32 v[42:43], v[20:21], v[20:21], v[42:43]
    v_pk_add_f32 v[40:41], v[40:41], v[22:23]
    v_pk_fma_f32 v[42:43], v[22:23], v[22:23], v[42:43]
    v_pk_add_f32 v[40:41], v[40:41], v[24:25]
    v_pk_fma_f32 v[42:43], v[24:25], v[24:25], v[42:43]
    v_pk_add_f32 v[40:41], v[40:41], v[26:27]
    v_pk_fma_f32 v[42:43], v[26:27], v[26:27], v[42:43]
    v_pk_add_f32 v[40:41], v[40:41], v[28:29]
    v_pk_fma_f32 v[42:43], v[28:29], v[28:29], v[42:43]
    v_pk_add_f32 v[40:41], v[40:41], v[30:31]
    v_pk_fma_f32 v[42:43], v[30:31], v[30:31], v[42:43]
    v_pk_add_f32 v[40:41], v[40:41], v[32:33]
    v_pk_fma_f32 v[42:43], v[32:33], v[32:33], v[42:43]
    v_pk_add_f32 v[40:41], v[40:41], v[34:35]
    v_pk_fma_f32 v[42:43], v[34:35], v[34:35], v[42:43]
    v_add_f32 v40, v40, v41
    v_add_f32 v41, v42, v43
    v_mov_b32 v42, v40
    v_mov_b32 v43, v41
    s_nop 0
    v_permlane16_swap_b32 v40, v42
    v_permlane16_swap_b32 v41, v43
    v_pk_add_f32 v[40:41], v[40:41], v[42:43]
    v_mov_b32 v42, v40
    v_mov_b32 v43, v41
    s_nop 0
    v_permlane32_swap_b32 v40, v42
    v_permlane32_swap_b32 v41, v43
    v_pk_add_f32 v[40:41], v[40:41], v[42:43]
    v_or_b32 v41, 0x80000000, v41
    s_lshl_b32 s40, s28, 3
    s_add_u32 s40, s40, s25
    s_lshl_b32 s40, s40, 8
    s_lshl_b32 s41, s29, 7
    s_add_u32 s40, s40, s41
    s_add_u32 s40, s40, s56
    s_add_u32 s40, s40, 0
    s_waitcnt vmcnt(0)
    s_cmp_eq_u32 s22, 0
    s_cbranch_scc1 du_106
    s_mov_b64 exec, 0xffff
    buffer_store_dwordx2 v[40:41], v2, s[4:7], s40 offen
    s_mov_b64 exec, -1
dur_107:
    s_mov_b32 s39, 1
    s_add_u32 s20, s20, 6291456
    s_add_u32 s21, s21, 409600
    s_branch layer_top
p5f_101:
    s_lshl_b32 s40, s28, 5
    s_lshl_b32 s41, s29, 4
    s_add_u32 s40, s40, s41
    s_mul_i32 s40, s40, 1280
    s_mul_i32 s41, s25, 160
    s_add_u32 s40, s40, s41
    v_and_b32 v14, 15, v0
    v_lshrrev_b32 v15, 4, v0
    v_mul_u32_u24 v11, 1280, v14
    v_lshl_add_u32 v11, v15, 3, v11
    buffer_store_dwordx2 v[246:247], v11, s[12:15], s40 offen offset:0
    buffer_store_dwordx2 v[248:249], v11, s[12:15], s40 offen offset:32
    buffer_store_dwordx2 v[250:251], v11, s[12:15], s40 offen offset:64
    buffer_store_dwordx2 v[252:253], v11, s[12:15], s40 offen offset:96
    buffer_store_dwordx2 v[254:255], v11, s[12:15], s40 offen offset:128
main_fin:
    s_nop 1
interleave_layers__sliding_block__dense_activation_squared_relu__prompt_kernel_end:
    s_endpgm
service:
    v_lshlrev_b32 v15, 7, v0
    v_mov_b32 v59, v4
    v_bfe_u32 v60, v0, 2, 2
    v_and_b32 v61, 3, v0
    v_mov_b32 v58, 0
    s_cmp_ge_u32 s26, 2
    s_cbranch_scc1 ot_20001
    s_cmp_ge_u32 s17, 20
    s_cbranch_scc1 ot_20001
    v_bfe_u32 v16, v0, 4, 1
    v_lshl_add_u32 v16, v16, 2, v61
    v_lshlrev_b32 v17, 3, v16
    v_mov_b32 v18, 0
    v_mov_b32 v19, 4088
    v_cmp_le_u32 vcc, 5, v16
    s_nop 1
    v_cndmask_b32 v18, v18, v19, vcc
    v_mov_b32 v19, 8144
    v_cmp_le_u32 vcc, 6, v16
    s_nop 1
    v_cndmask_b32 v18, v18, v19, vcc
    v_add_u32 v68, v17, v18
    v_mov_b32 v18, 4096
    v_mov_b32 v19, 8176
    v_cmp_le_u32 vcc, 4, v16
    s_nop 1
    v_cndmask_b32 v18, v18, v19, vcc
    v_add_u32 v69, v17, v18
    v_cmp_eq_u32 vcc, 7, v16
    s_nop 1
    v_cndmask_b32 v69, v69, 0, vcc
    v_mul_u32_u24 v16, 160, v60
    v_lshl_add_u32 v16, v4, 10, v16
    v_add3_u32 v68, v68, v16, s34
    v_add3_u32 v69, v69, v16, s34
    s_lshl_b32 s35, s17, 1
    s_add_u32 s35, s35, s26
    s_mul_i32 s40, s16, 327680
    s_lshl_b32 s41, s35, 11
    s_add_u32 s40, s40, s41
    s_waitcnt vmcnt(0)
    ds_read_b64_tr_b16 v[72:73], v68 offset:0
    ds_read_b64_tr_b16 v[74:75], v68 offset:2048
    ds_read_b64_tr_b16 v[76:77], v69 offset:0
    ds_read_b64_tr_b16 v[78:79], v69 offset:2048
    ds_read_b64_tr_b16 v[80:81], v68 offset:40
    ds_read_b64_tr_b16 v[82:83], v68 offset:2088
    ds_read_b64_tr_b16 v[84:85], v69 offset:40
    ds_read_b64_tr_b16 v[86:87], v69 offset:2088
    ds_read_b64_tr_b16 v[88:89], v68 offset:80
    ds_read_b64_tr_b16 v[90:91], v68 offset:2128
    ds_read_b64_tr_b16 v[92:93], v69 offset:80
    ds_read_b64_tr_b16 v[94:95], v69 offset:2128
    ds_read_b64_tr_b16 v[96:97], v68 offset:120
    ds_read_b64_tr_b16 v[98:99], v68 offset:2168
    ds_read_b64_tr_b16 v[100:101], v69 offset:120
    ds_read_b64_tr_b16 v[102:103], v69 offset:2168
    s_waitcnt lgkmcnt(14)
    buffer_store_dwordx4 v[72:75], v1, s[4:7], s40 offen offset:0 sc1
    s_waitcnt lgkmcnt(12)
    buffer_store_dwordx4 v[76:79], v1, s[4:7], s40 offen offset:1024 sc1
    s_add_u32 s40, s40, 81920
    s_waitcnt lgkmcnt(10)
    buffer_store_dwordx4 v[80:83], v1, s[4:7], s40 offen offset:0 sc1
    s_waitcnt lgkmcnt(8)
    buffer_store_dwordx4 v[84:87], v1, s[4:7], s40 offen offset:1024 sc1
    s_add_u32 s40, s40, 81920
    s_waitcnt lgkmcnt(6)
    buffer_store_dwordx4 v[88:91], v1, s[4:7], s40 offen offset:0 sc1
    s_waitcnt lgkmcnt(4)
    buffer_store_dwordx4 v[92:95], v1, s[4:7], s40 offen offset:1024 sc1
    s_add_u32 s40, s40, 81920
    s_waitcnt lgkmcnt(2)
    buffer_store_dwordx4 v[96:99], v1, s[4:7], s40 offen offset:0 sc1
    s_waitcnt lgkmcnt(0)
    buffer_store_dwordx4 v[100:103], v1, s[4:7], s40 offen offset:1024 sc1
    s_add_u32 s40, s40, 81920
    s_barrier
    s_mov_b32 s61, 0
pl_20005:
    v_mov_b32 v7, 0
    buffer_load_dword v7, v7, s[48:51], 0 offen sc1
    s_waitcnt vmcnt(0)
ck_20007:
    s_nop 0
    v_cmp_eq_u32 vcc, 0, v7
    s_add_u32 s61, s61, 1
    s_nop 3
    s_cbranch_vccz pd_20006
    s_cmp_ge_u32 s61, s23
    s_cbranch_scc1 to_20008
    s_branch pl_20005
pd_20006:
    v_readfirstlane_b32 s100, v7
    v_mov_b32 v16, 159752
    v_mov_b32 v17, 1
    s_mov_b64 exec, 1
    ds_add_rtn_u32 v17, v16, v17
    s_cmp_lt_u32 s17, 20
    s_cselect_b32 s40, 5, 3
    s_waitcnt lgkmcnt(0)
    v_cmp_ne_u32 vcc, s40, v17
    s_nop 4
    s_cbranch_vccnz ar_20009
    s_lshr_b32 s40, s27, 2
    s_lshl_b32 s40, s40, 7
    s_add_u32 s40, s40, 5373952
    v_mov_b32 v16, 0
    v_mov_b32 v17, s100
    buffer_store_dword v17, v16, s[4:7], s40 offen sc1
ar_20009:
    s_nop 1
    s_mov_b64 exec, -1
    s_branch non_20004j
ot_20001:
    s_waitcnt lgkmcnt(0)
    s_lshl_b32 s58, s26, 8
    s_add_u32 s58, s58, s2
    s_sub_u32 s58, s58, 512
    s_lshl_b32 s41, s2, 1
    s_add_u32 s41, s41, s26
    s_add_u32 s41, s41, 192
    s_cmp_lt_u32 s26, 2
    s_cselect_b32 s58, s41, s58
    s_lshl_b32 s41, s26, 5
    s_add_u32 s41, s41, s17
    s_cmp_lt_u32 s41, 20
    s_cselect_b32 s58, 9999, s58
    s_sub_u32 s41, s41, 32
    s_cmp_lt_u32 s41, 20
    s_cselect_b32 s58, 9999, s58
    s_barrier
    s_cmp_ge_u32 s58, 580
    s_cbranch_scc1 non_20010
    v_bfe_u32 v16, v0, 3, 2
    v_and_b32 v17, 7, v0
    v_lshlrev_b32 v17, 4, v17
    s_cmp_ge_u32 s58, 240
    s_cbranch_scc1 n16_20012
    s_load_dwordx2 s[44:45], s[0:1], 32
    s_mov_b32 s46, 0x1e0000
    s_mul_i32 s59, s58, 205
    s_lshr_b32 s59, s59, 11
    s_mul_i32 s60, s59, 10
    s_sub_u32 s60, s58, s60
    v_lshrrev_b32 v64, 3, v0
    v_mul_u32_u24 v64, 3072, v64
    v_add_u32 v64, v64, v17
    s_mul_i32 s40, s60, 196608
    s_lshl_b32 s41, s59, 7
    s_add_u32 s40, s40, s41
    s_waitcnt lgkmcnt(0)
    s_add_u32 s41, s34, 0
    s_mov_b32 m0, s41
    s_add_u32 s42, s40, 0
    buffer_load_dwordx4 v64, s[44:47], s42 offen lds
    s_add_u32 s41, s34, 1024
    s_mov_b32 m0, s41
    s_add_u32 s42, s40, 49152
    buffer_load_dwordx4 v64, s[44:47], s42 offen lds
    s_add_u32 s41, s34, 2048
    s_mov_b32 m0, s41
    s_add_u32 s42, s40, 24576
    buffer_load_dwordx4 v64, s[44:47], s42 offen lds
    s_add_u32 s41, s34, 3072
    s_mov_b32 m0, s41
    s_add_u32 s42, s40, 73728
    buffer_load_dwordx4 v64, s[44:47], s42 offen lds
    s_add_u32 s41, s34, 4096
    s_mov_b32 m0, s41
    s_add_u32 s42, s40, 98304
    buffer_load_dwordx4 v64, s[44:47], s42 offen lds
    s_add_u32 s41, s34, 5120
    s_mov_b32 m0, s41
    s_add_u32 s42, s40, 147456
    buffer_load_dwordx4 v64, s[44:47], s42 offen lds
    s_add_u32 s41, s34, 6144
    s_mov_b32 m0, s41
    s_add_u32 s42, s40, 122880
    buffer_load_dwordx4 v64, s[44:47], s42 offen lds
    s_add_u32 s41, s34, 7168
    s_mov_b32 m0, s41
    s_add_u32 s42, s40, 172032
    buffer_load_dwordx4 v64, s[44:47], s42 offen lds
    v_lshl_add_u32 v68, v59, 2, v60
    v_lshlrev_b32 v68, 7, v68
    v_bfe_u32 v16, v0, 4, 1
    v_lshl_add_u32 v68, v16, 5, v68
    v_lshl_add_u32 v68, v61, 3, v68
    v_add_u32 v68, s34, v68
    s_lshl_b32 s41, s59, 1
    s_add_u32 s41, s41, 0
    s_mul_i32 s42, s41, 171
    s_lshr_b32 s42, s42, 9
    s_mul_i32 s43, s42, 3
    s_sub_u32 s43, s41, s43
    s_mul_i32 s36, s42, 122880
    s_lshl_b32 s43, s43, 10
    s_add_u32 s36, s36, s43
    s_mul_i32 s43, s60, 12288
    s_add_u32 s36, s36, s43
    s_add_u32 s36, s36, 6332416
    s_lshl_b32 s41, s59, 1
    s_add_u32 s41, s41, 1
    s_mul_i32 s42, s41, 171
    s_lshr_b32 s42, s42, 9
    s_mul_i32 s43, s42, 3
    s_sub_u32 s43, s41, s43
    s_mul_i32 s37, s42, 122880
    s_lshl_b32 s43, s43, 10
    s_add_u32 s37, s37, s43
    s_mul_i32 s43, s60, 12288
    s_add_u32 s37, s37, s43
    s_add_u32 s37, s37, 6332416
    s_mul_i32 s38, s59, 2560
    s_lshl_b32 s41, s60, 7
    s_add_u32 s38, s38, s41
    s_add_u32 s38, s38, 5242880
    s_branch dn_20011
n16_20012:
    v_mul_u32_u24 v64, 1280, v16
    v_add_u32 v64, v64, v17
    s_cmp_ge_u32 s58, 480
    s_cbranch_scc1 wo_20013
    s_load_dwordx2 s[44:45], s[0:1], 48
    s_mov_b32 s46, 0x1e0000
    s_sub_u32 s57, s58, 240
    s_mul_i32 s59, s57, 205
    s_lshr_b32 s59, s59, 10
    s_lshl_b32 s36, s59, 5
    s_add_u32 s36, s36, 0
    v_mov_b32 v65, 10240
    s_lshl_b32 s37, s59, 5
    s_add_u32 s37, s37, 4
    v_mov_b32 v66, 10240
    s_lshl_b32 s38, s59, 5
    s_add_u32 s38, s38, 16
    v_mov_b32 v67, 10240
    s_lshl_b32 s39, s59, 5
    s_add_u32 s39, s39, 20
    v_mov_b32 v68, 10240
    s_mov_b32 s53, 245760
    s_mov_b32 s54, 9117696
    s_branch ld_20014
wo_20013:
    s_waitcnt lgkmcnt(0)
    s_load_dwordx2 s[44:45], s[0:1], 16
    s_mov_b32 s46, 0xc8000
    s_sub_u32 s57, s58, 480
    s_mul_i32 s59, s57, 205
    s_lshr_b32 s59, s59, 10
    s_lshl_b32 s41, s59, 2
    s_add_u32 s41, s41, 0
    s_mul_i32 s42, s41, 205
    s_lshr_b32 s42, s42, 10
    s_mul_i32 s43, s42, 5
    s_sub_u32 s43, s41, s43
    s_lshr_b32 s41, s43, 1
    s_mul_i32 s41, s41, 20
    s_and_b32 s60, s43, 1
    s_lshl_b32 s60, s60, 2
    s_add_u32 s41, s41, s60
    s_cmp_eq_u32 s43, 4
    s_cselect_b32 s41, 16, s41
    s_cselect_b32 s60, 15360, 0
    s_add_u32 s60, s60, 10240
    s_mul_i32 s42, s42, 40
    s_add_u32 s36, s41, s42
    v_mov_b32 v65, s60
    s_lshl_b32 s41, s59, 2
    s_add_u32 s41, s41, 1
    s_mul_i32 s42, s41, 205
    s_lshr_b32 s42, s42, 10
    s_mul_i32 s43, s42, 5
    s_sub_u32 s43, s41, s43
    s_lshr_b32 s41, s43, 1
    s_mul_i32 s41, s41, 20
    s_and_b32 s60, s43, 1
    s_lshl_b32 s60, s60, 2
    s_add_u32 s41, s41, s60
    s_cmp_eq_u32 s43, 4
    s_cselect_b32 s41, 16, s41
    s_cselect_b32 s60, 15360, 0
    s_add_u32 s60, s60, 10240
    s_mul_i32 s42, s42, 40
    s_add_u32 s37, s41, s42
    v_mov_b32 v66, s60
    s_lshl_b32 s41, s59, 2
    s_add_u32 s41, s41, 2
    s_mul_i32 s42, s41, 205
    s_lshr_b32 s42, s42, 10
    s_mul_i32 s43, s42, 5
    s_sub_u32 s43, s41, s43
    s_lshr_b32 s41, s43, 1
    s_mul_i32 s41, s41, 20
    s_and_b32 s60, s43, 1
    s_lshl_b32 s60, s60, 2
    s_add_u32 s41, s41, s60
    s_cmp_eq_u32 s43, 4
    s_cselect_b32 s41, 16, s41
    s_cselect_b32 s60, 15360, 0
    s_add_u32 s60, s60, 10240
    s_mul_i32 s42, s42, 40
    s_add_u32 s38, s41, s42
    v_mov_b32 v67, s60
    s_lshl_b32 s41, s59, 2
    s_add_u32 s41, s41, 3
    s_mul_i32 s42, s41, 205
    s_lshr_b32 s42, s42, 10
    s_mul_i32 s43, s42, 5
    s_sub_u32 s43, s41, s43
    s_lshr_b32 s41, s43, 1
    s_mul_i32 s41, s41, 20
    s_and_b32 s60, s43, 1
    s_lshl_b32 s60, s60, 2
    s_add_u32 s41, s41, s60
    s_cmp_eq_u32 s43, 4
    s_cselect_b32 s41, 16, s41
    s_cselect_b32 s60, 15360, 0
    s_add_u32 s60, s60, 10240
    s_mul_i32 s42, s42, 40
    s_add_u32 s39, s41, s42
    v_mov_b32 v68, s60
    s_mov_b32 s53, 102400
    s_mov_b32 s54, 8298496
ld_20014:
    s_nop 0
    s_mul_i32 s60, s59, 5
    s_sub_u32 s60, s57, s60
    v_cndmask_b32 v65, v65, 0, s[32:33]
    v_add_u32 v65, v65, v64
    s_mul_i32 s36, s36, 1280
    s_lshl_b32 s41, s60, 8
    s_add_u32 s36, s36, s41
    v_cndmask_b32 v66, v66, 0, s[32:33]
    v_add_u32 v66, v66, v64
    s_mul_i32 s37, s37, 1280
    s_lshl_b32 s41, s60, 8
    s_add_u32 s37, s37, s41
    v_cndmask_b32 v67, v67, 0, s[32:33]
    v_add_u32 v67, v67, v64
    s_mul_i32 s38, s38, 1280
    s_lshl_b32 s41, s60, 8
    s_add_u32 s38, s38, s41
    v_cndmask_b32 v68, v68, 0, s[32:33]
    v_add_u32 v68, v68, v64
    s_mul_i32 s39, s39, 1280
    s_lshl_b32 s41, s60, 8
    s_add_u32 s39, s39, s41
    s_waitcnt lgkmcnt(0)
    s_add_u32 s41, s34, 0
    s_mov_b32 m0, s41
    s_add_u32 s42, s36, 0
    buffer_load_dwordx4 v65, s[44:47], s42 offen lds
    s_add_u32 s41, s34, 1024
    s_mov_b32 m0, s41
    s_add_u32 s42, s37, 0
    buffer_load_dwordx4 v66, s[44:47], s42 offen lds
    s_add_u32 s41, s34, 2048
    s_mov_b32 m0, s41
    s_add_u32 s42, s38, 0
    buffer_load_dwordx4 v67, s[44:47], s42 offen lds
    s_add_u32 s41, s34, 3072
    s_mov_b32 m0, s41
    s_add_u32 s42, s39, 0
    buffer_load_dwordx4 v68, s[44:47], s42 offen lds
    s_add_u32 s41, s34, 4096
    s_mov_b32 m0, s41
    s_add_u32 s42, s36, 128
    buffer_load_dwordx4 v65, s[44:47], s42 offen lds
    s_add_u32 s41, s34, 5120
    s_mov_b32 m0, s41
    s_add_u32 s42, s37, 128
    buffer_load_dwordx4 v66, s[44:47], s42 offen lds
    s_add_u32 s41, s34, 6144
    s_mov_b32 m0, s41
    s_add_u32 s42, s38, 128
    buffer_load_dwordx4 v67, s[44:47], s42 offen lds
    s_add_u32 s41, s34, 7168
    s_mov_b32 m0, s41
    s_add_u32 s42, s39, 128
    buffer_load_dwordx4 v68, s[44:47], s42 offen lds
    s_mov_b32 s39, 0
    v_lshrrev_b32 v69, 4, v0
    v_lshlrev_b32 v69, 10, v69
    v_lshl_add_u32 v69, v60, 7, v69
    v_lshl_add_u32 v69, v61, 3, v69
    v_add_u32 v69, s34, v69
    s_mul_i32 s56, s59, 5120
    s_add_u32 s56, s56, s54
dn_20011:
    s_nop 0
    s_waitcnt vmcnt(8)
    s_branch dn_20011j
non_20010:
    s_waitcnt vmcnt(0)
dn_20011j:
    s_waitcnt vmcnt(0)
    s_mov_b32 s61, 0
pl_20015:
    v_mov_b32 v7, 0
    buffer_load_dword v7, v7, s[48:51], 0 offen sc1
    s_waitcnt vmcnt(0)
ck_20017:
    s_nop 0
    v_cmp_eq_u32 vcc, 0, v7
    s_add_u32 s61, s61, 1
    s_nop 3
    s_cbranch_vccz pd_20016
    s_cmp_ge_u32 s61, s23
    s_cbranch_scc1 to_20018
    s_branch pl_20015
pd_20016:
    v_readfirstlane_b32 s100, v7
    s_mov_b32 s52, s60
    s_cmp_lg_u32 s26, 3
    s_cbranch_scc1 wj_20019
    s_lshl_b32 s40, s16, 12
    s_lshl_b32 s41, s25, 12
    v_mov_b32 v16, s40
    v_mov_b32 v17, s41
    v_cndmask_b32 v18, v17, v16, s[32:33]
    v_and_b32 v16, 31, v0
    v_lshl_add_u32 v18, v16, 7, v18
    s_mov_b32 s40, 5373952
    s_mov_b32 exec_hi, 0xfffff
    s_mov_b32 s61, 0
pl_20020:
    buffer_load_dword v16, v18, s[4:7], s40 offen sc1
    s_waitcnt vmcnt(0)
    v_cmp_ne_u32 vcc, s100, v16
    s_add_u32 s61, s61, 1
    s_nop 3
    s_cbranch_vccz pd_20021
    s_cmp_ge_u32 s61, s23
    s_cbranch_scc1 to_20022
    s_sleep 4
    s_branch pl_20020
pd_20021:
    s_mov_b64 exec, -1
    v_mov_b32 v16, 159748
    v_mov_b32 v17, s100
    ds_write_b32 v16, v17
wj_20019:
    s_nop 1
    s_mov_b32 s60, s52
    s_cmp_ge_u32 s58, 580
    s_cbranch_scc1 non_20023
    s_cmp_ge_u32 s58, 240
    s_cbranch_scc1 n16_20024
    ds_read_b64_tr_b16 v[72:73], v68 offset:0
    ds_read_b64_tr_b16 v[74:75], v68 offset:1024
    ds_read_b64_tr_b16 v[76:77], v68 offset:2048
    ds_read_b64_tr_b16 v[78:79], v68 offset:3072
    ds_read_b64_tr_b16 v[80:81], v68 offset:4096
    ds_read_b64_tr_b16 v[82:83], v68 offset:5120
    ds_read_b64_tr_b16 v[84:85], v68 offset:6144
    ds_read_b64_tr_b16 v[86:87], v68 offset:7168
    ds_read_b64_tr_b16 v[88:89], v68 offset:64
    ds_read_b64_tr_b16 v[90:91], v68 offset:1088
    ds_read_b64_tr_b16 v[92:93], v68 offset:2112
    ds_read_b64_tr_b16 v[94:95], v68 offset:3136
    ds_read_b64_tr_b16 v[96:97], v68 offset:4160
    ds_read_b64_tr_b16 v[98:99], v68 offset:5184
    ds_read_b64_tr_b16 v[100:101], v68 offset:6208
    ds_read_b64_tr_b16 v[102:103], v68 offset:7232
    s_waitcnt lgkmcnt(14)
    buffer_store_dwordx4 v[72:75], v1, s[4:7], s36 offen sc1
    s_add_u32 s36, s36, 3072
    s_waitcnt lgkmcnt(12)
    buffer_store_dwordx4 v[76:79], v1, s[4:7], s36 offen sc1
    s_add_u32 s36, s36, 3072
    s_waitcnt lgkmcnt(10)
    buffer_store_dwordx4 v[80:83], v1, s[4:7], s36 offen sc1
    s_add_u32 s36, s36, 3072
    s_waitcnt lgkmcnt(8)
    buffer_store_dwordx4 v[84:87], v1, s[4:7], s36 offen sc1
    s_add_u32 s36, s36, 3072
    s_waitcnt lgkmcnt(6)
    buffer_store_dwordx4 v[88:91], v1, s[4:7], s37 offen sc1
    s_add_u32 s37, s37, 3072
    s_waitcnt lgkmcnt(4)
    buffer_store_dwordx4 v[92:95], v1, s[4:7], s37 offen sc1
    s_add_u32 s37, s37, 3072
    s_waitcnt lgkmcnt(2)
    buffer_store_dwordx4 v[96:99], v1, s[4:7], s37 offen sc1
    s_add_u32 s37, s37, 3072
    s_waitcnt lgkmcnt(0)
    buffer_store_dwordx4 v[100:103], v1, s[4:7], s37 offen sc1
    s_add_u32 s37, s37, 3072
    s_mov_b32 s41, 0x3f803f80
    v_mov_b32 v52, 0
    v_mov_b32 v53, 0
    v_mov_b32 v54, 0
    v_mov_b32 v55, 0
    v_dot2_f32_bf16 v52, v72, s41, v52
    v_dot2_f32_bf16 v54, v88, s41, v54
    v_dot2_f32_bf16 v53, v73, s41, v53
    v_dot2_f32_bf16 v55, v89, s41, v55
    v_dot2_f32_bf16 v52, v74, s41, v52
    v_dot2_f32_bf16 v54, v90, s41, v54
    v_dot2_f32_bf16 v53, v75, s41, v53
    v_dot2_f32_bf16 v55, v91, s41, v55
    v_dot2_f32_bf16 v52, v76, s41, v52
    v_dot2_f32_bf16 v54, v92, s41, v54
    v_dot2_f32_bf16 v53, v77, s41, v53
    v_dot2_f32_bf16 v55, v93, s41, v55
    v_dot2_f32_bf16 v52, v78, s41, v52
    v_dot2_f32_bf16 v54, v94, s41, v54
    v_dot2_f32_bf16 v53, v79, s41, v53
    v_dot2_f32_bf16 v55, v95, s41, v55
    v_dot2_f32_bf16 v52, v80, s41, v52
    v_dot2_f32_bf16 v54, v96, s41, v54
    v_dot2_f32_bf16 v53, v81, s41, v53
    v_dot2_f32_bf16 v55, v97, s41, v55
    v_dot2_f32_bf16 v52, v82, s41, v52
    v_dot2_f32_bf16 v54, v98, s41, v54
    v_dot2_f32_bf16 v53, v83, s41, v53
    v_dot2_f32_bf16 v55, v99, s41, v55
    v_dot2_f32_bf16 v52, v84, s41, v52
    v_dot2_f32_bf16 v54, v100, s41, v54
    v_dot2_f32_bf16 v53, v85, s41, v53
    v_dot2_f32_bf16 v55, v101, s41, v55
    v_dot2_f32_bf16 v52, v86, s41, v52
    v_dot2_f32_bf16 v54, v102, s41, v54
    v_dot2_f32_bf16 v53, v87, s41, v53
    v_dot2_f32_bf16 v55, v103, s41, v55
    s_nop 1
    v_add_f32 v52, v52, v53
    v_mov_b32 v53, v52
    s_nop 1
    v_permlane32_swap_b32 v52, v53
    v_add_f32 v52, v52, v53
    v_add_f32 v54, v54, v55
    v_mov_b32 v55, v54
    s_nop 1
    v_permlane32_swap_b32 v54, v55
    v_add_f32 v54, v54, v55
    s_mov_b64 exec, 0xffffffff
    buffer_store_dword v52, v3, s[4:7], s38 offen sc1
    buffer_store_dword v54, v3, s[4:7], s38 offen offset:1280 sc1
    s_mov_b64 exec, -1
    s_branch non_20023
n16_20024:
    ds_read_b64_tr_b16 v[72:73], v69 offset:0
    ds_read_b64_tr_b16 v[74:75], v69 offset:512
    ds_read_b64_tr_b16 v[76:77], v69 offset:32
    ds_read_b64_tr_b16 v[78:79], v69 offset:544
    ds_read_b64_tr_b16 v[80:81], v69 offset:64
    ds_read_b64_tr_b16 v[82:83], v69 offset:576
    ds_read_b64_tr_b16 v[84:85], v69 offset:96
    ds_read_b64_tr_b16 v[86:87], v69 offset:608
    ds_read_b64_tr_b16 v[88:89], v69 offset:4096
    ds_read_b64_tr_b16 v[90:91], v69 offset:4608
    ds_read_b64_tr_b16 v[92:93], v69 offset:4128
    ds_read_b64_tr_b16 v[94:95], v69 offset:4640
    ds_read_b64_tr_b16 v[96:97], v69 offset:4160
    ds_read_b64_tr_b16 v[98:99], v69 offset:4672
    ds_read_b64_tr_b16 v[100:101], v69 offset:4192
    ds_read_b64_tr_b16 v[102:103], v69 offset:4704
    s_lshl_b32 s41, s60, 3
    s_add_u32 s41, s41, 0
    s_mul_i32 s42, s41, 205
    s_lshr_b32 s42, s42, 10
    s_mul_i32 s43, s42, 5
    s_sub_u32 s43, s41, s43
    s_mul_i32 s42, s42, s53
    s_lshl_b32 s43, s43, 10
    s_add_u32 s42, s42, s43
    s_add_u32 s42, s42, s56
    s_waitcnt lgkmcnt(14)
    buffer_store_dwordx4 v[72:75], v1, s[4:7], s42 offen sc1
    s_lshl_b32 s41, s60, 3
    s_add_u32 s41, s41, 1
    s_mul_i32 s42, s41, 205
    s_lshr_b32 s42, s42, 10
    s_mul_i32 s43, s42, 5
    s_sub_u32 s43, s41, s43
    s_mul_i32 s42, s42, s53
    s_lshl_b32 s43, s43, 10
    s_add_u32 s42, s42, s43
    s_add_u32 s42, s42, s56
    s_waitcnt lgkmcnt(12)
    buffer_store_dwordx4 v[76:79], v1, s[4:7], s42 offen sc1
    s_lshl_b32 s41, s60, 3
    s_add_u32 s41, s41, 2
    s_mul_i32 s42, s41, 205
    s_lshr_b32 s42, s42, 10
    s_mul_i32 s43, s42, 5
    s_sub_u32 s43, s41, s43
    s_mul_i32 s42, s42, s53
    s_lshl_b32 s43, s43, 10
    s_add_u32 s42, s42, s43
    s_add_u32 s42, s42, s56
    s_waitcnt lgkmcnt(10)
    buffer_store_dwordx4 v[80:83], v1, s[4:7], s42 offen sc1
    s_lshl_b32 s41, s60, 3
    s_add_u32 s41, s41, 3
    s_mul_i32 s42, s41, 205
    s_lshr_b32 s42, s42, 10
    s_mul_i32 s43, s42, 5
    s_sub_u32 s43, s41, s43
    s_mul_i32 s42, s42, s53
    s_lshl_b32 s43, s43, 10
    s_add_u32 s42, s42, s43
    s_add_u32 s42, s42, s56
    s_waitcnt lgkmcnt(8)
    buffer_store_dwordx4 v[84:87], v1, s[4:7], s42 offen sc1
    s_lshl_b32 s41, s60, 3
    s_add_u32 s41, s41, 4
    s_mul_i32 s42, s41, 205
    s_lshr_b32 s42, s42, 10
    s_mul_i32 s43, s42, 5
    s_sub_u32 s43, s41, s43
    s_mul_i32 s42, s42, s53
    s_lshl_b32 s43, s43, 10
    s_add_u32 s42, s42, s43
    s_add_u32 s42, s42, s56
    s_waitcnt lgkmcnt(6)
    buffer_store_dwordx4 v[88:91], v1, s[4:7], s42 offen sc1
    s_lshl_b32 s41, s60, 3
    s_add_u32 s41, s41, 5
    s_mul_i32 s42, s41, 205
    s_lshr_b32 s42, s42, 10
    s_mul_i32 s43, s42, 5
    s_sub_u32 s43, s41, s43
    s_mul_i32 s42, s42, s53
    s_lshl_b32 s43, s43, 10
    s_add_u32 s42, s42, s43
    s_add_u32 s42, s42, s56
    s_waitcnt lgkmcnt(4)
    buffer_store_dwordx4 v[92:95], v1, s[4:7], s42 offen sc1
    s_lshl_b32 s41, s60, 3
    s_add_u32 s41, s41, 6
    s_mul_i32 s42, s41, 205
    s_lshr_b32 s42, s42, 10
    s_mul_i32 s43, s42, 5
    s_sub_u32 s43, s41, s43
    s_mul_i32 s42, s42, s53
    s_lshl_b32 s43, s43, 10
    s_add_u32 s42, s42, s43
    s_add_u32 s42, s42, s56
    s_waitcnt lgkmcnt(2)
    buffer_store_dwordx4 v[96:99], v1, s[4:7], s42 offen sc1
    s_lshl_b32 s41, s60, 3
    s_add_u32 s41, s41, 7
    s_mul_i32 s42, s41, 205
    s_lshr_b32 s42, s42, 10
    s_mul_i32 s43, s42, 5
    s_sub_u32 s43, s41, s43
    s_mul_i32 s42, s42, s53
    s_lshl_b32 s43, s43, 10
    s_add_u32 s42, s42, s43
    s_add_u32 s42, s42, s56
    s_waitcnt lgkmcnt(0)
    buffer_store_dwordx4 v[100:103], v1, s[4:7], s42 offen sc1
non_20023:
    s_nop 1
    s_mov_b32 s61, 0
pl_20026:
    v_mov_b32 v7, 0
    buffer_load_dword v7, v7, s[48:51], 0 offen sc1
    s_waitcnt vmcnt(0)
ck_20028:
    s_nop 0
    v_cmp_eq_u32 vcc, 0, v7
    s_add_u32 s61, s61, 1
    s_nop 3
    s_cbranch_vccz pd_20027
    s_cmp_ge_u32 s61, s23
    s_cbranch_scc1 to_20029
    s_branch pl_20026
pd_20027:
    v_readfirstlane_b32 s100, v7
    s_cmp_ge_u32 s58, 580
    s_cbranch_scc1 non_20030
    s_lshl_b32 s55, s58, 2
    s_add_u32 s55, s55, 5505024
    v_mov_b32 v16, s100
    v_mov_b32 v17, 0
    s_mov_b64 exec, 1
    buffer_store_dword v16, v17, s[4:7], s55 offen sc1
    s_mov_b64 exec, -1
non_20030:
    s_nop 0
non_20004j:
    s_cmp_lg_u32 s3, 4
    s_cbranch_scc1 in_20031
    s_lshl_b32 s40, s17, 2
    s_add_u32 s41, s62, s100
    v_mov_b32 v16, s41
    v_mov_b32 v7, s40
    s_mov_b64 exec, 1
    buffer_store_dword v16, v7, s[4:7], s63 offen sc1
    s_mov_b64 exec, -1
in_20031:
    s_nop 0
    v_mov_b32 v16, 159748
    s_mov_b32 s61, 0
lf_20032:
    s_nop 1
    ds_read_b32 v17, v16
    s_waitcnt lgkmcnt(0)
    v_cmp_ne_u32 vcc, s100, v17
    s_add_u32 s61, s61, 1
    s_nop 3
    s_cbranch_vccz lfd_20033
    s_lshr_b32 s60, s61, 5
    s_cmp_ge_u32 s60, s23
    s_cbranch_scc1 to_20034
    s_sleep 1
    s_branch lf_20032
lfd_20033:
    s_lshl_b32 s42, s26, 11
    s_mul_i32 s43, s17, 81920
    s_add_u32 s43, s43, s42
    v_add_u32 v4, s42, v1
    v_add_u32 v13, 65536, v4
    s_lshl_b32 s40, s26, 2
    s_add_u32 s40, s40, 159776
    v_mov_b32 v16, s40
    v_mov_b32 v200, 0x3f803f80
    v_mov_b32 v201, 0x3f803f80
    v_mov_b32 v202, 0x3f803f80
    v_mov_b32 v203, 0x3f803f80
    s_add_u32 s40, s42, 16384
    s_mov_b32 m0, s40
    s_add_u32 s41, s43, 16384
    buffer_load_dwordx4 v1, s[4:7], s41 offen offset:0 sc1 lds
    buffer_load_dwordx4 v1, s[4:7], s41 offen offset:1024 sc1 lds
    s_add_u32 s40, s42, 24576
    s_mov_b32 m0, s40
    s_add_u32 s41, s43, 24576
    buffer_load_dwordx4 v1, s[4:7], s41 offen offset:0 sc1 lds
    buffer_load_dwordx4 v1, s[4:7], s41 offen offset:1024 sc1 lds
    s_add_u32 s40, s42, 32768
    s_mov_b32 m0, s40
    s_add_u32 s41, s43, 32768
    buffer_load_dwordx4 v1, s[4:7], s41 offen offset:0 sc1 lds
    buffer_load_dwordx4 v1, s[4:7], s41 offen offset:1024 sc1 lds
    s_waitcnt vmcnt(4)
    s_add_u32 s40, s100, 2
    v_mov_b32 v17, s40
    ds_write_b32 v16, v17
    ds_read_b128 v[56:59], v4 offset:16384
    ds_read_b128 v[60:63], v4 offset:17408
    s_waitcnt lgkmcnt(1)
    v_mfma_f32_32x32x16_bf16 v[132:147], v[200:203], v[56:59], 0
    s_waitcnt lgkmcnt(0)
    v_mfma_f32_32x32x16_bf16 v[148:163], v[200:203], v[60:63], 0
    s_add_u32 s40, s42, 40960
    s_mov_b32 m0, s40
    s_add_u32 s41, s43, 40960
    buffer_load_dwordx4 v1, s[4:7], s41 offen offset:0 sc1 lds
    buffer_load_dwordx4 v1, s[4:7], s41 offen offset:1024 sc1 lds
    s_waitcnt vmcnt(4)
    s_add_u32 s40, s100, 3
    v_mov_b32 v17, s40
    ds_write_b32 v16, v17
    ds_read_b128 v[64:67], v4 offset:24576
    ds_read_b128 v[68:71], v4 offset:25600
    s_waitcnt lgkmcnt(1)
    v_mfma_f32_32x32x16_bf16 v[132:147], v[200:203], v[64:67], v[132:147]
    s_waitcnt lgkmcnt(0)
    v_mfma_f32_32x32x16_bf16 v[148:163], v[200:203], v[68:71], v[148:163]
    s_add_u32 s40, s42, 49152
    s_mov_b32 m0, s40
    s_add_u32 s41, s43, 49152
    buffer_load_dwordx4 v1, s[4:7], s41 offen offset:0 sc1 lds
    buffer_load_dwordx4 v1, s[4:7], s41 offen offset:1024 sc1 lds
    s_waitcnt vmcnt(4)
    s_add_u32 s40, s100, 4
    v_mov_b32 v17, s40
    ds_write_b32 v16, v17
    ds_read_b128 v[72:75], v4 offset:32768
    ds_read_b128 v[76:79], v4 offset:33792
    s_waitcnt lgkmcnt(1)
    v_mfma_f32_32x32x16_bf16 v[132:147], v[200:203], v[72:75], v[132:147]
    s_waitcnt lgkmcnt(0)
    v_mfma_f32_32x32x16_bf16 v[148:163], v[200:203], v[76:79], v[148:163]
    s_add_u32 s40, s42, 57344
    s_mov_b32 m0, s40
    s_add_u32 s41, s43, 57344
    buffer_load_dwordx4 v1, s[4:7], s41 offen offset:0 sc1 lds
    buffer_load_dwordx4 v1, s[4:7], s41 offen offset:1024 sc1 lds
    s_waitcnt vmcnt(4)
    s_add_u32 s40, s100, 5
    v_mov_b32 v17, s40
    ds_write_b32 v16, v17
    ds_read_b128 v[80:83], v4 offset:40960
    ds_read_b128 v[84:87], v4 offset:41984
    s_waitcnt lgkmcnt(1)
    v_mfma_f32_32x32x16_bf16 v[132:147], v[200:203], v[80:83], v[132:147]
    s_waitcnt lgkmcnt(0)
    v_mfma_f32_32x32x16_bf16 v[148:163], v[200:203], v[84:87], v[148:163]
    s_add_u32 s40, s42, 65536
    s_mov_b32 m0, s40
    s_add_u32 s41, s43, 65536
    buffer_load_dwordx4 v1, s[4:7], s41 offen offset:0 sc1 lds
    buffer_load_dwordx4 v1, s[4:7], s41 offen offset:1024 sc1 lds
    s_waitcnt vmcnt(4)
    s_add_u32 s40, s100, 6
    v_mov_b32 v17, s40
    ds_write_b32 v16, v17
    ds_read_b128 v[88:91], v4 offset:49152
    ds_read_b128 v[92:95], v4 offset:50176
    s_waitcnt lgkmcnt(1)
    v_mfma_f32_32x32x16_bf16 v[132:147], v[200:203], v[88:91], v[132:147]
    s_waitcnt lgkmcnt(0)
    v_mfma_f32_32x32x16_bf16 v[148:163], v[200:203], v[92:95], v[148:163]
    s_add_u32 s40, s42, 73728
    s_mov_b32 m0, s40
    s_add_u32 s41, s43, 73728
    buffer_load_dwordx4 v1, s[4:7], s41 offen offset:0 sc1 lds
    buffer_load_dwordx4 v1, s[4:7], s41 offen offset:1024 sc1 lds
    s_waitcnt vmcnt(4)
    s_add_u32 s40, s100, 7
    v_mov_b32 v17, s40
    ds_write_b32 v16, v17
    ds_read_b128 v[96:99], v4 offset:57344
    ds_read_b128 v[100:103], v4 offset:58368
    s_waitcnt lgkmcnt(1)
    v_mfma_f32_32x32x16_bf16 v[132:147], v[200:203], v[96:99], v[132:147]
    s_waitcnt lgkmcnt(0)
    v_mfma_f32_32x32x16_bf16 v[148:163], v[200:203], v[100:103], v[148:163]
    s_waitcnt vmcnt(2)
    s_add_u32 s40, s100, 8
    v_mov_b32 v17, s40
    ds_write_b32 v16, v17
    ds_read_b128 v[104:107], v13 offset:0
    ds_read_b128 v[108:111], v13 offset:1024
    s_waitcnt lgkmcnt(1)
    v_mfma_f32_32x32x16_bf16 v[132:147], v[200:203], v[104:107], v[132:147]
    s_waitcnt lgkmcnt(0)
    v_mfma_f32_32x32x16_bf16 v[148:163], v[200:203], v[108:111], v[148:163]
    s_waitcnt vmcnt(0)
    s_add_u32 s40, s100, 9
    v_mov_b32 v17, s40
    ds_write_b32 v16, v17
    ds_read_b128 v[112:115], v13 offset:8192
    ds_read_b128 v[116:119], v13 offset:9216
    s_waitcnt lgkmcnt(1)
    v_mfma_f32_32x32x16_bf16 v[132:147], v[200:203], v[112:115], v[132:147]
    s_waitcnt lgkmcnt(0)
    v_mfma_f32_32x32x16_bf16 v[148:163], v[200:203], v[116:119], v[148:163]
    s_mul_i32 s40, s26, 15360
    v_add_u32 v6, s40, v1
    v_add_u32 v5, 102400, v6
    v_subrev_u32 v16, 16, v16
    s_mov_b32 s61, 0
lf_20035:
    s_nop 6
    ds_read_b32 v17, v16
    s_waitcnt lgkmcnt(0)
    v_cmp_ne_u32 vcc, s100, v17
    s_add_u32 s61, s61, 1
    s_nop 3
    s_cbranch_vccz lfd_20036
    s_lshr_b32 s60, s61, 5
    s_cmp_ge_u32 s60, s23
    s_cbranch_scc1 to_20037
    s_sleep 1
    s_branch lf_20035
lfd_20036:
    ds_read_b128 v[40:43], v4 offset:0
    ds_read_b128 v[44:47], v4 offset:1024
    s_waitcnt lgkmcnt(1)
    v_mfma_f32_32x32x16_bf16 v[132:147], v[200:203], v[40:43], v[132:147]
    s_waitcnt lgkmcnt(0)
    v_mfma_f32_32x32x16_bf16 v[148:163], v[200:203], v[44:47], v[148:163]
    ds_read_b128 v[48:51], v4 offset:8192
    ds_read_b128 v[52:55], v4 offset:9216
    s_waitcnt lgkmcnt(1)
    v_mfma_f32_32x32x16_bf16 v[132:147], v[200:203], v[48:51], v[132:147]
    s_waitcnt lgkmcnt(0)
    v_mfma_f32_32x32x16_bf16 v[148:163], v[200:203], v[52:55], v[148:163]
    s_nop 9
    v_mov_b32 v16, v132
    s_nop 0
    v_mov_b32 v17, v148
    s_lshl_b32 s40, s26, 8
    s_add_u32 s40, s40, 160000
    v_and_b32 v18, 31, v0
    v_lshl_add_u32 v18, v18, 2, s40
    ds_write_b32 v18, v16
    ds_write_b32 v18, v17 offset:128
    s_waitcnt lgkmcnt(0)
    s_mul_i32 s47, s25, 245760
    s_add_u32 s47, s47, 9117696
    v_and_b32 v125, 3, v0
    s_lshl_b32 s40, s17, 2
    v_add_lshl_u32 v125, v125, s40, 7
    s_lshl_b32 s40, s16, 14
    v_add_u32 v125, s40, v125
    v_mov_b32 v16, 131072
    v_mov_b32 v17, 409600
    v_cmp_gt_u32 vcc, 4, v0
    s_nop 1
    v_cndmask_b32 v16, v17, v16, vcc
    v_add_u32 v125, v125, v16
    s_and_b32 s40, s17, 7
    s_lshl_b32 s41, s16, 3
    s_add_u32 s40, s40, s41
    s_lshl_b32 s40, s40, 7
    s_add_u32 s41, s40, 262144
    v_writelane_b32 v125, s41, 8
    s_add_u32 s41, s40, 270336
    v_writelane_b32 v125, s41, 9
svc_top:
    s_nop 2
    s_barrier
    s_cmp_lg_u32 s26, 0
    s_cbranch_scc1 tc_20038
    s_mov_b64 exec, 0x3ff
    buffer_load_dword v126, v125, s[4:7], s21 offen sc1
    s_mov_b64 exec, -1
tc_20038:
    s_lshr_b32 s58, s27, 2
    s_mul_i32 s58, s58, 10240
    s_mul_i32 s59, s26, 2560
    s_add_u32 s58, s58, s59
    s_add_u32 s58, s58, 11091968
    s_mov_b64 exec, 0xfffff
    buffer_load_dword v126, v15, s[4:7], s58 offen sc1
    s_mov_b64 exec, -1
    s_cmp_lg_u32 s39, 0
    s_cbranch_scc1 sv_20039
    s_mov_b32 s40, 5505024
    v_min_u32 v28, 256, v1
    s_mov_b32 s61, 0
pl_20041:
    s_nop 1
    buffer_load_dwordx4 v[16:19], v1, s[4:7], s40 offen sc1
    buffer_load_dwordx4 v[20:23], v1, s[4:7], s40 offen offset:1024 sc1
    buffer_load_dwordx4 v[24:27], v28, s[4:7], s40 offen offset:2048 sc1
    s_waitcnt vmcnt(0)
    v_xor_b32 v16, s100, v16
    v_xor_b32 v17, s100, v17
    v_xor_b32 v18, s100, v18
    v_xor_b32 v19, s100, v19
    v_xor_b32 v20, s100, v20
    v_xor_b32 v21, s100, v21
    v_xor_b32 v22, s100, v22
    v_xor_b32 v23, s100, v23
    v_xor_b32 v24, s100, v24
    v_xor_b32 v25, s100, v25
    v_xor_b32 v26, s100, v26
    v_xor_b32 v27, s100, v27
    v_or_b32 v16, v16, v17
    v_or_b32 v16, v16, v18
    v_or_b32 v16, v16, v19
    v_or_b32 v16, v16, v20
    v_or_b32 v16, v16, v21
    v_or_b32 v16, v16, v22
    v_or_b32 v16, v16, v23
    v_or_b32 v16, v16, v24
    v_or_b32 v16, v16, v25
    v_or_b32 v16, v16, v26
    v_or_b32 v16, v16, v27
    v_cmp_ne_u32 vcc, 0, v16
    s_add_u32 s61, s61, 1
    s_nop 3
    s_cbranch_vccz pd_20042
    s_cmp_ge_u32 s61, s23
    s_cbranch_scc1 to_20043
    s_sleep 4
    s_branch pl_20041
pd_20042:
    s_mul_i32 s46, s30, 122880
    s_add_u32 s46, s46, 6332416
    s_mul_i32 s40, s26, 15360
    s_add_u32 s40, s40, s46
    buffer_load_dwordx4 v[132:135], v1, s[4:7], s40 offen offset:0 sc1
    buffer_load_dwordx4 v[136:139], v1, s[4:7], s40 offen offset:1024 sc1
    buffer_load_dwordx4 v[140:143], v1, s[4:7], s40 offen offset:2048 sc1
    buffer_load_dwordx4 v[144:147], v1, s[4:7], s40 offen offset:3072 sc1
    s_add_u32 s40, s40, 4096
    buffer_load_dwordx4 v[148:151], v1, s[4:7], s40 offen offset:0 sc1
    buffer_load_dwordx4 v[152:155], v1, s[4:7], s40 offen offset:1024 sc1
    buffer_load_dwordx4 v[156:159], v1, s[4:7], s40 offen offset:2048 sc1
    buffer_load_dwordx4 v[160:163], v1, s[4:7], s40 offen offset:3072 sc1
    s_add_u32 s40, s40, 4096
    buffer_load_dwordx4 v[164:167], v1, s[4:7], s40 offen offset:0 sc1
    buffer_load_dwordx4 v[168:171], v1, s[4:7], s40 offen offset:1024 sc1
    buffer_load_dwordx4 v[172:175], v1, s[4:7], s40 offen offset:2048 sc1
    buffer_load_dwordx4 v[176:179], v1, s[4:7], s40 offen offset:3072 sc1
    s_add_u32 s40, s40, 4096
    buffer_load_dwordx4 v[180:183], v1, s[4:7], s40 offen offset:0 sc1
    buffer_load_dwordx4 v[184:187], v1, s[4:7], s40 offen offset:1024 sc1
    buffer_load_dwordx4 v[188:191], v1, s[4:7], s40 offen offset:2048 sc1
    s_branch sv_20040
sv_20039:
    s_mul_i32 s58, s17, 25600
    s_lshl_b32 s59, s26, 13
    s_add_u32 s58, s58, s59
    s_add_u32 s58, s58, 8298496
    buffer_load_dword v124, v15, s[4:7], s58 offen
sv_20040:
    s_waitcnt lgkmcnt(0)
    s_barrier
    s_sub_u32 s48, s27, 128
    s_lshl_b32 s49, s48, 7
    s_add_u32 s49, s49, s21
    s_add_u32 s49, s49, 278528
    s_mul_i32 s48, s48, 6144
    s_add_u32 s48, s48, s20
    s_sub_u32 s50, 7, s26
    s_add_u32 s52, s4, s49
    s_addc_u32 s53, s5, 0
    s_cmp_eq_u32 s16, 0
    s_cbranch_scc1 nh_20044
    s_lshl_b32 s40, s50, 10
    v_add_u32 v252, s40, v8
    s_lshl_b32 s40, s50, 8
    v_add_u32 v2, s40, v9
    s_lshl_b32 s40, s50, 11
    v_add_u32 v253, s40, v10
    v_add_u32 v254, s40, v11
    v_add_u32 v255, s40, v12
    s_mov_b32 s61, 0
pl_20045:
    s_nop 1
    s_load_dword s54, s[52:53], 0 glc
    s_waitcnt lgkmcnt(0)
    s_add_u32 s61, s61, 1
    s_cmp_eq_u32 s54, s100
    s_cbranch_scc1 pd_20046
    s_cmp_lt_u32 s61, s23
    s_cbranch_scc1 pl_20045
    s_mov_b32 s23, 0
pd_20046:
    s_add_u32 s40, s48, 0
    buffer_load_dwordx4 v[16:19], v1, s[4:7], s40 offen offset:0 sc1
    buffer_load_dwordx4 v[20:23], v1, s[4:7], s40 offen offset:1024 sc1
    buffer_load_dwordx4 v[24:27], v1, s[4:7], s40 offen offset:2048 sc1
    s_waitcnt vmcnt(1)
    ds_write_b128 v252, v[20:23] offset:0
    ds_write_b64 v2, v[16:17] offset:0
    ds_write_b64 v253, v[18:19] offset:0
    s_waitcnt vmcnt(0)
    ds_write_b64 v254, v[24:25] offset:0
    ds_write_b64 v255, v[26:27] offset:0
    s_lshl_b32 s40, s39, 5
    s_lshl_b32 s41, s26, 2
    s_add_u32 s40, s40, s41
    s_add_u32 s40, s40, 104448
    v_mov_b32 v252, s40
    v_mov_b32 v253, s100
    s_waitcnt lgkmcnt(0)
    ds_write_b32 v252, v253
nh_20044:
    s_nop 0
    s_cmp_eq_u32 s16, 0
    s_cbranch_scc1 nh_20047
    s_lshl_b32 s40, s26, 10
    v_add_u32 v252, s40, v8
    s_lshl_b32 s40, s26, 8
    v_add_u32 v2, s40, v9
    s_lshl_b32 s40, s26, 11
    v_add_u32 v253, s40, v10
    v_add_u32 v254, s40, v11
    v_add_u32 v255, s40, v12
    s_mov_b32 s61, 0
pl_20048:
    s_nop 1
    s_load_dword s54, s[52:53], 64 glc
    s_waitcnt lgkmcnt(0)
    s_add_u32 s61, s61, 1
    s_cmp_eq_u32 s54, s100
    s_cbranch_scc1 pd_20049
    s_cmp_lt_u32 s61, s23
    s_cbranch_scc1 pl_20048
    s_mov_b32 s23, 0
pd_20049:
    s_add_u32 s40, s48, 3072
    buffer_load_dwordx4 v[16:19], v1, s[4:7], s40 offen offset:0 sc1
    buffer_load_dwordx4 v[20:23], v1, s[4:7], s40 offen offset:1024 sc1
    buffer_load_dwordx4 v[24:27], v1, s[4:7], s40 offen offset:2048 sc1
    s_waitcnt vmcnt(1)
    ds_write_b128 v252, v[20:23] offset:0
    ds_write_b64 v2, v[16:17] offset:0
    ds_write_b64 v253, v[18:19] offset:0
    s_waitcnt vmcnt(0)
    ds_write_b64 v254, v[24:25] offset:0
    ds_write_b64 v255, v[26:27] offset:0
    s_lshl_b32 s40, s39, 5
    s_lshl_b32 s41, s26, 2
    s_add_u32 s40, s40, s41
    s_add_u32 s40, s40, 104464
    v_mov_b32 v252, s40
    v_mov_b32 v253, s100
    s_waitcnt lgkmcnt(0)
    ds_write_b32 v252, v253
nh_20047:
    s_nop 0
    s_mul_i32 s40, s26, 25600
    s_mul_i32 s41, s25, 102400
    s_add_u32 s41, s41, s40
    s_add_u32 s41, s41, 8298496
    s_mov_b32 m0, s40
    s_nop 0
    buffer_load_dwordx4 v1, s[4:7], s41 offen offset:0 sc1 lds
    buffer_load_dwordx4 v1, s[4:7], s41 offen offset:1024 sc1 lds
    buffer_load_dwordx4 v1, s[4:7], s41 offen offset:2048 sc1 lds
    buffer_load_dwordx4 v1, s[4:7], s41 offen offset:3072 sc1 lds
    s_add_u32 s40, s40, 4096
    s_add_u32 s41, s41, 4096
    s_mov_b32 m0, s40
    s_nop 0
    buffer_load_dwordx4 v1, s[4:7], s41 offen offset:0 sc1 lds
    buffer_load_dwordx4 v1, s[4:7], s41 offen offset:1024 sc1 lds
    buffer_load_dwordx4 v1, s[4:7], s41 offen offset:2048 sc1 lds
    buffer_load_dwordx4 v1, s[4:7], s41 offen offset:3072 sc1 lds
    s_add_u32 s40, s40, 4096
    s_add_u32 s41, s41, 4096
    s_mov_b32 m0, s40
    s_nop 0
    buffer_load_dwordx4 v1, s[4:7], s41 offen offset:0 sc1 lds
    buffer_load_dwordx4 v1, s[4:7], s41 offen offset:1024 sc1 lds
    buffer_load_dwordx4 v1, s[4:7], s41 offen offset:2048 sc1 lds
    buffer_load_dwordx4 v1, s[4:7], s41 offen offset:3072 sc1 lds
    s_add_u32 s40, s40, 4096
    s_add_u32 s41, s41, 4096
    s_mov_b32 m0, s40
    s_nop 0
    buffer_load_dwordx4 v1, s[4:7], s41 offen offset:0 sc1 lds
    buffer_load_dwordx4 v1, s[4:7], s41 offen offset:1024 sc1 lds
    buffer_load_dwordx4 v1, s[4:7], s41 offen offset:2048 sc1 lds
    buffer_load_dwordx4 v1, s[4:7], s41 offen offset:3072 sc1 lds
    s_add_u32 s40, s40, 4096
    s_add_u32 s41, s41, 4096
    s_mov_b32 m0, s40
    s_nop 0
    buffer_load_dwordx4 v1, s[4:7], s41 offen offset:0 sc1 lds
    buffer_load_dwordx4 v1, s[4:7], s41 offen offset:1024 sc1 lds
    buffer_load_dwordx4 v1, s[4:7], s41 offen offset:2048 sc1 lds
    buffer_load_dwordx4 v1, s[4:7], s41 offen offset:3072 sc1 lds
    s_add_u32 s40, s40, 4096
    s_add_u32 s41, s41, 4096
    s_mov_b32 m0, s40
    s_nop 0
    buffer_load_dwordx4 v1, s[4:7], s41 offen offset:0 sc1 lds
    buffer_load_dwordx4 v1, s[4:7], s41 offen offset:1024 sc1 lds
    buffer_load_dwordx4 v1, s[4:7], s41 offen offset:2048 sc1 lds
    buffer_load_dwordx4 v1, s[4:7], s41 offen offset:3072 sc1 lds
    s_add_u32 s40, s40, 4096
    s_add_u32 s41, s41, 4096
    s_mov_b32 m0, s40
    s_nop 0
    buffer_load_dwordx4 v1, s[4:7], s41 offen offset:0 sc1 lds
    s_cmp_lg_u32 s39, 0
    s_cbranch_scc1 sv_20050
    s_mul_i32 s40, s26, 15360
    s_add_u32 s40, s40, s46
    s_add_u32 s40, s40, 61440
    buffer_load_dwordx4 v[192:195], v1, s[4:7], s40 offen offset:0 sc1
    buffer_load_dwordx4 v[196:199], v1, s[4:7], s40 offen offset:1024 sc1
    buffer_load_dwordx4 v[200:203], v1, s[4:7], s40 offen offset:2048 sc1
    buffer_load_dwordx4 v[204:207], v1, s[4:7], s40 offen offset:3072 sc1
    s_add_u32 s40, s40, 4096
    buffer_load_dwordx4 v[208:211], v1, s[4:7], s40 offen offset:0 sc1
    buffer_load_dwordx4 v[212:215], v1, s[4:7], s40 offen offset:1024 sc1
    buffer_load_dwordx4 v[216:219], v1, s[4:7], s40 offen offset:2048 sc1
    buffer_load_dwordx4 v[220:223], v1, s[4:7], s40 offen offset:3072 sc1
    s_add_u32 s40, s40, 4096
    buffer_load_dwordx4 v[224:227], v1, s[4:7], s40 offen offset:0 sc1
    buffer_load_dwordx4 v[228:231], v1, s[4:7], s40 offen offset:1024 sc1
    buffer_load_dwordx4 v[232:235], v1, s[4:7], s40 offen offset:2048 sc1
    buffer_load_dwordx4 v[236:239], v1, s[4:7], s40 offen offset:3072 sc1
    s_add_u32 s40, s40, 4096
    buffer_load_dwordx4 v[240:243], v1, s[4:7], s40 offen offset:0 sc1
    buffer_load_dwordx4 v[244:247], v1, s[4:7], s40 offen offset:1024 sc1
    buffer_load_dwordx4 v[248:251], v1, s[4:7], s40 offen offset:2048 sc1
sv_20050:
    s_cmp_eq_u32 s39, 0
    s_cbranch_scc1 sv_20051
    s_mul_i32 s40, s26, 10240
    s_add_u32 s40, s40, s47
    s_add_u32 s40, s40, 163840
    buffer_load_dwordx4 v[40:43], v1, s[4:7], s40 offen offset:0 sc1
    buffer_load_dwordx4 v[44:47], v1, s[4:7], s40 offen offset:1024 sc1
    buffer_load_dwordx4 v[48:51], v1, s[4:7], s40 offen offset:2048 sc1
    buffer_load_dwordx4 v[52:55], v1, s[4:7], s40 offen offset:3072 sc1
    s_add_u32 s40, s40, 4096
    buffer_load_dwordx4 v[56:59], v1, s[4:7], s40 offen offset:0 sc1
    buffer_load_dwordx4 v[60:63], v1, s[4:7], s40 offen offset:1024 sc1
    buffer_load_dwordx4 v[64:67], v1, s[4:7], s40 offen offset:2048 sc1
    buffer_load_dwordx4 v[68:71], v1, s[4:7], s40 offen offset:3072 sc1
    s_add_u32 s40, s40, 4096
    buffer_load_dwordx4 v[72:75], v1, s[4:7], s40 offen offset:0 sc1
    buffer_load_dwordx4 v[76:79], v1, s[4:7], s40 offen offset:1024 sc1
    s_mul_i32 s40, s26, 10240
    s_add_u32 s40, s40, s47
    s_add_u32 s40, s40, 204800
    buffer_load_dwordx4 v[80:83], v1, s[4:7], s40 offen offset:0 sc1
    buffer_load_dwordx4 v[84:87], v1, s[4:7], s40 offen offset:1024 sc1
    buffer_load_dwordx4 v[88:91], v1, s[4:7], s40 offen offset:2048 sc1
    buffer_load_dwordx4 v[92:95], v1, s[4:7], s40 offen offset:3072 sc1
    s_add_u32 s40, s40, 4096
    buffer_load_dwordx4 v[96:99], v1, s[4:7], s40 offen offset:0 sc1
    buffer_load_dwordx4 v[100:103], v1, s[4:7], s40 offen offset:1024 sc1
    buffer_load_dwordx4 v[104:107], v1, s[4:7], s40 offen offset:2048 sc1
    buffer_load_dwordx4 v[108:111], v1, s[4:7], s40 offen offset:3072 sc1
    s_add_u32 s40, s40, 4096
    buffer_load_dwordx4 v[112:115], v1, s[4:7], s40 offen offset:0 sc1
    buffer_load_dwordx4 v[116:119], v1, s[4:7], s40 offen offset:1024 sc1
sv_20051:
    s_waitcnt vmcnt(15)
    s_barrier
    ds_write_b128 v5, v[132:135] offset:0
    ds_write_b128 v5, v[136:139] offset:1024
    ds_write_b128 v5, v[140:143] offset:2048
    ds_write_b128 v5, v[144:147] offset:3072
    ds_write_b128 v5, v[148:151] offset:4096
    ds_write_b128 v5, v[152:155] offset:5120
    ds_write_b128 v5, v[156:159] offset:6144
    ds_write_b128 v5, v[160:163] offset:7168
    ds_write_b128 v5, v[164:167] offset:8192
    ds_write_b128 v5, v[168:171] offset:9216
    ds_write_b128 v5, v[172:175] offset:10240
    ds_write_b128 v5, v[176:179] offset:11264
    ds_write_b128 v5, v[180:183] offset:12288
    ds_write_b128 v5, v[184:187] offset:13312
    ds_write_b128 v5, v[188:191] offset:14336
    s_waitcnt lgkmcnt(0)
    s_barrier
    s_waitcnt vmcnt(0)
    ds_write_b128 v6, v[192:195] offset:0
    ds_write_b128 v6, v[196:199] offset:1024
    ds_write_b128 v6, v[200:203] offset:2048
    ds_write_b128 v6, v[204:207] offset:3072
    ds_write_b128 v6, v[208:211] offset:4096
    ds_write_b128 v6, v[212:215] offset:5120
    ds_write_b128 v6, v[216:219] offset:6144
    ds_write_b128 v6, v[220:223] offset:7168
    ds_write_b128 v6, v[224:227] offset:8192
    ds_write_b128 v6, v[228:231] offset:9216
    ds_write_b128 v6, v[232:235] offset:10240
    ds_write_b128 v6, v[236:239] offset:11264
    ds_write_b128 v6, v[240:243] offset:12288
    ds_write_b128 v6, v[244:247] offset:13312
    ds_write_b128 v6, v[248:251] offset:14336
    s_waitcnt lgkmcnt(0)
    s_barrier
    s_cmp_lg_u32 s26, 0
    s_cbranch_scc1 tc_20052
    s_mov_b64 exec, 0x3ff
    buffer_load_dword v126, v125, s[4:7], s21 offen sc1
    s_mov_b64 exec, -1
tc_20052:
    s_mul_i32 s40, s26, 5120
    s_add_u32 s41, s40, s47
    s_add_u32 s41, s41, 0
    s_add_u32 s40, s40, 66560
    s_mov_b32 m0, s40
    s_nop 0
    buffer_load_dwordx4 v1, s[4:7], s41 offen offset:0 sc1 lds
    buffer_load_dwordx4 v1, s[4:7], s41 offen offset:1024 sc1 lds
    buffer_load_dwordx4 v1, s[4:7], s41 offen offset:2048 sc1 lds
    buffer_load_dwordx4 v1, s[4:7], s41 offen offset:3072 sc1 lds
    s_add_u32 s40, s40, 4096
    s_add_u32 s41, s41, 4096
    s_mov_b32 m0, s40
    s_nop 0
    buffer_load_dwordx4 v1, s[4:7], s41 offen offset:0 sc1 lds
    s_cmp_ge_u32 s26, 3
    s_cbranch_scc1 w2_20053
    s_mul_i32 s40, s26, 5120
    s_add_u32 s41, s40, s47
    s_add_u32 s41, s41, 20480
    s_add_u32 s40, s40, 87040
    s_mov_b32 m0, s40
    s_nop 0
    buffer_load_dwordx4 v1, s[4:7], s41 offen offset:0 sc1 lds
    buffer_load_dwordx4 v1, s[4:7], s41 offen offset:1024 sc1 lds
    buffer_load_dwordx4 v1, s[4:7], s41 offen offset:2048 sc1 lds
    buffer_load_dwordx4 v1, s[4:7], s41 offen offset:3072 sc1 lds
    s_add_u32 s40, s40, 4096
    s_add_u32 s41, s41, 4096
    s_mov_b32 m0, s40
    s_nop 0
    buffer_load_dwordx4 v1, s[4:7], s41 offen offset:0 sc1 lds
w2_20053:
    s_mul_i32 s40, s26, 5120
    s_add_u32 s41, s40, s47
    s_add_u32 s41, s41, 35840
    s_add_u32 s40, s40, 102400
    s_mov_b32 m0, s40
    s_nop 0
    buffer_load_dwordx4 v1, s[4:7], s41 offen offset:0 sc1 lds
    buffer_load_dwordx4 v1, s[4:7], s41 offen offset:1024 sc1 lds
    buffer_load_dwordx4 v1, s[4:7], s41 offen offset:2048 sc1 lds
    buffer_load_dwordx4 v1, s[4:7], s41 offen offset:3072 sc1 lds
    s_add_u32 s40, s40, 4096
    s_add_u32 s41, s41, 4096
    s_mov_b32 m0, s40
    s_nop 0
    buffer_load_dwordx4 v1, s[4:7], s41 offen offset:0 sc1 lds
    s_mul_i32 s40, s26, 5120
    s_add_u32 s41, s40, s47
    s_add_u32 s41, s41, 56320
    s_add_u32 s40, s40, 122880
    s_mov_b32 m0, s40
    s_nop 0
    buffer_load_dwordx4 v1, s[4:7], s41 offen offset:0 sc1 lds
    buffer_load_dwordx4 v1, s[4:7], s41 offen offset:1024 sc1 lds
    buffer_load_dwordx4 v1, s[4:7], s41 offen offset:2048 sc1 lds
    buffer_load_dwordx4 v1, s[4:7], s41 offen offset:3072 sc1 lds
    s_add_u32 s40, s40, 4096
    s_add_u32 s41, s41, 4096
    s_mov_b32 m0, s40
    s_nop 0
    buffer_load_dwordx4 v1, s[4:7], s41 offen offset:0 sc1 lds
    s_mul_i32 s40, s26, 5120
    s_add_u32 s41, s40, s47
    s_add_u32 s41, s41, 76800
    s_add_u32 s40, s40, 143360
    s_mov_b32 m0, s40
    s_nop 0
    buffer_load_dwordx4 v1, s[4:7], s41 offen offset:0 sc1 lds
    buffer_load_dwordx4 v1, s[4:7], s41 offen offset:1024 sc1 lds
    buffer_load_dwordx4 v1, s[4:7], s41 offen offset:2048 sc1 lds
    buffer_load_dwordx4 v1, s[4:7], s41 offen offset:3072 sc1 lds
    s_add_u32 s40, s40, 4096
    s_add_u32 s41, s41, 4096
    s_mov_b32 m0, s40
    s_nop 0
    buffer_load_dwordx4 v1, s[4:7], s41 offen offset:0 sc1 lds
    s_barrier
    s_waitcnt vmcnt(0)
    s_mul_i32 s40, s26, 5120
    s_add_u32 s41, s40, s47
    s_add_u32 s41, s41, 97280
    s_add_u32 s40, s40, 0
    s_mov_b32 m0, s40
    s_nop 0
    buffer_load_dwordx4 v1, s[4:7], s41 offen offset:0 sc1 lds
    buffer_load_dwordx4 v1, s[4:7], s41 offen offset:1024 sc1 lds
    buffer_load_dwordx4 v1, s[4:7], s41 offen offset:2048 sc1 lds
    buffer_load_dwordx4 v1, s[4:7], s41 offen offset:3072 sc1 lds
    s_add_u32 s40, s40, 4096
    s_add_u32 s41, s41, 4096
    s_mov_b32 m0, s40
    s_nop 0
    buffer_load_dwordx4 v1, s[4:7], s41 offen offset:0 sc1 lds
    s_cmp_ge_u32 s26, 2
    s_cbranch_scc1 w2_20054
    s_mul_i32 s40, s26, 5120
    s_add_u32 s41, s40, s47
    s_add_u32 s41, s41, 117760
    s_add_u32 s40, s40, 20480
    s_mov_b32 m0, s40
    s_nop 0
    buffer_load_dwordx4 v1, s[4:7], s41 offen offset:0 sc1 lds
    buffer_load_dwordx4 v1, s[4:7], s41 offen offset:1024 sc1 lds
    buffer_load_dwordx4 v1, s[4:7], s41 offen offset:2048 sc1 lds
    buffer_load_dwordx4 v1, s[4:7], s41 offen offset:3072 sc1 lds
    s_add_u32 s40, s40, 4096
    s_add_u32 s41, s41, 4096
    s_mov_b32 m0, s40
    s_nop 0
    buffer_load_dwordx4 v1, s[4:7], s41 offen offset:0 sc1 lds
w2_20054:
    s_barrier
    s_mul_i32 s40, s26, 5120
    s_add_u32 s41, s40, s47
    s_add_u32 s41, s41, 128000
    s_add_u32 s40, s40, 30720
    s_mov_b32 m0, s40
    s_nop 0
    buffer_load_dwordx4 v1, s[4:7], s41 offen offset:0 sc1 lds
    buffer_load_dwordx4 v1, s[4:7], s41 offen offset:1024 sc1 lds
    buffer_load_dwordx4 v1, s[4:7], s41 offen offset:2048 sc1 lds
    buffer_load_dwordx4 v1, s[4:7], s41 offen offset:3072 sc1 lds
    s_add_u32 s40, s40, 4096
    s_add_u32 s41, s41, 4096
    s_mov_b32 m0, s40
    s_nop 0
    buffer_load_dwordx4 v1, s[4:7], s41 offen offset:0 sc1 lds
    s_cmp_ge_u32 s26, 3
    s_cbranch_scc1 w2_20055
    s_mul_i32 s40, s26, 5120
    s_add_u32 s41, s40, s47
    s_add_u32 s41, s41, 148480
    s_add_u32 s40, s40, 51200
    s_mov_b32 m0, s40
    s_nop 0
    buffer_load_dwordx4 v1, s[4:7], s41 offen offset:0 sc1 lds
    buffer_load_dwordx4 v1, s[4:7], s41 offen offset:1024 sc1 lds
    buffer_load_dwordx4 v1, s[4:7], s41 offen offset:2048 sc1 lds
    buffer_load_dwordx4 v1, s[4:7], s41 offen offset:3072 sc1 lds
    s_add_u32 s40, s40, 4096
    s_add_u32 s41, s41, 4096
    s_mov_b32 m0, s40
    s_nop 0
    buffer_load_dwordx4 v1, s[4:7], s41 offen offset:0 sc1 lds
w2_20055:
    s_barrier
    s_waitcnt vmcnt(0)
    s_cmp_eq_u32 s39, 0
    s_cbranch_scc1 rf_20056
    s_mul_i32 s40, s26, 10240
    s_add_u32 s40, s40, 66560
    v_add_u32 v252, s40, v1
    ds_write_b128 v252, v[40:43] offset:0
    ds_write_b128 v252, v[44:47] offset:1024
    ds_write_b128 v252, v[48:51] offset:2048
    ds_write_b128 v252, v[52:55] offset:3072
    ds_write_b128 v252, v[56:59] offset:4096
    ds_write_b128 v252, v[60:63] offset:5120
    ds_write_b128 v252, v[64:67] offset:6144
    ds_write_b128 v252, v[68:71] offset:7168
    ds_write_b128 v252, v[72:75] offset:8192
    ds_write_b128 v252, v[76:79] offset:9216
    s_branch rf_20057
rf_20056:
    s_mul_i32 s40, s26, 5120
    s_add_u32 s41, s40, s47
    s_add_u32 s41, s41, 163840
    s_add_u32 s40, s40, 66560
    s_mov_b32 m0, s40
    s_nop 0
    buffer_load_dwordx4 v1, s[4:7], s41 offen offset:0 sc1 lds
    buffer_load_dwordx4 v1, s[4:7], s41 offen offset:1024 sc1 lds
    buffer_load_dwordx4 v1, s[4:7], s41 offen offset:2048 sc1 lds
    buffer_load_dwordx4 v1, s[4:7], s41 offen offset:3072 sc1 lds
    s_add_u32 s40, s40, 4096
    s_add_u32 s41, s41, 4096
    s_mov_b32 m0, s40
    s_nop 0
    buffer_load_dwordx4 v1, s[4:7], s41 offen offset:0 sc1 lds
    s_mul_i32 s40, s26, 5120
    s_add_u32 s41, s40, s47
    s_add_u32 s41, s41, 184320
    s_add_u32 s40, s40, 87040
    s_mov_b32 m0, s40
    s_nop 0
    buffer_load_dwordx4 v1, s[4:7], s41 offen offset:0 sc1 lds
    buffer_load_dwordx4 v1, s[4:7], s41 offen offset:1024 sc1 lds
    buffer_load_dwordx4 v1, s[4:7], s41 offen offset:2048 sc1 lds
    buffer_load_dwordx4 v1, s[4:7], s41 offen offset:3072 sc1 lds
    s_add_u32 s40, s40, 4096
    s_add_u32 s41, s41, 4096
    s_mov_b32 m0, s40
    s_nop 0
    buffer_load_dwordx4 v1, s[4:7], s41 offen offset:0 sc1 lds
rf_20057:
    s_cmp_eq_u32 s39, 0
    s_cbranch_scc1 wb_20058
    s_lshl_b32 s40, s17, 2
    s_add_u32 s40, s40, s26
    s_cmp_lg_u32 s40, 0
    s_cbranch_scc1 wb_20058
    buffer_wbl2 sc1
wb_20058:
    s_barrier
    s_cmp_eq_u32 s39, 0
    s_cbranch_scc1 rf_20059
    s_mul_i32 s40, s26, 10240
    s_add_u32 s40, s40, 107520
    v_add_u32 v252, s40, v1
    ds_write_b128 v252, v[80:83] offset:0
    ds_write_b128 v252, v[84:87] offset:1024
    ds_write_b128 v252, v[88:91] offset:2048
    ds_write_b128 v252, v[92:95] offset:3072
    ds_write_b128 v252, v[96:99] offset:4096
    ds_write_b128 v252, v[100:103] offset:5120
    ds_write_b128 v252, v[104:107] offset:6144
    ds_write_b128 v252, v[108:111] offset:7168
    ds_write_b128 v252, v[112:115] offset:8192
    ds_write_b128 v252, v[116:119] offset:9216
    s_branch rf_20060
rf_20059:
    s_mul_i32 s40, s26, 5120
    s_add_u32 s41, s40, s47
    s_add_u32 s41, s41, 204800
    s_add_u32 s40, s40, 107520
    s_mov_b32 m0, s40
    s_nop 0
    buffer_load_dwordx4 v1, s[4:7], s41 offen offset:0 sc1 lds
    buffer_load_dwordx4 v1, s[4:7], s41 offen offset:1024 sc1 lds
    buffer_load_dwordx4 v1, s[4:7], s41 offen offset:2048 sc1 lds
    buffer_load_dwordx4 v1, s[4:7], s41 offen offset:3072 sc1 lds
    s_add_u32 s40, s40, 4096
    s_add_u32 s41, s41, 4096
    s_mov_b32 m0, s40
    s_nop 0
    buffer_load_dwordx4 v1, s[4:7], s41 offen offset:0 sc1 lds
    s_mul_i32 s40, s26, 5120
    s_add_u32 s41, s40, s47
    s_add_u32 s41, s41, 225280
    s_add_u32 s40, s40, 128000
    s_mov_b32 m0, s40
    s_nop 0
    buffer_load_dwordx4 v1, s[4:7], s41 offen offset:0 sc1 lds
    buffer_load_dwordx4 v1, s[4:7], s41 offen offset:1024 sc1 lds
    buffer_load_dwordx4 v1, s[4:7], s41 offen offset:2048 sc1 lds
    buffer_load_dwordx4 v1, s[4:7], s41 offen offset:3072 sc1 lds
    s_add_u32 s40, s40, 4096
    s_add_u32 s41, s41, 4096
    s_mov_b32 m0, s40
    s_nop 0
    buffer_load_dwordx4 v1, s[4:7], s41 offen offset:0 sc1 lds
rf_20060:
    s_waitcnt vmcnt(0) lgkmcnt(0)
    s_barrier
    s_cmp_lg_u32 s39, 0
    s_cbranch_scc1 interleave_layers__sliding_block__dense_activation_squared_relu__prompt_kernel_end
    s_barrier
    ds_write_b128 v4, v[40:43] offset:0
    ds_write_b128 v4, v[44:47] offset:1024
    ds_write_b128 v4, v[48:51] offset:8192
    ds_write_b128 v4, v[52:55] offset:9216
    ds_write_b128 v4, v[56:59] offset:16384
    ds_write_b128 v4, v[60:63] offset:17408
    ds_write_b128 v4, v[64:67] offset:24576
    ds_write_b128 v4, v[68:71] offset:25600
    ds_write_b128 v4, v[72:75] offset:32768
    ds_write_b128 v4, v[76:79] offset:33792
    ds_write_b128 v4, v[80:83] offset:40960
    ds_write_b128 v4, v[84:87] offset:41984
    ds_write_b128 v4, v[88:91] offset:49152
    ds_write_b128 v4, v[92:95] offset:50176
    ds_write_b128 v4, v[96:99] offset:57344
    ds_write_b128 v4, v[100:103] offset:58368
    ds_write_b128 v13, v[104:107] offset:0
    ds_write_b128 v13, v[108:111] offset:1024
    ds_write_b128 v13, v[112:115] offset:8192
    ds_write_b128 v13, v[116:119] offset:9216
    s_waitcnt lgkmcnt(0)
    s_mov_b32 s39, 1
    s_add_u32 s20, s20, 6291456
    s_add_u32 s21, s21, 409600
    s_barrier
    s_branch svc_top
to_6:
    s_mov_b32 s23, 0
    s_branch pd_4
to_10:
    s_mov_b32 s23, 0
    s_branch lfd_9
to_15:
    s_mov_b32 s23, 0
    s_branch pd_14
inv_16:
    buffer_inv sc1
    s_waitcnt vmcnt(0)
    s_branch invr_17
q0_18:
    s_lshl_b32 s40, s26, 2
    s_add_u32 s40, s40, 159760
    v_mov_b32 v221, s40
    v_mov_b32 v222, s100
    ds_write_b32 v221, v222
    v_and_b32 v221, 3, v0
    v_lshlrev_b32 v221, 2, v221
    v_add_u32 v221, 159760, v221
    s_mov_b32 s61, 0
q0_18p:
    s_nop 1
    ds_read_b32 v222, v221
    s_waitcnt lgkmcnt(0)
    v_cmp_ne_u32 vcc, s100, v222
    s_add_u32 s61, s61, 1
    s_nop 3
    s_cbranch_vccz q1_19
    s_lshr_b32 s60, s61, 6
    s_cmp_lt_u32 s60, s23
    s_cbranch_scc1 q0_18p
    s_branch q1_19
q0_20:
    v_and_b32 v221, 3, v0
    v_lshlrev_b32 v221, 2, v221
    v_add_u32 v221, 159776, v221
    s_mov_b64 s[58:59], vcc
    s_mov_b32 s61, 0
q0_20p:
    s_nop 0
    ds_read_b32 v222, v221
    s_waitcnt lgkmcnt(0)
    s_add_u32 s60, s100, 2
    v_subrev_u32 v222, s60, v222
    v_cmp_le_u32 vcc, 32, v222
    s_add_u32 s61, s61, 1
    s_nop 3
    s_cbranch_vccz q0_20d
    s_lshr_b32 s60, s61, 6
    s_cmp_lt_u32 s60, s23
    s_cbranch_scc1 q0_20p
q0_20d:
    s_mov_b64 vcc, s[58:59]
    s_branch q1_21
q0_22:
    v_and_b32 v221, 3, v0
    v_lshlrev_b32 v221, 2, v221
    v_add_u32 v221, 159776, v221
    s_mov_b64 s[58:59], vcc
    s_mov_b32 s61, 0
q0_22p:
    s_nop 0
    ds_read_b32 v222, v221
    s_waitcnt lgkmcnt(0)
    s_add_u32 s60, s100, 3
    v_subrev_u32 v222, s60, v222
    v_cmp_le_u32 vcc, 32, v222
    s_add_u32 s61, s61, 1
    s_nop 3
    s_cbranch_vccz q0_22d
    s_lshr_b32 s60, s61, 6
    s_cmp_lt_u32 s60, s23
    s_cbranch_scc1 q0_22p
q0_22d:
    s_mov_b64 vcc, s[58:59]
    s_branch q1_23
q0_24:
    v_and_b32 v221, 3, v0
    v_lshlrev_b32 v221, 2, v221
    v_add_u32 v221, 159776, v221
    s_mov_b64 s[58:59], vcc
    s_mov_b32 s61, 0
q0_24p:
    s_nop 0
    ds_read_b32 v222, v221
    s_waitcnt lgkmcnt(0)
    s_add_u32 s60, s100, 4
    v_subrev_u32 v222, s60, v222
    v_cmp_le_u32 vcc, 32, v222
    s_add_u32 s61, s61, 1
    s_nop 3
    s_cbranch_vccz q0_24d
    s_lshr_b32 s60, s61, 6
    s_cmp_lt_u32 s60, s23
    s_cbranch_scc1 q0_24p
q0_24d:
    s_mov_b64 vcc, s[58:59]
    s_branch q1_25
q0_26:
    v_and_b32 v221, 3, v0
    v_lshlrev_b32 v221, 2, v221
    v_add_u32 v221, 159776, v221
    s_mov_b64 s[58:59], vcc
    s_mov_b32 s61, 0
q0_26p:
    s_nop 0
    ds_read_b32 v222, v221
    s_waitcnt lgkmcnt(0)
    s_add_u32 s60, s100, 5
    v_subrev_u32 v222, s60, v222
    v_cmp_le_u32 vcc, 32, v222
    s_add_u32 s61, s61, 1
    s_nop 3
    s_cbranch_vccz q0_26d
    s_lshr_b32 s60, s61, 6
    s_cmp_lt_u32 s60, s23
    s_cbranch_scc1 q0_26p
q0_26d:
    s_mov_b64 vcc, s[58:59]
    s_branch q1_27
q0_28:
    v_and_b32 v221, 3, v0
    v_lshlrev_b32 v221, 2, v221
    v_add_u32 v221, 159776, v221
    s_mov_b64 s[58:59], vcc
    s_mov_b32 s61, 0
q0_28p:
    s_nop 0
    ds_read_b32 v222, v221
    s_waitcnt lgkmcnt(0)
    s_add_u32 s60, s100, 6
    v_subrev_u32 v222, s60, v222
    v_cmp_le_u32 vcc, 32, v222
    s_add_u32 s61, s61, 1
    s_nop 3
    s_cbranch_vccz q0_28d
    s_lshr_b32 s60, s61, 6
    s_cmp_lt_u32 s60, s23
    s_cbranch_scc1 q0_28p
q0_28d:
    s_mov_b64 vcc, s[58:59]
    s_branch q1_29
q0_30:
    v_and_b32 v221, 3, v0
    v_lshlrev_b32 v221, 2, v221
    v_add_u32 v221, 159776, v221
    s_mov_b64 s[58:59], vcc
    s_mov_b32 s61, 0
q0_30p:
    s_nop 0
    ds_read_b32 v222, v221
    s_waitcnt lgkmcnt(0)
    s_add_u32 s60, s100, 7
    v_subrev_u32 v222, s60, v222
    v_cmp_le_u32 vcc, 32, v222
    s_add_u32 s61, s61, 1
    s_nop 3
    s_cbranch_vccz q0_30d
    s_lshr_b32 s60, s61, 6
    s_cmp_lt_u32 s60, s23
    s_cbranch_scc1 q0_30p
q0_30d:
    s_mov_b64 vcc, s[58:59]
    s_branch q1_31
q0_32:
    v_and_b32 v221, 3, v0
    v_lshlrev_b32 v221, 2, v221
    v_add_u32 v221, 159776, v221
    s_mov_b64 s[58:59], vcc
    s_mov_b32 s61, 0
q0_32p:
    s_nop 0
    ds_read_b32 v222, v221
    s_waitcnt lgkmcnt(0)
    s_add_u32 s60, s100, 8
    v_subrev_u32 v222, s60, v222
    v_cmp_le_u32 vcc, 32, v222
    s_add_u32 s61, s61, 1
    s_nop 3
    s_cbranch_vccz q0_32d
    s_lshr_b32 s60, s61, 6
    s_cmp_lt_u32 s60, s23
    s_cbranch_scc1 q0_32p
q0_32d:
    s_mov_b64 vcc, s[58:59]
    s_branch q1_33
q0_35:
    v_and_b32 v221, 3, v0
    v_lshlrev_b32 v221, 2, v221
    v_add_u32 v221, 159776, v221
    s_mov_b64 s[58:59], vcc
    s_mov_b32 s61, 0
q0_35p:
    s_nop 0
    ds_read_b32 v222, v221
    s_waitcnt lgkmcnt(0)
    s_add_u32 s60, s100, 9
    v_subrev_u32 v222, s60, v222
    v_cmp_le_u32 vcc, 32, v222
    s_add_u32 s61, s61, 1
    s_nop 3
    s_cbranch_vccz q0_35d
    s_lshr_b32 s60, s61, 6
    s_cmp_lt_u32 s60, s23
    s_cbranch_scc1 q0_35p
q0_35d:
    s_mov_b64 vcc, s[58:59]
    s_branch q1_36
hc_40:
    s_mov_b32 s61, 0
hc_40p:
    ds_read_b32 v223, v222 offset:0
    s_waitcnt lgkmcnt(0)
    v_cmp_ne_u32 vcc, s100, v223
    s_add_u32 s61, s61, 1
    s_nop 3
    s_cbranch_vccz hcr_41
    s_lshr_b32 s60, s61, 6
    s_cmp_lt_u32 s60, s23
    s_cbranch_scc1 hc_40p
    s_mov_b32 s23, 0
    s_branch hcr_41
att0_g0:
    v_exp_f32 v68, v68
    v_exp_f32 v69, v69
    v_exp_f32 v70, v70
    v_exp_f32 v71, v71
    v_exp_f32 v72, v72
    v_exp_f32 v73, v73
    v_exp_f32 v74, v74
    v_exp_f32 v75, v75
    v_cvt_pk_bf16_f32 v68, v68, v69
    v_cvt_pk_bf16_f32 v69, v70, v71
    v_cvt_pk_bf16_f32 v70, v72, v73
    v_cvt_pk_bf16_f32 v71, v74, v75
    v_exp_f32 v76, v76
    v_exp_f32 v77, v77
    v_exp_f32 v78, v78
    v_exp_f32 v79, v79
    v_exp_f32 v80, v80
    v_exp_f32 v81, v81
    s_waitcnt lgkmcnt(2)
    v_mfma_f32_32x32x16_bf16 v[116:131], v[148:151], v[68:71], v[116:131]
    v_exp_f32 v82, v82
    v_exp_f32 v83, v83
    v_cvt_pk_bf16_f32 v72, v76, v77
    v_cvt_pk_bf16_f32 v73, v78, v79
    v_cvt_pk_bf16_f32 v74, v80, v81
    v_cvt_pk_bf16_f32 v75, v82, v83
    s_waitcnt lgkmcnt(0)
    s_nop 0
    v_mfma_f32_32x32x16_bf16 v[116:131], v[152:155], v[72:75], v[116:131]
    s_branch att_done
hc_42:
    s_mov_b32 s61, 0
hc_42p:
    ds_read_b32 v223, v222 offset:16
    s_waitcnt lgkmcnt(0)
    v_cmp_ne_u32 vcc, s100, v223
    s_add_u32 s61, s61, 1
    s_nop 3
    s_cbranch_vccz hcr_43
    s_lshr_b32 s60, s61, 6
    s_cmp_lt_u32 s60, s23
    s_cbranch_scc1 hc_42p
    s_mov_b32 s23, 0
    s_branch hcr_43
hc_47:
    s_mov_b32 s61, 0
hc_47p:
    ds_read_b32 v223, v222 offset:0
    s_waitcnt lgkmcnt(0)
    v_cmp_ne_u32 vcc, s100, v223
    s_add_u32 s61, s61, 1
    s_nop 3
    s_cbranch_vccz hcr_48
    s_lshr_b32 s60, s61, 6
    s_cmp_lt_u32 s60, s23
    s_cbranch_scc1 hc_47p
    s_mov_b32 s23, 0
    s_branch hcr_48
att1_g0:
    v_exp_f32 v68, v68
    v_exp_f32 v69, v69
    v_exp_f32 v70, v70
    v_exp_f32 v71, v71
    v_exp_f32 v72, v72
    v_exp_f32 v73, v73
    v_exp_f32 v74, v74
    v_exp_f32 v75, v75
    v_cvt_pk_bf16_f32 v68, v68, v69
    v_cvt_pk_bf16_f32 v69, v70, v71
    v_cvt_pk_bf16_f32 v70, v72, v73
    v_cvt_pk_bf16_f32 v71, v74, v75
    v_exp_f32 v76, v76
    v_exp_f32 v77, v77
    v_exp_f32 v78, v78
    v_exp_f32 v79, v79
    v_exp_f32 v80, v80
    v_exp_f32 v81, v81
    s_waitcnt lgkmcnt(2)
    v_mfma_f32_32x32x16_bf16 v[132:147], v[148:151], v[68:71], v[132:147]
    v_exp_f32 v82, v82
    v_exp_f32 v83, v83
    v_cvt_pk_bf16_f32 v72, v76, v77
    v_cvt_pk_bf16_f32 v73, v78, v79
    v_cvt_pk_bf16_f32 v74, v80, v81
    v_cvt_pk_bf16_f32 v75, v82, v83
    s_waitcnt lgkmcnt(0)
    s_nop 0
    v_mfma_f32_32x32x16_bf16 v[132:147], v[152:155], v[72:75], v[132:147]
    s_branch att_done
hc_49:
    s_mov_b32 s61, 0
hc_49p:
    ds_read_b32 v223, v222 offset:16
    s_waitcnt lgkmcnt(0)
    v_cmp_ne_u32 vcc, s100, v223
    s_add_u32 s61, s61, 1
    s_nop 3
    s_cbranch_vccz hcr_50
    s_lshr_b32 s60, s61, 6
    s_cmp_lt_u32 s60, s23
    s_cbranch_scc1 hc_49p
    s_mov_b32 s23, 0
    s_branch hcr_50
hc_54:
    s_mov_b32 s61, 0
hc_54p:
    ds_read_b32 v223, v222 offset:0
    s_waitcnt lgkmcnt(0)
    v_cmp_ne_u32 vcc, s100, v223
    s_add_u32 s61, s61, 1
    s_nop 3
    s_cbranch_vccz hcr_55
    s_lshr_b32 s60, s61, 6
    s_cmp_lt_u32 s60, s23
    s_cbranch_scc1 hc_54p
    s_mov_b32 s23, 0
    s_branch hcr_55
att2_g0:
    v_exp_f32 v68, v68
    v_exp_f32 v69, v69
    v_exp_f32 v70, v70
    v_exp_f32 v71, v71
    v_exp_f32 v72, v72
    v_exp_f32 v73, v73
    v_exp_f32 v74, v74
    v_exp_f32 v75, v75
    v_cvt_pk_bf16_f32 v68, v68, v69
    v_cvt_pk_bf16_f32 v69, v70, v71
    v_cvt_pk_bf16_f32 v70, v72, v73
    v_cvt_pk_bf16_f32 v71, v74, v75
    v_exp_f32 v76, v76
    v_exp_f32 v77, v77
    v_exp_f32 v78, v78
    v_exp_f32 v79, v79
    v_exp_f32 v80, v80
    v_exp_f32 v81, v81
    s_waitcnt lgkmcnt(2)
    v_mfma_f32_32x32x16_bf16 v[132:147], v[148:151], v[68:71], v[132:147]
    v_exp_f32 v82, v82
    v_exp_f32 v83, v83
    v_cvt_pk_bf16_f32 v72, v76, v77
    v_cvt_pk_bf16_f32 v73, v78, v79
    v_cvt_pk_bf16_f32 v74, v80, v81
    v_cvt_pk_bf16_f32 v75, v82, v83
    s_waitcnt lgkmcnt(0)
    s_nop 0
    v_mfma_f32_32x32x16_bf16 v[132:147], v[152:155], v[72:75], v[132:147]
    s_branch att_done
hc_56:
    s_mov_b32 s61, 0
hc_56p:
    ds_read_b32 v223, v222 offset:16
    s_waitcnt lgkmcnt(0)
    v_cmp_ne_u32 vcc, s100, v223
    s_add_u32 s61, s61, 1
    s_nop 3
    s_cbranch_vccz hcr_57
    s_lshr_b32 s60, s61, 6
    s_cmp_lt_u32 s60, s23
    s_cbranch_scc1 hc_56p
    s_mov_b32 s23, 0
    s_branch hcr_57
hc_61:
    s_mov_b32 s61, 0
hc_61p:
    ds_read_b32 v223, v222 offset:0
    s_waitcnt lgkmcnt(0)
    v_cmp_ne_u32 vcc, s100, v223
    s_add_u32 s61, s61, 1
    s_nop 3
    s_cbranch_vccz hcr_62
    s_lshr_b32 s60, s61, 6
    s_cmp_lt_u32 s60, s23
    s_cbranch_scc1 hc_61p
    s_mov_b32 s23, 0
    s_branch hcr_62
att3_g0:
    v_exp_f32 v68, v68
    v_exp_f32 v69, v69
    v_exp_f32 v70, v70
    v_exp_f32 v71, v71
    v_exp_f32 v72, v72
    v_exp_f32 v73, v73
    v_exp_f32 v74, v74
    v_exp_f32 v75, v75
    v_cvt_pk_bf16_f32 v68, v68, v69
    v_cvt_pk_bf16_f32 v69, v70, v71
    v_cvt_pk_bf16_f32 v70, v72, v73
    v_cvt_pk_bf16_f32 v71, v74, v75
    v_exp_f32 v76, v76
    v_exp_f32 v77, v77
    v_exp_f32 v78, v78
    v_exp_f32 v79, v79
    v_exp_f32 v80, v80
    v_exp_f32 v81, v81
    s_waitcnt lgkmcnt(2)
    v_mfma_f32_32x32x16_bf16 v[132:147], v[148:151], v[68:71], v[132:147]
    v_exp_f32 v82, v82
    v_exp_f32 v83, v83
    v_cvt_pk_bf16_f32 v72, v76, v77
    v_cvt_pk_bf16_f32 v73, v78, v79
    v_cvt_pk_bf16_f32 v74, v80, v81
    v_cvt_pk_bf16_f32 v75, v82, v83
    s_waitcnt lgkmcnt(0)
    s_nop 0
    v_mfma_f32_32x32x16_bf16 v[132:147], v[152:155], v[72:75], v[132:147]
    s_branch att_done
hc_63:
    s_mov_b32 s61, 0
hc_63p:
    ds_read_b32 v223, v222 offset:16
    s_waitcnt lgkmcnt(0)
    v_cmp_ne_u32 vcc, s100, v223
    s_add_u32 s61, s61, 1
    s_nop 3
    s_cbranch_vccz hcr_64
    s_lshr_b32 s60, s61, 6
    s_cmp_lt_u32 s60, s23
    s_cbranch_scc1 hc_63p
    s_mov_b32 s23, 0
    s_branch hcr_64
du_65:
    s_nop 7
    s_nop 7
    s_waitcnt vmcnt(0) lgkmcnt(0)
    buffer_store_dwordx4 v[116:119], v1, s[4:7], s48 offen sc1
    buffer_store_dwordx2 v[120:121], v172, s[4:7], s49 offen offset:2048 sc1
    s_nop 2
    s_branch dur_66
du_67:
    s_nop 7
    s_nop 7
    s_waitcnt vmcnt(0) lgkmcnt(0)
    buffer_store_dwordx4 v[132:135], v1, s[4:7], s50 offen sc1
    buffer_store_dwordx2 v[136:137], v172, s[4:7], s51 offen offset:2048 sc1
    s_nop 2
    s_branch dur_68
du_69:
    s_nop 7
    s_nop 7
    s_waitcnt vmcnt(0) lgkmcnt(0)
    s_mov_b64 exec, 3
    buffer_store_dword v216, v217, s[4:7], s42 offen sc1
    s_mov_b64 exec, -1
    s_nop 2
    s_branch dur_70
slowA:
    s_nop 15
    s_waitcnt vmcnt(0) lgkmcnt(0)
    s_and_b32 s59, s18, 7
    s_lshl_b32 s58, s59, 10
    v_add_u32 v174, s58, v236
    s_lshl_b32 s58, s59, 8
    v_add_u32 v175, s58, v237
    s_lshl_b32 s58, s59, 11
    v_add_u32 v176, s58, v242
    v_add_u32 v177, s58, v243
    v_mov_b32 v46, 0
    s_sub_u32 s60, 8, s59
    s_cmp_eq_u32 s16, 0
    s_cselect_b32 s60, s60, 0
    v_mov_b32 v178, 0xff800000
    v_mov_b32 v116, 0
    v_mov_b32 v117, 0
    v_mov_b32 v118, 0
    v_mov_b32 v119, 0
    v_mov_b32 v120, 0
    v_mov_b32 v121, 0
    v_mov_b32 v122, 0
    v_mov_b32 v123, 0
    v_mov_b32 v124, 0
    v_mov_b32 v125, 0
    v_mov_b32 v126, 0
    v_mov_b32 v127, 0
    v_mov_b32 v128, 0
    v_mov_b32 v129, 0
    v_mov_b32 v130, 0
    v_mov_b32 v131, 0
    s_cmp_gt_u32 s60, 0
    s_cbranch_scc1 sl_10001
    ds_read_b128 v[100:103], v174 offset:0
    ds_read_b64 v[104:105], v175 offset:0
    s_waitcnt lgkmcnt(1)
    v_mfma_f32_32x32x16_bf16 v[68:83], v[100:103], v[52:55], v[196:211]
    s_waitcnt lgkmcnt(0)
    v_mfma_f32_32x32x16_bf16 v[68:83], v[104:107], v[44:47], v[68:83]
    s_nop 11
    v_max3_f32 v178, v178, v68, v69
    v_max3_f32 v178, v178, v70, v71
    v_max3_f32 v178, v178, v72, v73
    v_max3_f32 v178, v178, v74, v75
    v_max3_f32 v178, v178, v76, v77
    v_max3_f32 v178, v178, v78, v79
    v_max3_f32 v178, v178, v80, v81
    v_max3_f32 v178, v178, v82, v83
sl_10001:
    s_nop 2
    s_cmp_gt_u32 s60, 1
    s_cbranch_scc1 sl_10002
    ds_read_b128 v[100:103], v174 offset:1024
    ds_read_b64 v[104:105], v175 offset:256
    s_waitcnt lgkmcnt(1)
    v_mfma_f32_32x32x16_bf16 v[68:83], v[100:103], v[52:55], 0
    s_waitcnt lgkmcnt(0)
    v_mfma_f32_32x32x16_bf16 v[68:83], v[104:107], v[44:47], v[68:83]
    s_nop 11
    v_max3_f32 v178, v178, v68, v69
    v_max3_f32 v178, v178, v70, v71
    v_max3_f32 v178, v178, v72, v73
    v_max3_f32 v178, v178, v74, v75
    v_max3_f32 v178, v178, v76, v77
    v_max3_f32 v178, v178, v78, v79
    v_max3_f32 v178, v178, v80, v81
    v_max3_f32 v178, v178, v82, v83
sl_10002:
    s_nop 2
    s_cmp_gt_u32 s60, 2
    s_cbranch_scc1 sl_10003
    ds_read_b128 v[100:103], v174 offset:2048
    ds_read_b64 v[104:105], v175 offset:512
    s_waitcnt lgkmcnt(1)
    v_mfma_f32_32x32x16_bf16 v[68:83], v[100:103], v[52:55], 0
    s_waitcnt lgkmcnt(0)
    v_mfma_f32_32x32x16_bf16 v[68:83], v[104:107], v[44:47], v[68:83]
    s_nop 11
    v_max3_f32 v178, v178, v68, v69
    v_max3_f32 v178, v178, v70, v71
    v_max3_f32 v178, v178, v72, v73
    v_max3_f32 v178, v178, v74, v75
    v_max3_f32 v178, v178, v76, v77
    v_max3_f32 v178, v178, v78, v79
    v_max3_f32 v178, v178, v80, v81
    v_max3_f32 v178, v178, v82, v83
sl_10003:
    s_nop 2
    s_cmp_gt_u32 s60, 3
    s_cbranch_scc1 sl_10004
    ds_read_b128 v[100:103], v174 offset:3072
    ds_read_b64 v[104:105], v175 offset:768
    s_waitcnt lgkmcnt(1)
    v_mfma_f32_32x32x16_bf16 v[68:83], v[100:103], v[52:55], 0
    s_waitcnt lgkmcnt(0)
    v_mfma_f32_32x32x16_bf16 v[68:83], v[104:107], v[44:47], v[68:83]
    s_nop 11
    v_max3_f32 v178, v178, v68, v69
    v_max3_f32 v178, v178, v70, v71
    v_max3_f32 v178, v178, v72, v73
    v_max3_f32 v178, v178, v74, v75
    v_max3_f32 v178, v178, v76, v77
    v_max3_f32 v178, v178, v78, v79
    v_max3_f32 v178, v178, v80, v81
    v_max3_f32 v178, v178, v82, v83
sl_10004:
    s_nop 2
    s_cmp_gt_u32 s60, 4
    s_cbranch_scc1 sl_10005
    ds_read_b128 v[100:103], v174 offset:4096
    ds_read_b64 v[104:105], v175 offset:1024
    s_waitcnt lgkmcnt(1)
    v_mfma_f32_32x32x16_bf16 v[68:83], v[100:103], v[52:55], 0
    s_waitcnt lgkmcnt(0)
    v_mfma_f32_32x32x16_bf16 v[68:83], v[104:107], v[44:47], v[68:83]
    s_nop 11
    v_max3_f32 v178, v178, v68, v69
    v_max3_f32 v178, v178, v70, v71
    v_max3_f32 v178, v178, v72, v73
    v_max3_f32 v178, v178, v74, v75
    v_max3_f32 v178, v178, v76, v77
    v_max3_f32 v178, v178, v78, v79
    v_max3_f32 v178, v178, v80, v81
    v_max3_f32 v178, v178, v82, v83
sl_10005:
    s_nop 2
    s_cmp_gt_u32 s60, 5
    s_cbranch_scc1 sl_10006
    ds_read_b128 v[100:103], v174 offset:5120
    ds_read_b64 v[104:105], v175 offset:1280
    s_waitcnt lgkmcnt(1)
    v_mfma_f32_32x32x16_bf16 v[68:83], v[100:103], v[52:55], 0
    s_waitcnt lgkmcnt(0)
    v_mfma_f32_32x32x16_bf16 v[68:83], v[104:107], v[44:47], v[68:83]
    s_nop 11
    v_max3_f32 v178, v178, v68, v69
    v_max3_f32 v178, v178, v70, v71
    v_max3_f32 v178, v178, v72, v73
    v_max3_f32 v178, v178, v74, v75
    v_max3_f32 v178, v178, v76, v77
    v_max3_f32 v178, v178, v78, v79
    v_max3_f32 v178, v178, v80, v81
    v_max3_f32 v178, v178, v82, v83
sl_10006:
    s_nop 2
    s_cmp_gt_u32 s60, 6
    s_cbranch_scc1 sl_10007
    ds_read_b128 v[100:103], v174 offset:6144
    ds_read_b64 v[104:105], v175 offset:1536
    s_waitcnt lgkmcnt(1)
    v_mfma_f32_32x32x16_bf16 v[68:83], v[100:103], v[52:55], 0
    s_waitcnt lgkmcnt(0)
    v_mfma_f32_32x32x16_bf16 v[68:83], v[104:107], v[44:47], v[68:83]
    s_nop 11
    v_max3_f32 v178, v178, v68, v69
    v_max3_f32 v178, v178, v70, v71
    v_max3_f32 v178, v178, v72, v73
    v_max3_f32 v178, v178, v74, v75
    v_max3_f32 v178, v178, v76, v77
    v_max3_f32 v178, v178, v78, v79
    v_max3_f32 v178, v178, v80, v81
    v_max3_f32 v178, v178, v82, v83
sl_10007:
    s_nop 2
    s_cmp_gt_u32 s60, 7
    s_cbranch_scc1 sl_10008
    ds_read_b128 v[100:103], v174 offset:7168
    ds_read_b64 v[104:105], v175 offset:1792
    s_waitcnt lgkmcnt(1)
    v_mfma_f32_32x32x16_bf16 v[68:83], v[100:103], v[52:55], 0
    s_waitcnt lgkmcnt(0)
    v_mfma_f32_32x32x16_bf16 v[68:83], v[104:107], v[44:47], v[68:83]
    s_nop 11
    v_max3_f32 v178, v178, v68, v69
    v_max3_f32 v178, v178, v70, v71
    v_max3_f32 v178, v178, v72, v73
    v_max3_f32 v178, v178, v74, v75
    v_max3_f32 v178, v178, v76, v77
    v_max3_f32 v178, v178, v78, v79
    v_max3_f32 v178, v178, v80, v81
    v_max3_f32 v178, v178, v82, v83
sl_10008:
    s_nop 2
    s_cmp_gt_u32 s60, 8
    s_cbranch_scc1 sl_10009
    ds_read_b128 v[100:103], v174 offset:8192
    ds_read_b64 v[104:105], v175 offset:2048
    s_waitcnt lgkmcnt(1)
    v_mfma_f32_32x32x16_bf16 v[68:83], v[100:103], v[52:55], v[180:195]
    s_waitcnt lgkmcnt(0)
    v_mfma_f32_32x32x16_bf16 v[68:83], v[104:107], v[44:47], v[68:83]
    s_nop 11
    v_max3_f32 v178, v178, v68, v69
    v_max3_f32 v178, v178, v70, v71
    v_max3_f32 v178, v178, v72, v73
    v_max3_f32 v178, v178, v74, v75
    v_max3_f32 v178, v178, v76, v77
    v_max3_f32 v178, v178, v78, v79
    v_max3_f32 v178, v178, v80, v81
    v_max3_f32 v178, v178, v82, v83
sl_10009:
    s_nop 2
    v_mov_b32 v179, v178
    s_nop 1
    v_permlane32_swap_b32 v178, v179
    v_max_f32 v178, v178, v179
    s_cmp_gt_u32 s60, 0
    s_cbranch_scc1 sl_10010
    ds_read_b128 v[100:103], v174 offset:0
    ds_read_b64 v[104:105], v175 offset:0
    s_waitcnt lgkmcnt(1)
    v_mfma_f32_32x32x16_bf16 v[68:83], v[100:103], v[52:55], v[196:211]
    s_waitcnt lgkmcnt(0)
    v_mfma_f32_32x32x16_bf16 v[68:83], v[104:107], v[44:47], v[68:83]
    ds_read_b64_tr_b16 v[148:149], v176 offset:0
    ds_read_b64_tr_b16 v[150:151], v177 offset:512
    ds_read_b64_tr_b16 v[152:153], v176 offset:1024
    ds_read_b64_tr_b16 v[154:155], v177 offset:1536
    s_nop 7
    v_sub_f32 v68, v68, v178
    v_sub_f32 v69, v69, v178
    v_sub_f32 v70, v70, v178
    v_sub_f32 v71, v71, v178
    v_sub_f32 v72, v72, v178
    v_sub_f32 v73, v73, v178
    v_sub_f32 v74, v74, v178
    v_sub_f32 v75, v75, v178
    v_sub_f32 v76, v76, v178
    v_sub_f32 v77, v77, v178
    v_sub_f32 v78, v78, v178
    v_sub_f32 v79, v79, v178
    v_sub_f32 v80, v80, v178
    v_sub_f32 v81, v81, v178
    v_sub_f32 v82, v82, v178
    v_sub_f32 v83, v83, v178
    v_exp_f32 v68, v68
    v_exp_f32 v69, v69
    v_exp_f32 v70, v70
    v_exp_f32 v71, v71
    v_exp_f32 v72, v72
    v_exp_f32 v73, v73
    v_exp_f32 v74, v74
    v_exp_f32 v75, v75
    v_exp_f32 v76, v76
    v_exp_f32 v77, v77
    v_exp_f32 v78, v78
    v_exp_f32 v79, v79
    v_exp_f32 v80, v80
    v_exp_f32 v81, v81
    v_exp_f32 v82, v82
    v_exp_f32 v83, v83
    v_cvt_pk_bf16_f32 v68, v68, v69
    v_cvt_pk_bf16_f32 v69, v70, v71
    v_cvt_pk_bf16_f32 v70, v72, v73
    v_cvt_pk_bf16_f32 v71, v74, v75
    v_cvt_pk_bf16_f32 v72, v76, v77
    v_cvt_pk_bf16_f32 v73, v78, v79
    v_cvt_pk_bf16_f32 v74, v80, v81
    v_cvt_pk_bf16_f32 v75, v82, v83
    s_waitcnt lgkmcnt(2)
    v_mfma_f32_32x32x16_bf16 v[116:131], v[148:151], v[68:71], v[116:131]
    s_waitcnt lgkmcnt(0)
    v_mfma_f32_32x32x16_bf16 v[116:131], v[152:155], v[72:75], v[116:131]
sl_10010:
    s_nop 11
    s_cmp_gt_u32 s60, 1
    s_cbranch_scc1 sl_10011
    ds_read_b128 v[100:103], v174 offset:1024
    ds_read_b64 v[104:105], v175 offset:256
    s_waitcnt lgkmcnt(1)
    v_mfma_f32_32x32x16_bf16 v[68:83], v[100:103], v[52:55], 0
    s_waitcnt lgkmcnt(0)
    v_mfma_f32_32x32x16_bf16 v[68:83], v[104:107], v[44:47], v[68:83]
    ds_read_b64_tr_b16 v[148:149], v176 offset:2048
    ds_read_b64_tr_b16 v[150:151], v177 offset:2560
    ds_read_b64_tr_b16 v[152:153], v176 offset:3072
    ds_read_b64_tr_b16 v[154:155], v177 offset:3584
    s_nop 7
    v_sub_f32 v68, v68, v178
    v_sub_f32 v69, v69, v178
    v_sub_f32 v70, v70, v178
    v_sub_f32 v71, v71, v178
    v_sub_f32 v72, v72, v178
    v_sub_f32 v73, v73, v178
    v_sub_f32 v74, v74, v178
    v_sub_f32 v75, v75, v178
    v_sub_f32 v76, v76, v178
    v_sub_f32 v77, v77, v178
    v_sub_f32 v78, v78, v178
    v_sub_f32 v79, v79, v178
    v_sub_f32 v80, v80, v178
    v_sub_f32 v81, v81, v178
    v_sub_f32 v82, v82, v178
    v_sub_f32 v83, v83, v178
    v_exp_f32 v68, v68
    v_exp_f32 v69, v69
    v_exp_f32 v70, v70
    v_exp_f32 v71, v71
    v_exp_f32 v72, v72
    v_exp_f32 v73, v73
    v_exp_f32 v74, v74
    v_exp_f32 v75, v75
    v_exp_f32 v76, v76
    v_exp_f32 v77, v77
    v_exp_f32 v78, v78
    v_exp_f32 v79, v79
    v_exp_f32 v80, v80
    v_exp_f32 v81, v81
    v_exp_f32 v82, v82
    v_exp_f32 v83, v83
    v_cvt_pk_bf16_f32 v68, v68, v69
    v_cvt_pk_bf16_f32 v69, v70, v71
    v_cvt_pk_bf16_f32 v70, v72, v73
    v_cvt_pk_bf16_f32 v71, v74, v75
    v_cvt_pk_bf16_f32 v72, v76, v77
    v_cvt_pk_bf16_f32 v73, v78, v79
    v_cvt_pk_bf16_f32 v74, v80, v81
    v_cvt_pk_bf16_f32 v75, v82, v83
    s_waitcnt lgkmcnt(2)
    v_mfma_f32_32x32x16_bf16 v[116:131], v[148:151], v[68:71], v[116:131]
    s_waitcnt lgkmcnt(0)
    v_mfma_f32_32x32x16_bf16 v[116:131], v[152:155], v[72:75], v[116:131]
sl_10011:
    s_nop 11
    s_cmp_gt_u32 s60, 2
    s_cbranch_scc1 sl_10012
    ds_read_b128 v[100:103], v174 offset:2048
    ds_read_b64 v[104:105], v175 offset:512
    s_waitcnt lgkmcnt(1)
    v_mfma_f32_32x32x16_bf16 v[68:83], v[100:103], v[52:55], 0
    s_waitcnt lgkmcnt(0)
    v_mfma_f32_32x32x16_bf16 v[68:83], v[104:107], v[44:47], v[68:83]
    ds_read_b64_tr_b16 v[148:149], v176 offset:4096
    ds_read_b64_tr_b16 v[150:151], v177 offset:4608
    ds_read_b64_tr_b16 v[152:153], v176 offset:5120
    ds_read_b64_tr_b16 v[154:155], v177 offset:5632
    s_nop 7
    v_sub_f32 v68, v68, v178
    v_sub_f32 v69, v69, v178
    v_sub_f32 v70, v70, v178
    v_sub_f32 v71, v71, v178
    v_sub_f32 v72, v72, v178
    v_sub_f32 v73, v73, v178
    v_sub_f32 v74, v74, v178
    v_sub_f32 v75, v75, v178
    v_sub_f32 v76, v76, v178
    v_sub_f32 v77, v77, v178
    v_sub_f32 v78, v78, v178
    v_sub_f32 v79, v79, v178
    v_sub_f32 v80, v80, v178
    v_sub_f32 v81, v81, v178
    v_sub_f32 v82, v82, v178
    v_sub_f32 v83, v83, v178
    v_exp_f32 v68, v68
    v_exp_f32 v69, v69
    v_exp_f32 v70, v70
    v_exp_f32 v71, v71
    v_exp_f32 v72, v72
    v_exp_f32 v73, v73
    v_exp_f32 v74, v74
    v_exp_f32 v75, v75
    v_exp_f32 v76, v76
    v_exp_f32 v77, v77
    v_exp_f32 v78, v78
    v_exp_f32 v79, v79
    v_exp_f32 v80, v80
    v_exp_f32 v81, v81
    v_exp_f32 v82, v82
    v_exp_f32 v83, v83
    v_cvt_pk_bf16_f32 v68, v68, v69
    v_cvt_pk_bf16_f32 v69, v70, v71
    v_cvt_pk_bf16_f32 v70, v72, v73
    v_cvt_pk_bf16_f32 v71, v74, v75
    v_cvt_pk_bf16_f32 v72, v76, v77
    v_cvt_pk_bf16_f32 v73, v78, v79
    v_cvt_pk_bf16_f32 v74, v80, v81
    v_cvt_pk_bf16_f32 v75, v82, v83
    s_waitcnt lgkmcnt(2)
    v_mfma_f32_32x32x16_bf16 v[116:131], v[148:151], v[68:71], v[116:131]
    s_waitcnt lgkmcnt(0)
    v_mfma_f32_32x32x16_bf16 v[116:131], v[152:155], v[72:75], v[116:131]
sl_10012:
    s_nop 11
    s_cmp_gt_u32 s60, 3
    s_cbranch_scc1 sl_10013
    ds_read_b128 v[100:103], v174 offset:3072
    ds_read_b64 v[104:105], v175 offset:768
    s_waitcnt lgkmcnt(1)
    v_mfma_f32_32x32x16_bf16 v[68:83], v[100:103], v[52:55], 0
    s_waitcnt lgkmcnt(0)
    v_mfma_f32_32x32x16_bf16 v[68:83], v[104:107], v[44:47], v[68:83]
    ds_read_b64_tr_b16 v[148:149], v176 offset:6144
    ds_read_b64_tr_b16 v[150:151], v177 offset:6656
    ds_read_b64_tr_b16 v[152:153], v176 offset:7168
    ds_read_b64_tr_b16 v[154:155], v177 offset:7680
    s_nop 7
    v_sub_f32 v68, v68, v178
    v_sub_f32 v69, v69, v178
    v_sub_f32 v70, v70, v178
    v_sub_f32 v71, v71, v178
    v_sub_f32 v72, v72, v178
    v_sub_f32 v73, v73, v178
    v_sub_f32 v74, v74, v178
    v_sub_f32 v75, v75, v178
    v_sub_f32 v76, v76, v178
    v_sub_f32 v77, v77, v178
    v_sub_f32 v78, v78, v178
    v_sub_f32 v79, v79, v178
    v_sub_f32 v80, v80, v178
    v_sub_f32 v81, v81, v178
    v_sub_f32 v82, v82, v178
    v_sub_f32 v83, v83, v178
    v_exp_f32 v68, v68
    v_exp_f32 v69, v69
    v_exp_f32 v70, v70
    v_exp_f32 v71, v71
    v_exp_f32 v72, v72
    v_exp_f32 v73, v73
    v_exp_f32 v74, v74
    v_exp_f32 v75, v75
    v_exp_f32 v76, v76
    v_exp_f32 v77, v77
    v_exp_f32 v78, v78
    v_exp_f32 v79, v79
    v_exp_f32 v80, v80
    v_exp_f32 v81, v81
    v_exp_f32 v82, v82
    v_exp_f32 v83, v83
    v_cvt_pk_bf16_f32 v68, v68, v69
    v_cvt_pk_bf16_f32 v69, v70, v71
    v_cvt_pk_bf16_f32 v70, v72, v73
    v_cvt_pk_bf16_f32 v71, v74, v75
    v_cvt_pk_bf16_f32 v72, v76, v77
    v_cvt_pk_bf16_f32 v73, v78, v79
    v_cvt_pk_bf16_f32 v74, v80, v81
    v_cvt_pk_bf16_f32 v75, v82, v83
    s_waitcnt lgkmcnt(2)
    v_mfma_f32_32x32x16_bf16 v[116:131], v[148:151], v[68:71], v[116:131]
    s_waitcnt lgkmcnt(0)
    v_mfma_f32_32x32x16_bf16 v[116:131], v[152:155], v[72:75], v[116:131]
sl_10013:
    s_nop 11
    s_cmp_gt_u32 s60, 4
    s_cbranch_scc1 sl_10014
    ds_read_b128 v[100:103], v174 offset:4096
    ds_read_b64 v[104:105], v175 offset:1024
    s_waitcnt lgkmcnt(1)
    v_mfma_f32_32x32x16_bf16 v[68:83], v[100:103], v[52:55], 0
    s_waitcnt lgkmcnt(0)
    v_mfma_f32_32x32x16_bf16 v[68:83], v[104:107], v[44:47], v[68:83]
    ds_read_b64_tr_b16 v[148:149], v176 offset:8192
    ds_read_b64_tr_b16 v[150:151], v177 offset:8704
    ds_read_b64_tr_b16 v[152:153], v176 offset:9216
    ds_read_b64_tr_b16 v[154:155], v177 offset:9728
    s_nop 7
    v_sub_f32 v68, v68, v178
    v_sub_f32 v69, v69, v178
    v_sub_f32 v70, v70, v178
    v_sub_f32 v71, v71, v178
    v_sub_f32 v72, v72, v178
    v_sub_f32 v73, v73, v178
    v_sub_f32 v74, v74, v178
    v_sub_f32 v75, v75, v178
    v_sub_f32 v76, v76, v178
    v_sub_f32 v77, v77, v178
    v_sub_f32 v78, v78, v178
    v_sub_f32 v79, v79, v178
    v_sub_f32 v80, v80, v178
    v_sub_f32 v81, v81, v178
    v_sub_f32 v82, v82, v178
    v_sub_f32 v83, v83, v178
    v_exp_f32 v68, v68
    v_exp_f32 v69, v69
    v_exp_f32 v70, v70
    v_exp_f32 v71, v71
    v_exp_f32 v72, v72
    v_exp_f32 v73, v73
    v_exp_f32 v74, v74
    v_exp_f32 v75, v75
    v_exp_f32 v76, v76
    v_exp_f32 v77, v77
    v_exp_f32 v78, v78
    v_exp_f32 v79, v79
    v_exp_f32 v80, v80
    v_exp_f32 v81, v81
    v_exp_f32 v82, v82
    v_exp_f32 v83, v83
    v_cvt_pk_bf16_f32 v68, v68, v69
    v_cvt_pk_bf16_f32 v69, v70, v71
    v_cvt_pk_bf16_f32 v70, v72, v73
    v_cvt_pk_bf16_f32 v71, v74, v75
    v_cvt_pk_bf16_f32 v72, v76, v77
    v_cvt_pk_bf16_f32 v73, v78, v79
    v_cvt_pk_bf16_f32 v74, v80, v81
    v_cvt_pk_bf16_f32 v75, v82, v83
    s_waitcnt lgkmcnt(2)
    v_mfma_f32_32x32x16_bf16 v[116:131], v[148:151], v[68:71], v[116:131]
    s_waitcnt lgkmcnt(0)
    v_mfma_f32_32x32x16_bf16 v[116:131], v[152:155], v[72:75], v[116:131]
sl_10014:
    s_nop 11
    s_cmp_gt_u32 s60, 5
    s_cbranch_scc1 sl_10015
    ds_read_b128 v[100:103], v174 offset:5120
    ds_read_b64 v[104:105], v175 offset:1280
    s_waitcnt lgkmcnt(1)
    v_mfma_f32_32x32x16_bf16 v[68:83], v[100:103], v[52:55], 0
    s_waitcnt lgkmcnt(0)
    v_mfma_f32_32x32x16_bf16 v[68:83], v[104:107], v[44:47], v[68:83]
    ds_read_b64_tr_b16 v[148:149], v176 offset:10240
    ds_read_b64_tr_b16 v[150:151], v177 offset:10752
    ds_read_b64_tr_b16 v[152:153], v176 offset:11264
    ds_read_b64_tr_b16 v[154:155], v177 offset:11776
    s_nop 7
    v_sub_f32 v68, v68, v178
    v_sub_f32 v69, v69, v178
    v_sub_f32 v70, v70, v178
    v_sub_f32 v71, v71, v178
    v_sub_f32 v72, v72, v178
    v_sub_f32 v73, v73, v178
    v_sub_f32 v74, v74, v178
    v_sub_f32 v75, v75, v178
    v_sub_f32 v76, v76, v178
    v_sub_f32 v77, v77, v178
    v_sub_f32 v78, v78, v178
    v_sub_f32 v79, v79, v178
    v_sub_f32 v80, v80, v178
    v_sub_f32 v81, v81, v178
    v_sub_f32 v82, v82, v178
    v_sub_f32 v83, v83, v178
    v_exp_f32 v68, v68
    v_exp_f32 v69, v69
    v_exp_f32 v70, v70
    v_exp_f32 v71, v71
    v_exp_f32 v72, v72
    v_exp_f32 v73, v73
    v_exp_f32 v74, v74
    v_exp_f32 v75, v75
    v_exp_f32 v76, v76
    v_exp_f32 v77, v77
    v_exp_f32 v78, v78
    v_exp_f32 v79, v79
    v_exp_f32 v80, v80
    v_exp_f32 v81, v81
    v_exp_f32 v82, v82
    v_exp_f32 v83, v83
    v_cvt_pk_bf16_f32 v68, v68, v69
    v_cvt_pk_bf16_f32 v69, v70, v71
    v_cvt_pk_bf16_f32 v70, v72, v73
    v_cvt_pk_bf16_f32 v71, v74, v75
    v_cvt_pk_bf16_f32 v72, v76, v77
    v_cvt_pk_bf16_f32 v73, v78, v79
    v_cvt_pk_bf16_f32 v74, v80, v81
    v_cvt_pk_bf16_f32 v75, v82, v83
    s_waitcnt lgkmcnt(2)
    v_mfma_f32_32x32x16_bf16 v[116:131], v[148:151], v[68:71], v[116:131]
    s_waitcnt lgkmcnt(0)
    v_mfma_f32_32x32x16_bf16 v[116:131], v[152:155], v[72:75], v[116:131]
sl_10015:
    s_nop 11
    s_cmp_gt_u32 s60, 6
    s_cbranch_scc1 sl_10016
    ds_read_b128 v[100:103], v174 offset:6144
    ds_read_b64 v[104:105], v175 offset:1536
    s_waitcnt lgkmcnt(1)
    v_mfma_f32_32x32x16_bf16 v[68:83], v[100:103], v[52:55], 0
    s_waitcnt lgkmcnt(0)
    v_mfma_f32_32x32x16_bf16 v[68:83], v[104:107], v[44:47], v[68:83]
    ds_read_b64_tr_b16 v[148:149], v176 offset:12288
    ds_read_b64_tr_b16 v[150:151], v177 offset:12800
    ds_read_b64_tr_b16 v[152:153], v176 offset:13312
    ds_read_b64_tr_b16 v[154:155], v177 offset:13824
    s_nop 7
    v_sub_f32 v68, v68, v178
    v_sub_f32 v69, v69, v178
    v_sub_f32 v70, v70, v178
    v_sub_f32 v71, v71, v178
    v_sub_f32 v72, v72, v178
    v_sub_f32 v73, v73, v178
    v_sub_f32 v74, v74, v178
    v_sub_f32 v75, v75, v178
    v_sub_f32 v76, v76, v178
    v_sub_f32 v77, v77, v178
    v_sub_f32 v78, v78, v178
    v_sub_f32 v79, v79, v178
    v_sub_f32 v80, v80, v178
    v_sub_f32 v81, v81, v178
    v_sub_f32 v82, v82, v178
    v_sub_f32 v83, v83, v178
    v_exp_f32 v68, v68
    v_exp_f32 v69, v69
    v_exp_f32 v70, v70
    v_exp_f32 v71, v71
    v_exp_f32 v72, v72
    v_exp_f32 v73, v73
    v_exp_f32 v74, v74
    v_exp_f32 v75, v75
    v_exp_f32 v76, v76
    v_exp_f32 v77, v77
    v_exp_f32 v78, v78
    v_exp_f32 v79, v79
    v_exp_f32 v80, v80
    v_exp_f32 v81, v81
    v_exp_f32 v82, v82
    v_exp_f32 v83, v83
    v_cvt_pk_bf16_f32 v68, v68, v69
    v_cvt_pk_bf16_f32 v69, v70, v71
    v_cvt_pk_bf16_f32 v70, v72, v73
    v_cvt_pk_bf16_f32 v71, v74, v75
    v_cvt_pk_bf16_f32 v72, v76, v77
    v_cvt_pk_bf16_f32 v73, v78, v79
    v_cvt_pk_bf16_f32 v74, v80, v81
    v_cvt_pk_bf16_f32 v75, v82, v83
    s_waitcnt lgkmcnt(2)
    v_mfma_f32_32x32x16_bf16 v[116:131], v[148:151], v[68:71], v[116:131]
    s_waitcnt lgkmcnt(0)
    v_mfma_f32_32x32x16_bf16 v[116:131], v[152:155], v[72:75], v[116:131]
sl_10016:
    s_nop 11
    s_cmp_gt_u32 s60, 7
    s_cbranch_scc1 sl_10017
    ds_read_b128 v[100:103], v174 offset:7168
    ds_read_b64 v[104:105], v175 offset:1792
    s_waitcnt lgkmcnt(1)
    v_mfma_f32_32x32x16_bf16 v[68:83], v[100:103], v[52:55], 0
    s_waitcnt lgkmcnt(0)
    v_mfma_f32_32x32x16_bf16 v[68:83], v[104:107], v[44:47], v[68:83]
    ds_read_b64_tr_b16 v[148:149], v176 offset:14336
    ds_read_b64_tr_b16 v[150:151], v177 offset:14848
    ds_read_b64_tr_b16 v[152:153], v176 offset:15360
    ds_read_b64_tr_b16 v[154:155], v177 offset:15872
    s_nop 7
    v_sub_f32 v68, v68, v178
    v_sub_f32 v69, v69, v178
    v_sub_f32 v70, v70, v178
    v_sub_f32 v71, v71, v178
    v_sub_f32 v72, v72, v178
    v_sub_f32 v73, v73, v178
    v_sub_f32 v74, v74, v178
    v_sub_f32 v75, v75, v178
    v_sub_f32 v76, v76, v178
    v_sub_f32 v77, v77, v178
    v_sub_f32 v78, v78, v178
    v_sub_f32 v79, v79, v178
    v_sub_f32 v80, v80, v178
    v_sub_f32 v81, v81, v178
    v_sub_f32 v82, v82, v178
    v_sub_f32 v83, v83, v178
    v_exp_f32 v68, v68
    v_exp_f32 v69, v69
    v_exp_f32 v70, v70
    v_exp_f32 v71, v71
    v_exp_f32 v72, v72
    v_exp_f32 v73, v73
    v_exp_f32 v74, v74
    v_exp_f32 v75, v75
    v_exp_f32 v76, v76
    v_exp_f32 v77, v77
    v_exp_f32 v78, v78
    v_exp_f32 v79, v79
    v_exp_f32 v80, v80
    v_exp_f32 v81, v81
    v_exp_f32 v82, v82
    v_exp_f32 v83, v83
    v_cvt_pk_bf16_f32 v68, v68, v69
    v_cvt_pk_bf16_f32 v69, v70, v71
    v_cvt_pk_bf16_f32 v70, v72, v73
    v_cvt_pk_bf16_f32 v71, v74, v75
    v_cvt_pk_bf16_f32 v72, v76, v77
    v_cvt_pk_bf16_f32 v73, v78, v79
    v_cvt_pk_bf16_f32 v74, v80, v81
    v_cvt_pk_bf16_f32 v75, v82, v83
    s_waitcnt lgkmcnt(2)
    v_mfma_f32_32x32x16_bf16 v[116:131], v[148:151], v[68:71], v[116:131]
    s_waitcnt lgkmcnt(0)
    v_mfma_f32_32x32x16_bf16 v[116:131], v[152:155], v[72:75], v[116:131]
sl_10017:
    s_nop 11
    s_cmp_gt_u32 s60, 8
    s_cbranch_scc1 sl_10018
    ds_read_b128 v[100:103], v174 offset:8192
    ds_read_b64 v[104:105], v175 offset:2048
    s_waitcnt lgkmcnt(1)
    v_mfma_f32_32x32x16_bf16 v[68:83], v[100:103], v[52:55], v[180:195]
    s_waitcnt lgkmcnt(0)
    v_mfma_f32_32x32x16_bf16 v[68:83], v[104:107], v[44:47], v[68:83]
    ds_read_b64_tr_b16 v[148:149], v176 offset:16384
    ds_read_b64_tr_b16 v[150:151], v177 offset:16896
    ds_read_b64_tr_b16 v[152:153], v176 offset:17408
    ds_read_b64_tr_b16 v[154:155], v177 offset:17920
    s_nop 7
    v_sub_f32 v68, v68, v178
    v_sub_f32 v69, v69, v178
    v_sub_f32 v70, v70, v178
    v_sub_f32 v71, v71, v178
    v_sub_f32 v72, v72, v178
    v_sub_f32 v73, v73, v178
    v_sub_f32 v74, v74, v178
    v_sub_f32 v75, v75, v178
    v_sub_f32 v76, v76, v178
    v_sub_f32 v77, v77, v178
    v_sub_f32 v78, v78, v178
    v_sub_f32 v79, v79, v178
    v_sub_f32 v80, v80, v178
    v_sub_f32 v81, v81, v178
    v_sub_f32 v82, v82, v178
    v_sub_f32 v83, v83, v178
    v_exp_f32 v68, v68
    v_exp_f32 v69, v69
    v_exp_f32 v70, v70
    v_exp_f32 v71, v71
    v_exp_f32 v72, v72
    v_exp_f32 v73, v73
    v_exp_f32 v74, v74
    v_exp_f32 v75, v75
    v_exp_f32 v76, v76
    v_exp_f32 v77, v77
    v_exp_f32 v78, v78
    v_exp_f32 v79, v79
    v_exp_f32 v80, v80
    v_exp_f32 v81, v81
    v_exp_f32 v82, v82
    v_exp_f32 v83, v83
    v_cvt_pk_bf16_f32 v68, v68, v69
    v_cvt_pk_bf16_f32 v69, v70, v71
    v_cvt_pk_bf16_f32 v70, v72, v73
    v_cvt_pk_bf16_f32 v71, v74, v75
    v_cvt_pk_bf16_f32 v72, v76, v77
    v_cvt_pk_bf16_f32 v73, v78, v79
    v_cvt_pk_bf16_f32 v74, v80, v81
    v_cvt_pk_bf16_f32 v75, v82, v83
    s_waitcnt lgkmcnt(2)
    v_mfma_f32_32x32x16_bf16 v[116:131], v[148:151], v[68:71], v[116:131]
    s_waitcnt lgkmcnt(0)
    v_mfma_f32_32x32x16_bf16 v[116:131], v[152:155], v[72:75], v[116:131]
sl_10018:
    s_nop 11
    v_mov_b32 v164, v124
    v_mov_b32 v165, v124
    s_nop 1
    v_permlane32_swap_b32 v164, v165
    s_nop 2
    s_branch normA
slowB:
    s_nop 15
    s_waitcnt vmcnt(0) lgkmcnt(0)
    s_and_b32 s59, s19, 7
    s_lshl_b32 s58, s59, 10
    v_add_u32 v174, s58, v236
    s_lshl_b32 s58, s59, 8
    v_add_u32 v175, s58, v237
    s_lshl_b32 s58, s59, 11
    v_add_u32 v176, s58, v242
    v_add_u32 v177, s58, v243
    v_mov_b32 v50, 0
    s_sub_u32 s60, 8, s59
    s_cmp_eq_u32 s16, 0
    s_cselect_b32 s60, s60, 0
    v_mov_b32 v178, 0xff800000
    v_mov_b32 v132, 0
    v_mov_b32 v133, 0
    v_mov_b32 v134, 0
    v_mov_b32 v135, 0
    v_mov_b32 v136, 0
    v_mov_b32 v137, 0
    v_mov_b32 v138, 0
    v_mov_b32 v139, 0
    v_mov_b32 v140, 0
    v_mov_b32 v141, 0
    v_mov_b32 v142, 0
    v_mov_b32 v143, 0
    v_mov_b32 v144, 0
    v_mov_b32 v145, 0
    v_mov_b32 v146, 0
    v_mov_b32 v147, 0
    s_cmp_gt_u32 s60, 0
    s_cbranch_scc1 sl_10019
    ds_read_b128 v[100:103], v174 offset:0
    ds_read_b64 v[104:105], v175 offset:0
    s_waitcnt lgkmcnt(1)
    v_mfma_f32_32x32x16_bf16 v[68:83], v[100:103], v[28:31], v[196:211]
    s_waitcnt lgkmcnt(0)
    v_mfma_f32_32x32x16_bf16 v[68:83], v[104:107], v[48:51], v[68:83]
    s_nop 11
    v_max3_f32 v178, v178, v68, v69
    v_max3_f32 v178, v178, v70, v71
    v_max3_f32 v178, v178, v72, v73
    v_max3_f32 v178, v178, v74, v75
    v_max3_f32 v178, v178, v76, v77
    v_max3_f32 v178, v178, v78, v79
    v_max3_f32 v178, v178, v80, v81
    v_max3_f32 v178, v178, v82, v83
sl_10019:
    s_nop 2
    s_cmp_gt_u32 s60, 1
    s_cbranch_scc1 sl_10020
    ds_read_b128 v[100:103], v174 offset:1024
    ds_read_b64 v[104:105], v175 offset:256
    s_waitcnt lgkmcnt(1)
    v_mfma_f32_32x32x16_bf16 v[68:83], v[100:103], v[28:31], 0
    s_waitcnt lgkmcnt(0)
    v_mfma_f32_32x32x16_bf16 v[68:83], v[104:107], v[48:51], v[68:83]
    s_nop 11
    v_max3_f32 v178, v178, v68, v69
    v_max3_f32 v178, v178, v70, v71
    v_max3_f32 v178, v178, v72, v73
    v_max3_f32 v178, v178, v74, v75
    v_max3_f32 v178, v178, v76, v77
    v_max3_f32 v178, v178, v78, v79
    v_max3_f32 v178, v178, v80, v81
    v_max3_f32 v178, v178, v82, v83
sl_10020:
    s_nop 2
    s_cmp_gt_u32 s60, 2
    s_cbranch_scc1 sl_10021
    ds_read_b128 v[100:103], v174 offset:2048
    ds_read_b64 v[104:105], v175 offset:512
    s_waitcnt lgkmcnt(1)
    v_mfma_f32_32x32x16_bf16 v[68:83], v[100:103], v[28:31], 0
    s_waitcnt lgkmcnt(0)
    v_mfma_f32_32x32x16_bf16 v[68:83], v[104:107], v[48:51], v[68:83]
    s_nop 11
    v_max3_f32 v178, v178, v68, v69
    v_max3_f32 v178, v178, v70, v71
    v_max3_f32 v178, v178, v72, v73
    v_max3_f32 v178, v178, v74, v75
    v_max3_f32 v178, v178, v76, v77
    v_max3_f32 v178, v178, v78, v79
    v_max3_f32 v178, v178, v80, v81
    v_max3_f32 v178, v178, v82, v83
sl_10021:
    s_nop 2
    s_cmp_gt_u32 s60, 3
    s_cbranch_scc1 sl_10022
    ds_read_b128 v[100:103], v174 offset:3072
    ds_read_b64 v[104:105], v175 offset:768
    s_waitcnt lgkmcnt(1)
    v_mfma_f32_32x32x16_bf16 v[68:83], v[100:103], v[28:31], 0
    s_waitcnt lgkmcnt(0)
    v_mfma_f32_32x32x16_bf16 v[68:83], v[104:107], v[48:51], v[68:83]
    s_nop 11
    v_max3_f32 v178, v178, v68, v69
    v_max3_f32 v178, v178, v70, v71
    v_max3_f32 v178, v178, v72, v73
    v_max3_f32 v178, v178, v74, v75
    v_max3_f32 v178, v178, v76, v77
    v_max3_f32 v178, v178, v78, v79
    v_max3_f32 v178, v178, v80, v81
    v_max3_f32 v178, v178, v82, v83
sl_10022:
    s_nop 2
    s_cmp_gt_u32 s60, 4
    s_cbranch_scc1 sl_10023
    ds_read_b128 v[100:103], v174 offset:4096
    ds_read_b64 v[104:105], v175 offset:1024
    s_waitcnt lgkmcnt(1)
    v_mfma_f32_32x32x16_bf16 v[68:83], v[100:103], v[28:31], 0
    s_waitcnt lgkmcnt(0)
    v_mfma_f32_32x32x16_bf16 v[68:83], v[104:107], v[48:51], v[68:83]
    s_nop 11
    v_max3_f32 v178, v178, v68, v69
    v_max3_f32 v178, v178, v70, v71
    v_max3_f32 v178, v178, v72, v73
    v_max3_f32 v178, v178, v74, v75
    v_max3_f32 v178, v178, v76, v77
    v_max3_f32 v178, v178, v78, v79
    v_max3_f32 v178, v178, v80, v81
    v_max3_f32 v178, v178, v82, v83
sl_10023:
    s_nop 2
    s_cmp_gt_u32 s60, 5
    s_cbranch_scc1 sl_10024
    ds_read_b128 v[100:103], v174 offset:5120
    ds_read_b64 v[104:105], v175 offset:1280
    s_waitcnt lgkmcnt(1)
    v_mfma_f32_32x32x16_bf16 v[68:83], v[100:103], v[28:31], 0
    s_waitcnt lgkmcnt(0)
    v_mfma_f32_32x32x16_bf16 v[68:83], v[104:107], v[48:51], v[68:83]
    s_nop 11
    v_max3_f32 v178, v178, v68, v69
    v_max3_f32 v178, v178, v70, v71
    v_max3_f32 v178, v178, v72, v73
    v_max3_f32 v178, v178, v74, v75
    v_max3_f32 v178, v178, v76, v77
    v_max3_f32 v178, v178, v78, v79
    v_max3_f32 v178, v178, v80, v81
    v_max3_f32 v178, v178, v82, v83
sl_10024:
    s_nop 2
    s_cmp_gt_u32 s60, 6
    s_cbranch_scc1 sl_10025
    ds_read_b128 v[100:103], v174 offset:6144
    ds_read_b64 v[104:105], v175 offset:1536
    s_waitcnt lgkmcnt(1)
    v_mfma_f32_32x32x16_bf16 v[68:83], v[100:103], v[28:31], 0
    s_waitcnt lgkmcnt(0)
    v_mfma_f32_32x32x16_bf16 v[68:83], v[104:107], v[48:51], v[68:83]
    s_nop 11
    v_max3_f32 v178, v178, v68, v69
    v_max3_f32 v178, v178, v70, v71
    v_max3_f32 v178, v178, v72, v73
    v_max3_f32 v178, v178, v74, v75
    v_max3_f32 v178, v178, v76, v77
    v_max3_f32 v178, v178, v78, v79
    v_max3_f32 v178, v178, v80, v81
    v_max3_f32 v178, v178, v82, v83
sl_10025:
    s_nop 2
    s_cmp_gt_u32 s60, 7
    s_cbranch_scc1 sl_10026
    ds_read_b128 v[100:103], v174 offset:7168
    ds_read_b64 v[104:105], v175 offset:1792
    s_waitcnt lgkmcnt(1)
    v_mfma_f32_32x32x16_bf16 v[68:83], v[100:103], v[28:31], 0
    s_waitcnt lgkmcnt(0)
    v_mfma_f32_32x32x16_bf16 v[68:83], v[104:107], v[48:51], v[68:83]
    s_nop 11
    v_max3_f32 v178, v178, v68, v69
    v_max3_f32 v178, v178, v70, v71
    v_max3_f32 v178, v178, v72, v73
    v_max3_f32 v178, v178, v74, v75
    v_max3_f32 v178, v178, v76, v77
    v_max3_f32 v178, v178, v78, v79
    v_max3_f32 v178, v178, v80, v81
    v_max3_f32 v178, v178, v82, v83
sl_10026:
    s_nop 2
    s_cmp_gt_u32 s60, 8
    s_cbranch_scc1 sl_10027
    ds_read_b128 v[100:103], v174 offset:8192
    ds_read_b64 v[104:105], v175 offset:2048
    s_waitcnt lgkmcnt(1)
    v_mfma_f32_32x32x16_bf16 v[68:83], v[100:103], v[28:31], v[180:195]
    s_waitcnt lgkmcnt(0)
    v_mfma_f32_32x32x16_bf16 v[68:83], v[104:107], v[48:51], v[68:83]
    s_nop 11
    v_max3_f32 v178, v178, v68, v69
    v_max3_f32 v178, v178, v70, v71
    v_max3_f32 v178, v178, v72, v73
    v_max3_f32 v178, v178, v74, v75
    v_max3_f32 v178, v178, v76, v77
    v_max3_f32 v178, v178, v78, v79
    v_max3_f32 v178, v178, v80, v81
    v_max3_f32 v178, v178, v82, v83
sl_10027:
    s_nop 2
    v_mov_b32 v179, v178
    s_nop 1
    v_permlane32_swap_b32 v178, v179
    v_max_f32 v178, v178, v179
    s_cmp_gt_u32 s60, 0
    s_cbranch_scc1 sl_10028
    ds_read_b128 v[100:103], v174 offset:0
    ds_read_b64 v[104:105], v175 offset:0
    s_waitcnt lgkmcnt(1)
    v_mfma_f32_32x32x16_bf16 v[68:83], v[100:103], v[28:31], v[196:211]
    s_waitcnt lgkmcnt(0)
    v_mfma_f32_32x32x16_bf16 v[68:83], v[104:107], v[48:51], v[68:83]
    ds_read_b64_tr_b16 v[148:149], v176 offset:0
    ds_read_b64_tr_b16 v[150:151], v177 offset:512
    ds_read_b64_tr_b16 v[152:153], v176 offset:1024
    ds_read_b64_tr_b16 v[154:155], v177 offset:1536
    s_nop 7
    v_sub_f32 v68, v68, v178
    v_sub_f32 v69, v69, v178
    v_sub_f32 v70, v70, v178
    v_sub_f32 v71, v71, v178
    v_sub_f32 v72, v72, v178
    v_sub_f32 v73, v73, v178
    v_sub_f32 v74, v74, v178
    v_sub_f32 v75, v75, v178
    v_sub_f32 v76, v76, v178
    v_sub_f32 v77, v77, v178
    v_sub_f32 v78, v78, v178
    v_sub_f32 v79, v79, v178
    v_sub_f32 v80, v80, v178
    v_sub_f32 v81, v81, v178
    v_sub_f32 v82, v82, v178
    v_sub_f32 v83, v83, v178
    v_exp_f32 v68, v68
    v_exp_f32 v69, v69
    v_exp_f32 v70, v70
    v_exp_f32 v71, v71
    v_exp_f32 v72, v72
    v_exp_f32 v73, v73
    v_exp_f32 v74, v74
    v_exp_f32 v75, v75
    v_exp_f32 v76, v76
    v_exp_f32 v77, v77
    v_exp_f32 v78, v78
    v_exp_f32 v79, v79
    v_exp_f32 v80, v80
    v_exp_f32 v81, v81
    v_exp_f32 v82, v82
    v_exp_f32 v83, v83
    v_cvt_pk_bf16_f32 v68, v68, v69
    v_cvt_pk_bf16_f32 v69, v70, v71
    v_cvt_pk_bf16_f32 v70, v72, v73
    v_cvt_pk_bf16_f32 v71, v74, v75
    v_cvt_pk_bf16_f32 v72, v76, v77
    v_cvt_pk_bf16_f32 v73, v78, v79
    v_cvt_pk_bf16_f32 v74, v80, v81
    v_cvt_pk_bf16_f32 v75, v82, v83
    s_waitcnt lgkmcnt(2)
    v_mfma_f32_32x32x16_bf16 v[132:147], v[148:151], v[68:71], v[132:147]
    s_waitcnt lgkmcnt(0)
    v_mfma_f32_32x32x16_bf16 v[132:147], v[152:155], v[72:75], v[132:147]
sl_10028:
    s_nop 11
    s_cmp_gt_u32 s60, 1
    s_cbranch_scc1 sl_10029
    ds_read_b128 v[100:103], v174 offset:1024
    ds_read_b64 v[104:105], v175 offset:256
    s_waitcnt lgkmcnt(1)
    v_mfma_f32_32x32x16_bf16 v[68:83], v[100:103], v[28:31], 0
    s_waitcnt lgkmcnt(0)
    v_mfma_f32_32x32x16_bf16 v[68:83], v[104:107], v[48:51], v[68:83]
    ds_read_b64_tr_b16 v[148:149], v176 offset:2048
    ds_read_b64_tr_b16 v[150:151], v177 offset:2560
    ds_read_b64_tr_b16 v[152:153], v176 offset:3072
    ds_read_b64_tr_b16 v[154:155], v177 offset:3584
    s_nop 7
    v_sub_f32 v68, v68, v178
    v_sub_f32 v69, v69, v178
    v_sub_f32 v70, v70, v178
    v_sub_f32 v71, v71, v178
    v_sub_f32 v72, v72, v178
    v_sub_f32 v73, v73, v178
    v_sub_f32 v74, v74, v178
    v_sub_f32 v75, v75, v178
    v_sub_f32 v76, v76, v178
    v_sub_f32 v77, v77, v178
    v_sub_f32 v78, v78, v178
    v_sub_f32 v79, v79, v178
    v_sub_f32 v80, v80, v178
    v_sub_f32 v81, v81, v178
    v_sub_f32 v82, v82, v178
    v_sub_f32 v83, v83, v178
    v_exp_f32 v68, v68
    v_exp_f32 v69, v69
    v_exp_f32 v70, v70
    v_exp_f32 v71, v71
    v_exp_f32 v72, v72
    v_exp_f32 v73, v73
    v_exp_f32 v74, v74
    v_exp_f32 v75, v75
    v_exp_f32 v76, v76
    v_exp_f32 v77, v77
    v_exp_f32 v78, v78
    v_exp_f32 v79, v79
    v_exp_f32 v80, v80
    v_exp_f32 v81, v81
    v_exp_f32 v82, v82
    v_exp_f32 v83, v83
    v_cvt_pk_bf16_f32 v68, v68, v69
    v_cvt_pk_bf16_f32 v69, v70, v71
    v_cvt_pk_bf16_f32 v70, v72, v73
    v_cvt_pk_bf16_f32 v71, v74, v75
    v_cvt_pk_bf16_f32 v72, v76, v77
    v_cvt_pk_bf16_f32 v73, v78, v79
    v_cvt_pk_bf16_f32 v74, v80, v81
    v_cvt_pk_bf16_f32 v75, v82, v83
    s_waitcnt lgkmcnt(2)
    v_mfma_f32_32x32x16_bf16 v[132:147], v[148:151], v[68:71], v[132:147]
    s_waitcnt lgkmcnt(0)
    v_mfma_f32_32x32x16_bf16 v[132:147], v[152:155], v[72:75], v[132:147]
sl_10029:
    s_nop 11
    s_cmp_gt_u32 s60, 2
    s_cbranch_scc1 sl_10030
    ds_read_b128 v[100:103], v174 offset:2048
    ds_read_b64 v[104:105], v175 offset:512
    s_waitcnt lgkmcnt(1)
    v_mfma_f32_32x32x16_bf16 v[68:83], v[100:103], v[28:31], 0
    s_waitcnt lgkmcnt(0)
    v_mfma_f32_32x32x16_bf16 v[68:83], v[104:107], v[48:51], v[68:83]
    ds_read_b64_tr_b16 v[148:149], v176 offset:4096
    ds_read_b64_tr_b16 v[150:151], v177 offset:4608
    ds_read_b64_tr_b16 v[152:153], v176 offset:5120
    ds_read_b64_tr_b16 v[154:155], v177 offset:5632
    s_nop 7
    v_sub_f32 v68, v68, v178
    v_sub_f32 v69, v69, v178
    v_sub_f32 v70, v70, v178
    v_sub_f32 v71, v71, v178
    v_sub_f32 v72, v72, v178
    v_sub_f32 v73, v73, v178
    v_sub_f32 v74, v74, v178
    v_sub_f32 v75, v75, v178
    v_sub_f32 v76, v76, v178
    v_sub_f32 v77, v77, v178
    v_sub_f32 v78, v78, v178
    v_sub_f32 v79, v79, v178
    v_sub_f32 v80, v80, v178
    v_sub_f32 v81, v81, v178
    v_sub_f32 v82, v82, v178
    v_sub_f32 v83, v83, v178
    v_exp_f32 v68, v68
    v_exp_f32 v69, v69
    v_exp_f32 v70, v70
    v_exp_f32 v71, v71
    v_exp_f32 v72, v72
    v_exp_f32 v73, v73
    v_exp_f32 v74, v74
    v_exp_f32 v75, v75
    v_exp_f32 v76, v76
    v_exp_f32 v77, v77
    v_exp_f32 v78, v78
    v_exp_f32 v79, v79
    v_exp_f32 v80, v80
    v_exp_f32 v81, v81
    v_exp_f32 v82, v82
    v_exp_f32 v83, v83
    v_cvt_pk_bf16_f32 v68, v68, v69
    v_cvt_pk_bf16_f32 v69, v70, v71
    v_cvt_pk_bf16_f32 v70, v72, v73
    v_cvt_pk_bf16_f32 v71, v74, v75
    v_cvt_pk_bf16_f32 v72, v76, v77
    v_cvt_pk_bf16_f32 v73, v78, v79
    v_cvt_pk_bf16_f32 v74, v80, v81
    v_cvt_pk_bf16_f32 v75, v82, v83
    s_waitcnt lgkmcnt(2)
    v_mfma_f32_32x32x16_bf16 v[132:147], v[148:151], v[68:71], v[132:147]
    s_waitcnt lgkmcnt(0)
    v_mfma_f32_32x32x16_bf16 v[132:147], v[152:155], v[72:75], v[132:147]
sl_10030:
    s_nop 11
    s_cmp_gt_u32 s60, 3
    s_cbranch_scc1 sl_10031
    ds_read_b128 v[100:103], v174 offset:3072
    ds_read_b64 v[104:105], v175 offset:768
    s_waitcnt lgkmcnt(1)
    v_mfma_f32_32x32x16_bf16 v[68:83], v[100:103], v[28:31], 0
    s_waitcnt lgkmcnt(0)
    v_mfma_f32_32x32x16_bf16 v[68:83], v[104:107], v[48:51], v[68:83]
    ds_read_b64_tr_b16 v[148:149], v176 offset:6144
    ds_read_b64_tr_b16 v[150:151], v177 offset:6656
    ds_read_b64_tr_b16 v[152:153], v176 offset:7168
    ds_read_b64_tr_b16 v[154:155], v177 offset:7680
    s_nop 7
    v_sub_f32 v68, v68, v178
    v_sub_f32 v69, v69, v178
    v_sub_f32 v70, v70, v178
    v_sub_f32 v71, v71, v178
    v_sub_f32 v72, v72, v178
    v_sub_f32 v73, v73, v178
    v_sub_f32 v74, v74, v178
    v_sub_f32 v75, v75, v178
    v_sub_f32 v76, v76, v178
    v_sub_f32 v77, v77, v178
    v_sub_f32 v78, v78, v178
    v_sub_f32 v79, v79, v178
    v_sub_f32 v80, v80, v178
    v_sub_f32 v81, v81, v178
    v_sub_f32 v82, v82, v178
    v_sub_f32 v83, v83, v178
    v_exp_f32 v68, v68
    v_exp_f32 v69, v69
    v_exp_f32 v70, v70
    v_exp_f32 v71, v71
    v_exp_f32 v72, v72
    v_exp_f32 v73, v73
    v_exp_f32 v74, v74
    v_exp_f32 v75, v75
    v_exp_f32 v76, v76
    v_exp_f32 v77, v77
    v_exp_f32 v78, v78
    v_exp_f32 v79, v79
    v_exp_f32 v80, v80
    v_exp_f32 v81, v81
    v_exp_f32 v82, v82
    v_exp_f32 v83, v83
    v_cvt_pk_bf16_f32 v68, v68, v69
    v_cvt_pk_bf16_f32 v69, v70, v71
    v_cvt_pk_bf16_f32 v70, v72, v73
    v_cvt_pk_bf16_f32 v71, v74, v75
    v_cvt_pk_bf16_f32 v72, v76, v77
    v_cvt_pk_bf16_f32 v73, v78, v79
    v_cvt_pk_bf16_f32 v74, v80, v81
    v_cvt_pk_bf16_f32 v75, v82, v83
    s_waitcnt lgkmcnt(2)
    v_mfma_f32_32x32x16_bf16 v[132:147], v[148:151], v[68:71], v[132:147]
    s_waitcnt lgkmcnt(0)
    v_mfma_f32_32x32x16_bf16 v[132:147], v[152:155], v[72:75], v[132:147]
sl_10031:
    s_nop 11
    s_cmp_gt_u32 s60, 4
    s_cbranch_scc1 sl_10032
    ds_read_b128 v[100:103], v174 offset:4096
    ds_read_b64 v[104:105], v175 offset:1024
    s_waitcnt lgkmcnt(1)
    v_mfma_f32_32x32x16_bf16 v[68:83], v[100:103], v[28:31], 0
    s_waitcnt lgkmcnt(0)
    v_mfma_f32_32x32x16_bf16 v[68:83], v[104:107], v[48:51], v[68:83]
    ds_read_b64_tr_b16 v[148:149], v176 offset:8192
    ds_read_b64_tr_b16 v[150:151], v177 offset:8704
    ds_read_b64_tr_b16 v[152:153], v176 offset:9216
    ds_read_b64_tr_b16 v[154:155], v177 offset:9728
    s_nop 7
    v_sub_f32 v68, v68, v178
    v_sub_f32 v69, v69, v178
    v_sub_f32 v70, v70, v178
    v_sub_f32 v71, v71, v178
    v_sub_f32 v72, v72, v178
    v_sub_f32 v73, v73, v178
    v_sub_f32 v74, v74, v178
    v_sub_f32 v75, v75, v178
    v_sub_f32 v76, v76, v178
    v_sub_f32 v77, v77, v178
    v_sub_f32 v78, v78, v178
    v_sub_f32 v79, v79, v178
    v_sub_f32 v80, v80, v178
    v_sub_f32 v81, v81, v178
    v_sub_f32 v82, v82, v178
    v_sub_f32 v83, v83, v178
    v_exp_f32 v68, v68
    v_exp_f32 v69, v69
    v_exp_f32 v70, v70
    v_exp_f32 v71, v71
    v_exp_f32 v72, v72
    v_exp_f32 v73, v73
    v_exp_f32 v74, v74
    v_exp_f32 v75, v75
    v_exp_f32 v76, v76
    v_exp_f32 v77, v77
    v_exp_f32 v78, v78
    v_exp_f32 v79, v79
    v_exp_f32 v80, v80
    v_exp_f32 v81, v81
    v_exp_f32 v82, v82
    v_exp_f32 v83, v83
    v_cvt_pk_bf16_f32 v68, v68, v69
    v_cvt_pk_bf16_f32 v69, v70, v71
    v_cvt_pk_bf16_f32 v70, v72, v73
    v_cvt_pk_bf16_f32 v71, v74, v75
    v_cvt_pk_bf16_f32 v72, v76, v77
    v_cvt_pk_bf16_f32 v73, v78, v79
    v_cvt_pk_bf16_f32 v74, v80, v81
    v_cvt_pk_bf16_f32 v75, v82, v83
    s_waitcnt lgkmcnt(2)
    v_mfma_f32_32x32x16_bf16 v[132:147], v[148:151], v[68:71], v[132:147]
    s_waitcnt lgkmcnt(0)
    v_mfma_f32_32x32x16_bf16 v[132:147], v[152:155], v[72:75], v[132:147]
sl_10032:
    s_nop 11
    s_cmp_gt_u32 s60, 5
    s_cbranch_scc1 sl_10033
    ds_read_b128 v[100:103], v174 offset:5120
    ds_read_b64 v[104:105], v175 offset:1280
    s_waitcnt lgkmcnt(1)
    v_mfma_f32_32x32x16_bf16 v[68:83], v[100:103], v[28:31], 0
    s_waitcnt lgkmcnt(0)
    v_mfma_f32_32x32x16_bf16 v[68:83], v[104:107], v[48:51], v[68:83]
    ds_read_b64_tr_b16 v[148:149], v176 offset:10240
    ds_read_b64_tr_b16 v[150:151], v177 offset:10752
    ds_read_b64_tr_b16 v[152:153], v176 offset:11264
    ds_read_b64_tr_b16 v[154:155], v177 offset:11776
    s_nop 7
    v_sub_f32 v68, v68, v178
    v_sub_f32 v69, v69, v178
    v_sub_f32 v70, v70, v178
    v_sub_f32 v71, v71, v178
    v_sub_f32 v72, v72, v178
    v_sub_f32 v73, v73, v178
    v_sub_f32 v74, v74, v178
    v_sub_f32 v75, v75, v178
    v_sub_f32 v76, v76, v178
    v_sub_f32 v77, v77, v178
    v_sub_f32 v78, v78, v178
    v_sub_f32 v79, v79, v178
    v_sub_f32 v80, v80, v178
    v_sub_f32 v81, v81, v178
    v_sub_f32 v82, v82, v178
    v_sub_f32 v83, v83, v178
    v_exp_f32 v68, v68
    v_exp_f32 v69, v69
    v_exp_f32 v70, v70
    v_exp_f32 v71, v71
    v_exp_f32 v72, v72
    v_exp_f32 v73, v73
    v_exp_f32 v74, v74
    v_exp_f32 v75, v75
    v_exp_f32 v76, v76
    v_exp_f32 v77, v77
    v_exp_f32 v78, v78
    v_exp_f32 v79, v79
    v_exp_f32 v80, v80
    v_exp_f32 v81, v81
    v_exp_f32 v82, v82
    v_exp_f32 v83, v83
    v_cvt_pk_bf16_f32 v68, v68, v69
    v_cvt_pk_bf16_f32 v69, v70, v71
    v_cvt_pk_bf16_f32 v70, v72, v73
    v_cvt_pk_bf16_f32 v71, v74, v75
    v_cvt_pk_bf16_f32 v72, v76, v77
    v_cvt_pk_bf16_f32 v73, v78, v79
    v_cvt_pk_bf16_f32 v74, v80, v81
    v_cvt_pk_bf16_f32 v75, v82, v83
    s_waitcnt lgkmcnt(2)
    v_mfma_f32_32x32x16_bf16 v[132:147], v[148:151], v[68:71], v[132:147]
    s_waitcnt lgkmcnt(0)
    v_mfma_f32_32x32x16_bf16 v[132:147], v[152:155], v[72:75], v[132:147]
sl_10033:
    s_nop 11
    s_cmp_gt_u32 s60, 6
    s_cbranch_scc1 sl_10034
    ds_read_b128 v[100:103], v174 offset:6144
    ds_read_b64 v[104:105], v175 offset:1536
    s_waitcnt lgkmcnt(1)
    v_mfma_f32_32x32x16_bf16 v[68:83], v[100:103], v[28:31], 0
    s_waitcnt lgkmcnt(0)
    v_mfma_f32_32x32x16_bf16 v[68:83], v[104:107], v[48:51], v[68:83]
    ds_read_b64_tr_b16 v[148:149], v176 offset:12288
    ds_read_b64_tr_b16 v[150:151], v177 offset:12800
    ds_read_b64_tr_b16 v[152:153], v176 offset:13312
    ds_read_b64_tr_b16 v[154:155], v177 offset:13824
    s_nop 7
    v_sub_f32 v68, v68, v178
    v_sub_f32 v69, v69, v178
    v_sub_f32 v70, v70, v178
    v_sub_f32 v71, v71, v178
    v_sub_f32 v72, v72, v178
    v_sub_f32 v73, v73, v178
    v_sub_f32 v74, v74, v178
    v_sub_f32 v75, v75, v178
    v_sub_f32 v76, v76, v178
    v_sub_f32 v77, v77, v178
    v_sub_f32 v78, v78, v178
    v_sub_f32 v79, v79, v178
    v_sub_f32 v80, v80, v178
    v_sub_f32 v81, v81, v178
    v_sub_f32 v82, v82, v178
    v_sub_f32 v83, v83, v178
    v_exp_f32 v68, v68
    v_exp_f32 v69, v69
    v_exp_f32 v70, v70
    v_exp_f32 v71, v71
    v_exp_f32 v72, v72
    v_exp_f32 v73, v73
    v_exp_f32 v74, v74
    v_exp_f32 v75, v75
    v_exp_f32 v76, v76
    v_exp_f32 v77, v77
    v_exp_f32 v78, v78
    v_exp_f32 v79, v79
    v_exp_f32 v80, v80
    v_exp_f32 v81, v81
    v_exp_f32 v82, v82
    v_exp_f32 v83, v83
    v_cvt_pk_bf16_f32 v68, v68, v69
    v_cvt_pk_bf16_f32 v69, v70, v71
    v_cvt_pk_bf16_f32 v70, v72, v73
    v_cvt_pk_bf16_f32 v71, v74, v75
    v_cvt_pk_bf16_f32 v72, v76, v77
    v_cvt_pk_bf16_f32 v73, v78, v79
    v_cvt_pk_bf16_f32 v74, v80, v81
    v_cvt_pk_bf16_f32 v75, v82, v83
    s_waitcnt lgkmcnt(2)
    v_mfma_f32_32x32x16_bf16 v[132:147], v[148:151], v[68:71], v[132:147]
    s_waitcnt lgkmcnt(0)
    v_mfma_f32_32x32x16_bf16 v[132:147], v[152:155], v[72:75], v[132:147]
sl_10034:
    s_nop 11
    s_cmp_gt_u32 s60, 7
    s_cbranch_scc1 sl_10035
    ds_read_b128 v[100:103], v174 offset:7168
    ds_read_b64 v[104:105], v175 offset:1792
    s_waitcnt lgkmcnt(1)
    v_mfma_f32_32x32x16_bf16 v[68:83], v[100:103], v[28:31], 0
    s_waitcnt lgkmcnt(0)
    v_mfma_f32_32x32x16_bf16 v[68:83], v[104:107], v[48:51], v[68:83]
    ds_read_b64_tr_b16 v[148:149], v176 offset:14336
    ds_read_b64_tr_b16 v[150:151], v177 offset:14848
    ds_read_b64_tr_b16 v[152:153], v176 offset:15360
    ds_read_b64_tr_b16 v[154:155], v177 offset:15872
    s_nop 7
    v_sub_f32 v68, v68, v178
    v_sub_f32 v69, v69, v178
    v_sub_f32 v70, v70, v178
    v_sub_f32 v71, v71, v178
    v_sub_f32 v72, v72, v178
    v_sub_f32 v73, v73, v178
    v_sub_f32 v74, v74, v178
    v_sub_f32 v75, v75, v178
    v_sub_f32 v76, v76, v178
    v_sub_f32 v77, v77, v178
    v_sub_f32 v78, v78, v178
    v_sub_f32 v79, v79, v178
    v_sub_f32 v80, v80, v178
    v_sub_f32 v81, v81, v178
    v_sub_f32 v82, v82, v178
    v_sub_f32 v83, v83, v178
    v_exp_f32 v68, v68
    v_exp_f32 v69, v69
    v_exp_f32 v70, v70
    v_exp_f32 v71, v71
    v_exp_f32 v72, v72
    v_exp_f32 v73, v73
    v_exp_f32 v74, v74
    v_exp_f32 v75, v75
    v_exp_f32 v76, v76
    v_exp_f32 v77, v77
    v_exp_f32 v78, v78
    v_exp_f32 v79, v79
    v_exp_f32 v80, v80
    v_exp_f32 v81, v81
    v_exp_f32 v82, v82
    v_exp_f32 v83, v83
    v_cvt_pk_bf16_f32 v68, v68, v69
    v_cvt_pk_bf16_f32 v69, v70, v71
    v_cvt_pk_bf16_f32 v70, v72, v73
    v_cvt_pk_bf16_f32 v71, v74, v75
    v_cvt_pk_bf16_f32 v72, v76, v77
    v_cvt_pk_bf16_f32 v73, v78, v79
    v_cvt_pk_bf16_f32 v74, v80, v81
    v_cvt_pk_bf16_f32 v75, v82, v83
    s_waitcnt lgkmcnt(2)
    v_mfma_f32_32x32x16_bf16 v[132:147], v[148:151], v[68:71], v[132:147]
    s_waitcnt lgkmcnt(0)
    v_mfma_f32_32x32x16_bf16 v[132:147], v[152:155], v[72:75], v[132:147]
sl_10035:
    s_nop 11
    s_cmp_gt_u32 s60, 8
    s_cbranch_scc1 sl_10036
    ds_read_b128 v[100:103], v174 offset:8192
    ds_read_b64 v[104:105], v175 offset:2048
    s_waitcnt lgkmcnt(1)
    v_mfma_f32_32x32x16_bf16 v[68:83], v[100:103], v[28:31], v[180:195]
    s_waitcnt lgkmcnt(0)
    v_mfma_f32_32x32x16_bf16 v[68:83], v[104:107], v[48:51], v[68:83]
    ds_read_b64_tr_b16 v[148:149], v176 offset:16384
    ds_read_b64_tr_b16 v[150:151], v177 offset:16896
    ds_read_b64_tr_b16 v[152:153], v176 offset:17408
    ds_read_b64_tr_b16 v[154:155], v177 offset:17920
    s_nop 7
    v_sub_f32 v68, v68, v178
    v_sub_f32 v69, v69, v178
    v_sub_f32 v70, v70, v178
    v_sub_f32 v71, v71, v178
    v_sub_f32 v72, v72, v178
    v_sub_f32 v73, v73, v178
    v_sub_f32 v74, v74, v178
    v_sub_f32 v75, v75, v178
    v_sub_f32 v76, v76, v178
    v_sub_f32 v77, v77, v178
    v_sub_f32 v78, v78, v178
    v_sub_f32 v79, v79, v178
    v_sub_f32 v80, v80, v178
    v_sub_f32 v81, v81, v178
    v_sub_f32 v82, v82, v178
    v_sub_f32 v83, v83, v178
    v_exp_f32 v68, v68
    v_exp_f32 v69, v69
    v_exp_f32 v70, v70
    v_exp_f32 v71, v71
    v_exp_f32 v72, v72
    v_exp_f32 v73, v73
    v_exp_f32 v74, v74
    v_exp_f32 v75, v75
    v_exp_f32 v76, v76
    v_exp_f32 v77, v77
    v_exp_f32 v78, v78
    v_exp_f32 v79, v79
    v_exp_f32 v80, v80
    v_exp_f32 v81, v81
    v_exp_f32 v82, v82
    v_exp_f32 v83, v83
    v_cvt_pk_bf16_f32 v68, v68, v69
    v_cvt_pk_bf16_f32 v69, v70, v71
    v_cvt_pk_bf16_f32 v70, v72, v73
    v_cvt_pk_bf16_f32 v71, v74, v75
    v_cvt_pk_bf16_f32 v72, v76, v77
    v_cvt_pk_bf16_f32 v73, v78, v79
    v_cvt_pk_bf16_f32 v74, v80, v81
    v_cvt_pk_bf16_f32 v75, v82, v83
    s_waitcnt lgkmcnt(2)
    v_mfma_f32_32x32x16_bf16 v[132:147], v[148:151], v[68:71], v[132:147]
    s_waitcnt lgkmcnt(0)
    v_mfma_f32_32x32x16_bf16 v[132:147], v[152:155], v[72:75], v[132:147]
sl_10036:
    s_nop 11
    v_mov_b32 v166, v140
    v_mov_b32 v167, v140
    s_nop 1
    v_permlane32_swap_b32 v166, v167
    s_nop 2
    s_branch normB
to_74:
    s_mov_b32 s23, 0
    s_branch pd_73
inv_75:
    buffer_inv sc1
    s_waitcnt vmcnt(0)
    s_branch invr_76
du_77:
    s_nop 7
    s_nop 7
    s_waitcnt vmcnt(0) lgkmcnt(0)
    s_bitcmp1_b32 s25, 0
    s_cbranch_scc1 xo_10037
    buffer_store_dwordx4 v[246:249], v244, s[4:7], s34 offen sc1
    buffer_store_dwordx4 v[250:253], v244, s[4:7], s36 offen sc1
    buffer_store_dwordx2 v[254:255], v244, s[4:7], s38 offen sc1
    s_branch xj_10038
xo_10037:
    buffer_store_dwordx4 v[248:251], v244, s[4:7], s35 offen sc1
    buffer_store_dwordx4 v[252:255], v244, s[4:7], s37 offen sc1
    buffer_store_dwordx2 v[246:247], v244, s[4:7], s34 offen sc1
xj_10038:
    s_nop 2
    s_branch dur_78
du_81:
    s_nop 7
    s_nop 7
    s_waitcnt vmcnt(0) lgkmcnt(0)
    s_mov_b64 exec, 0xffff
    buffer_store_dwordx2 v[40:41], v2, s[4:7], s40 offen sc1
    s_mov_b64 exec, -1
    s_nop 2
    s_branch dur_82
to_85:
    s_mov_b32 s23, 0
    s_branch pd_84
inv_86:
    buffer_inv sc1
    s_waitcnt vmcnt(0)
    s_branch invr_87
du_88:
    s_nop 7
    s_nop 7
    s_waitcnt vmcnt(0) lgkmcnt(0)
    buffer_store_dwordx4 v[56:59], v1, s[4:7], s44 offen offset:0 sc1
    buffer_store_dwordx4 v[64:67], v1, s[4:7], s44 offen offset:1024 sc1
    s_nop 2
    s_branch dur_89
du_90:
    s_nop 7
    s_nop 7
    s_waitcnt vmcnt(0) lgkmcnt(0)
    buffer_store_dwordx4 v[72:75], v1, s[4:7], s44 offen offset:2048 sc1
    buffer_store_dwordx4 v[80:83], v1, s[4:7], s44 offen offset:3072 sc1
    s_nop 2
    s_branch dur_91
du_92:
    s_nop 7
    s_nop 7
    s_waitcnt vmcnt(0) lgkmcnt(0)
    buffer_store_dwordx4 v[88:91], v1, s[4:7], s45 offen offset:0 sc1
    buffer_store_dwordx4 v[96:99], v1, s[4:7], s45 offen offset:1024 sc1
    s_nop 2
    s_branch dur_93
du_94:
    s_nop 7
    s_nop 7
    s_waitcnt vmcnt(0) lgkmcnt(0)
    s_mov_b64 exec, 1
    buffer_store_dword v8, v9, s[4:7], s40 offen sc1
    s_mov_b64 exec, -1
    s_nop 2
    s_branch dur_95
to_98:
    s_mov_b32 s23, 0
    s_branch pd_97
inv_99:
    buffer_inv sc1
    s_waitcnt vmcnt(0)
    s_branch invr_100
du_102:
    s_nop 7
    s_nop 7
    s_waitcnt vmcnt(0) lgkmcnt(0)
    s_bitcmp1_b32 s25, 0
    s_cbranch_scc1 xo_10039
    buffer_store_dwordx4 v[246:249], v244, s[4:7], s34 offen sc1
    buffer_store_dwordx4 v[250:253], v244, s[4:7], s36 offen sc1
    buffer_store_dwordx2 v[254:255], v244, s[4:7], s38 offen sc1
    s_branch xj_10040
xo_10039:
    buffer_store_dwordx4 v[248:251], v244, s[4:7], s35 offen sc1
    buffer_store_dwordx4 v[252:255], v244, s[4:7], s37 offen sc1
    buffer_store_dwordx2 v[246:247], v244, s[4:7], s34 offen sc1
xj_10040:
    s_nop 2
    s_branch dur_103
du_106:
    s_nop 7
    s_nop 7
    s_waitcnt vmcnt(0) lgkmcnt(0)
    s_mov_b64 exec, 0xffff
    buffer_store_dwordx2 v[40:41], v2, s[4:7], s40 offen sc1
    s_mov_b64 exec, -1
    s_nop 2
    s_branch dur_107
to_20008:
    s_mov_b32 s23, 0
    s_branch pd_20006
to_20018:
    s_mov_b32 s23, 0
    s_branch pd_20016
to_20022:
    s_mov_b32 s23, 0
    s_branch pd_20021
to_20029:
    s_mov_b32 s23, 0
    s_branch pd_20027
to_20034:
    s_mov_b32 s23, 0
    s_branch lfd_20033
to_20037:
    s_mov_b32 s23, 0
    s_branch lfd_20036
to_20043:
    s_mov_b32 s23, 0
    s_branch pd_20042
    s_endpgm
.section .rodata,"a"
.p2align 6
.amdhsa_kernel interleave_layers__sliding_block__dense_activation_squared_relu__prompt_kernel
  .amdhsa_next_free_vgpr 256
  .amdhsa_next_free_sgpr 102
  .amdhsa_accum_offset 256
  .amdhsa_group_segment_fixed_size 0
  .amdhsa_kernarg_size 88
  .amdhsa_user_sgpr_count 2
  .amdhsa_user_sgpr_kernarg_segment_ptr 1
  .amdhsa_system_sgpr_workgroup_id_x 1
  .amdhsa_float_denorm_mode_32 3
.end_amdhsa_kernel
```
